```python
import torch

def _softmax(x, axis=-1):
    return torch.softmax(x, dim=axis)
def _gelu(x):
    return torch.nn.functional.gelu(x, approximate="tanh")
def _silu(x):
    return torch.nn.functional.silu(x)
def _sigmoid(x):
    return torch.sigmoid(x)
def _layernorm(x, axis=-1, eps=1e-5):
    m = x.mean(dim=axis, keepdim=True)
    v = x.var(dim=axis, keepdim=True, unbiased=False)
    return (x - m) / torch.sqrt(v + eps)
def _scatter_add(tgt, idx, src, axis=0):
    return tgt.clone().index_add_(axis, idx, src)
def _segment_sum(src, seg, n):
    out = torch.zeros((n,) + src.shape[1:], dtype=src.dtype)
    return out.index_add_(0, seg, src)
def _pad(x, pw):
    flat = tuple(v for pair in reversed(pw) for v in pair)
    return torch.nn.functional.pad(x, flat)

kernel_name = 'standalone__swiglu_ffn__prompt'

def setup_inputs():

    _w = (lambda a: (lambda t: t.to(torch.bfloat16) if t.is_floating_point() else t)(torch.as_tensor(a)))
    B, S, D, F = 1, 2048, 1024, 3584
    return {
        "x": _w((lambda *s: torch.randn(*s, dtype=torch.bfloat16) * 0.05)(B, S, D)),
        "w_gate": _w((lambda *s: torch.randn(*s, dtype=torch.bfloat16) * 0.05)(D, F)),
        "w_up": _w((lambda *s: torch.randn(*s, dtype=torch.bfloat16) * 0.05)(D, F)),
        "w_down": _w((lambda *s: torch.randn(*s, dtype=torch.bfloat16) * 0.05)(F, D)),
    }

def reference(x, w_gate, w_up, w_down):
    g = _silu(x @ w_gate)
    u = x @ w_up
    return (g * u) @ w_down
```

```asm
; @launch grid=(256,1,1) block=(256,1,1) lds=163840
.amdgcn_target "amdgcn-amd-amdhsa--gfx950"
.text
.globl standalone__swiglu_ffn__prompt_kernel
.p2align 8
.type standalone__swiglu_ffn__prompt_kernel,@function
standalone__swiglu_ffn__prompt_kernel:
    s_cmp_ge_u32 s2, 256
    s_cbranch_scc1 L_end
    s_load_dwordx4 s[4:7], s[0:1], 0
    s_load_dwordx4 s[12:15], s[0:1], 16
    s_load_dwordx4 s[60:63], s[0:1], 40
    s_load_dwordx2 s[100:101], s[0:1], 32
    v_lshrrev_b32 v20, 6, v0
    s_nop 0
    v_readfirstlane_b32 s16, v20
    s_getpc_b64 s[58:59]
    s_lshr_b32 s57, s2, 3
    v_and_b32 v31, 15, v0
    s_lshl_b32 s56, s57, 11
    v_lshl_add_u32 v21, v31, 7, s56
    global_load_dword v16, v21, s[58:59]
    v_and_b32 v0, 63, v0
    s_and_b32 s19, s57, 7
    s_lshr_b32 s59, s57, 3
    s_and_b32 s56, s2, 7
    s_lshl_b32 s56, s56, 2
    s_add_u32 s20, s56, s59
    s_and_b32 s17, s16, 1
    s_lshr_b32 s18, s16, 1
    v_lshrrev_b32 v30, 4, v0
    s_lshl_b32 s56, s17, 2
    v_or_b32 v23, s56, v30
    v_and_b32 v22, 7, v0
    v_xor_b32 v21, v23, v22
    v_lshlrev_b32 v21, 4, v21
    v_lshrrev_b32 v22, 3, v0
    v_lshlrev_b32 v22, 11, v22
    s_lshl_b32 s57, s19, 19
    v_add3_u32 v1, v21, v22, s57
    v_lshl_or_b32 v21, v23, 1, s18
    v_xor_b32 v21, v21, v31
    s_and_b32 s57, s20, 1
    s_lshl_b32 s57, s57, 1
    v_subrev_u32 v24, s57, v21
    v_cmp_gt_u32 vcc, 14, v24
    v_mov_b32 v24, 0x4000000
    s_nop 0
    v_cndmask_b32 v21, v24, v21, vcc
    v_lshlrev_b32 v21, 4, v21
    v_mul_u32_u24 v22, 7168, v30
    s_mul_i32 s57, s20, 224
    s_and_b32 s57, s57, 0xffffffc0
    v_add3_u32 v2, v21, v22, s57
    s_lshl_b32 s56, s59, 13
    s_lshl_b32 s22, s16, 10
    s_or_b32 s32, s56, s22
    s_lshl_b32 s24, s32, 4
    s_xor_b32 s33, s32, 0x1000
    s_lshl_b32 s25, s33, 4
    s_lshr_b32 s57, s19, 1
    s_lshl_b32 s57, s57, 12
    s_and_b32 s56, s19, 1
    s_lshl_b32 s56, s56, 10
    s_or_b32 s56, s56, s57
    s_lshl_b32 s57, s17, 11
    s_or_b32 s56, s56, s57
    s_lshl_b32 s58, s18, 14
    s_mul_i32 s40, s56, 28
    s_or_b32 s48, s56, s58
    s_xor_b32 s34, s32, 8192
    s_lshl_b32 s26, s34, 4
    s_xor_b32 s35, s32, 12288
    s_lshl_b32 s27, s35, 4
    s_xor_b32 s36, s32, 16384
    s_lshl_b32 s28, s36, 4
    s_xor_b32 s37, s32, 20480
    s_lshl_b32 s29, s37, 4
    s_xor_b32 s38, s32, 24576
    s_lshl_b32 s30, s38, 4
    s_xor_b32 s39, s32, 28672
    s_lshl_b32 s31, s39, 4
    s_xor_b32 s57, s56, 1024
    s_mul_i32 s41, s57, 28
    s_or_b32 s49, s57, s58
    s_xor_b32 s57, s56, 4096
    s_mul_i32 s42, s57, 28
    s_or_b32 s50, s57, s58
    s_xor_b32 s57, s56, 5120
    s_mul_i32 s43, s57, 28
    s_or_b32 s51, s57, s58
    s_xor_b32 s57, s56, 8192
    s_mul_i32 s44, s57, 28
    s_or_b32 s52, s57, s58
    s_xor_b32 s57, s56, 9216
    s_mul_i32 s45, s57, 28
    s_or_b32 s53, s57, s58
    s_xor_b32 s57, s56, 12288
    s_mul_i32 s46, s57, 28
    s_or_b32 s54, s57, s58
    s_xor_b32 s57, s56, 13312
    s_mul_i32 s47, s57, 28
    s_or_b32 s55, s57, s58
    v_add_u32 v28, 458752, v2
    s_cmp_eq_u32 s18, 0
    s_mov_b32 s10, 7340032
    s_mov_b32 s11, 0x20000
    s_waitcnt lgkmcnt(0)
    s_cselect_b32 s8, s6, s12
    s_cselect_b32 s9, s7, s13
    s_mov_b32 s6, 4194304
    s_mov_b32 s7, 0x20000
    s_add_u32 m0, s32, 65536
    s_nop 0
    buffer_load_dwordx4 v1, s[4:7], s24 offen offset:0 lds
    s_add_u32 m0, s33, 65536
    s_nop 0
    buffer_load_dwordx4 v1, s[4:7], s25 offen offset:0 lds
    s_add_u32 m0, s48, 0
    s_nop 0
    buffer_load_dwordx4 v2, s[8:11], s40 offen nt lds
    s_add_u32 m0, s32, 98176
    s_nop 0
    buffer_load_dwordx4 v1, s[4:7], s24 offen offset:128 lds
    s_add_u32 m0, s33, 98176
    s_nop 0
    buffer_load_dwordx4 v1, s[4:7], s25 offen offset:128 lds
    s_add_u32 m0, s48, 32768
    s_nop 0
    buffer_load_dwordx4 v28, s[8:11], s40 offen nt lds
    s_add_u32 m0, s49, 0
    s_nop 0
    buffer_load_dwordx4 v2, s[8:11], s41 offen nt lds
    s_add_u32 m0, s34, 65536
    s_nop 0
    buffer_load_dwordx4 v1, s[4:7], s26 offen offset:0 lds
    s_mov_b32 s96, s14
    s_mov_b32 s97, s15
    s_mov_b32 s98, 7340032
    s_mov_b32 s99, 0x20000
    s_mov_b32 s12, s62
    s_mov_b32 s13, s63
    s_mov_b32 s14, 33554432
    s_mov_b32 s15, 0x20000
    s_mov_b32 s62, 256
    s_mov_b32 s63, 0x20000
    s_lshl_b32 s56, s19, 1
    s_add_u32 s56, s56, s17
    s_lshl_b32 s56, s56, 5
    s_add_u32 s56, s56, s20
    s_lshl_b32 s56, s56, 8
    s_lshl_b32 s57, s18, 7
    s_add_u32 s56, s56, s57
    s_add_u32 s56, s56, 25165824
    s_xor_b32 s57, s2, 1
    s_lshl_b32 s57, s57, 2
    s_add_u32 s57, s57, s16
    s_lshl_b32 s58, s57, 7
    s_add_u32 s58, s58, 25296896
    v_lshrrev_b32 v20, 5, v0
    v_lshlrev_b32 v20, 25, v20
    v_lshl_add_u32 v20, v0, 2, v20
    v_add_u32 v19, s56, v20
    v_add_u32 v21, s58, v20
    v_accvgpr_write_b32 a240, v21
    v_lshlrev_b32 v20, 25, v0
    s_lshl_b32 s56, s2, 13
    s_lshl_b32 s59, s16, 11
    s_add_u32 s56, s56, s59
    s_cmp_lt_u32 s2, 32
    s_cselect_b32 s56, s56, 33554432
    s_add_u32 s56, s56, 25165824
    v_lshl_add_u32 v22, v0, 4, s56
    v_mov_b32 v24, 0
    v_mov_b32 v25, 0
    v_mov_b32 v26, 0
    v_mov_b32 v27, 0
    buffer_store_dwordx4 v[24:27], v22, s[12:15], 0 offen offset:0 sc1
    buffer_store_dwordx4 v[24:27], v22, s[12:15], 0 offen offset:1024 sc1
    s_xor_b32 s58, s58, 512
    v_add_u32 v21, s58, v20
    v_accvgpr_write_b32 a241, v21
    v_lshlrev_b32 v24, 4, v0
    s_lshl_b32 s57, s57, 13
    s_add_u32 s57, s57, 16777216
    v_add_u32 v21, s57, v24
    v_accvgpr_write_b32 a242, v21
    v_xor_b32 v21, 0x8000, v21
    v_accvgpr_write_b32 a243, v21
    v_lshrrev_b32 v22, 1, v31
    v_xor_b32 v22, v22, v30
    v_lshlrev_b32 v22, 4, v22
    v_lshlrev_b32 v23, 7, v31
    s_lshl_b32 s56, s17, 14
    s_add_u32 s56, s56, 65536
    v_add3_u32 v3, v22, v23, s56
    v_xor_b32 v4, 64, v3
    v_add_u32 v5, 0x10000, v3
    v_add_u32 v6, 0x10000, v4
    v_bfe_u32 v22, v0, 2, 2
    v_and_b32 v21, 1, v30
    v_lshl_or_b32 v23, v21, 2, v22
    v_lshl_add_u32 v20, v30, 3, v22
    v_lshlrev_b32 v24, 8, v20
    v_and_b32 v25, 3, v0
    v_lshlrev_b32 v26, 3, v25
    s_and_b32 s56, s20, 1
    s_lshl_b32 s57, s18, 2
    s_add_u32 s57, s57, s56
    s_add_u32 s58, s57, 0
    v_xor_b32 v27, s58, v23
    v_lshlrev_b32 v27, 5, v27
    v_add3_u32 v7, v27, v24, v26
    v_xor_b32 v27, 16, v7
    v_add_u32 v10, 0x4000, v27
    s_add_u32 s58, s57, 1
    v_xor_b32 v27, s58, v23
    v_lshlrev_b32 v27, 5, v27
    v_add3_u32 v8, v27, v24, v26
    v_xor_b32 v27, 16, v8
    v_add_u32 v11, 0x4000, v27
    s_add_u32 s58, s57, 2
    v_xor_b32 v27, s58, v23
    v_lshlrev_b32 v27, 5, v27
    v_add3_u32 v9, v27, v24, v26
    v_xor_b32 v27, 16, v9
    v_add_u32 v12, 0x4000, v27
    s_add_u32 s58, s56, 3
    v_xor_b32 v27, s58, v23
    v_lshlrev_b32 v27, 5, v27
    v_lshrrev_b32 v23, 1, v25
    v_add_u32 v27, v27, v24
    v_xor_b32 v24, s18, v23
    v_lshlrev_b32 v24, 4, v24
    v_lshlrev_b32 v23, 14, v23
    v_add3_u32 v27, v27, v24, v23
    v_and_b32 v23, 8, v26
    v_add_u32 v13, v27, v23
    v_lshlrev_b32 v20, 7, v22
    v_lshl_add_u32 v20, v30, 12, v20
    v_lshrrev_b32 v22, 1, v22
    v_lshl_or_b32 v22, v21, 1, v22
    v_xor_b32 v23, 0, v22
    v_lshlrev_b32 v23, 5, v23
    v_add3_u32 v23, v23, v20, v26
    v_accvgpr_write_b32 a244, v23
    v_xor_b32 v23, 1, v22
    v_lshlrev_b32 v23, 5, v23
    v_add3_u32 v23, v23, v20, v26
    v_accvgpr_write_b32 a245, v23
    v_xor_b32 v23, 2, v22
    v_lshlrev_b32 v23, 5, v23
    v_add3_u32 v23, v23, v20, v26
    v_accvgpr_write_b32 a246, v23
    v_xor_b32 v23, 3, v22
    v_lshlrev_b32 v23, 5, v23
    v_add3_u32 v23, v23, v20, v26
    v_accvgpr_write_b32 a247, v23
    s_lshl_b32 s56, s19, 1
    s_add_u32 s56, s56, s17
    s_mul_i32 s56, s56, 917504
    s_lshr_b32 s57, s20, 4
    s_mul_i32 s57, s57, 57344
    s_add_u32 s56, s56, s57
    s_and_b32 s57, s20, 15
    s_lshl_b32 s57, s57, 1
    s_add_u32 s57, s57, s18
    s_lshl_b32 s58, s57, 9
    s_add_u32 s58, s58, s56
    s_lshl_b32 s57, s57, 8
    s_add_u32 s57, s57, s56
    s_add_u32 s57, s57, 49152
    v_lshlrev_b32 v20, 4, v31
    v_lshrrev_b32 v23, 1, v30
    v_lshl_or_b32 v24, v21, 1, v23
    v_mul_u32_u24 v25, 114688, v21
    v_lshlrev_b32 v26, 8, v23
    v_add3_u32 v25, v25, v26, v20
    v_add_u32 v14, s58, v25
    v_mul_u32_u24 v25, 114688, v24
    v_add3_u32 v15, v25, v20, s57
    s_bfe_u32 s56, s2, 0x20001
    s_lshl_b32 s56, s56, 2
    s_bfe_u32 s57, s2, 0x20003
    s_add_u32 s19, s56, s57
    s_lshr_b32 s20, s2, 5
    s_mul_i32 s23, s18, 98304
    s_and_b32 s59, s2, 1
    v_lshlrev_b32 v22, 11, v31
    v_lshlrev_b32 v24, 4, v24
    s_lshl_b32 s56, s19, 18
    s_lshl_b32 s57, s16, 16
    s_add_u32 s56, s56, s57
    s_lshl_b32 s58, s20, 8
    s_lshl_b32 s57, s59, 7
    s_add_u32 s58, s58, s57
    s_add_u32 s56, s56, s58
    v_add3_u32 v22, v22, v24, s56
    v_accvgpr_write_b32 a248, v22
    v_lshrrev_b32 v20, 3, v0
    v_and_b32 v21, 2, v20
    v_and_b32 v22, 7, v0
    v_xor_b32 v21, v21, v22
    s_lshl_b32 s57, s17, 2
    v_xor_b32 v21, s57, v21
    v_lshlrev_b32 v21, 4, v21
    v_lshlrev_b32 v20, 11, v20
    s_mul_i32 s56, s59, 1792
    s_lshl_b32 s57, s18, 6
    s_add_u32 s56, s56, s57
    s_lshl_b32 s57, s17, 3
    s_add_u32 s56, s56, s57
    s_lshl_b32 s56, s56, 11
    s_add_u32 s56, s56, s58
    v_add3_u32 v18, v20, v21, s56
    v_xor_b32 v17, 0x80, v18
    s_lshl_b32 s56, s19, 2
    s_add_u32 s56, s56, s16
    s_mul_i32 s56, s56, 229376
    s_mul_i32 s57, s59, 57344
    s_add_u32 s56, s56, s57
    v_lshl_add_u32 v20, v0, 4, s56
    v_accvgpr_write_b32 a249, v20
    s_lshl_b32 s56, s19, 1
    s_add_u32 s56, s56, s59
    s_lshl_b32 s56, s56, 12
    s_add_u32 s56, s56, 25165824
    v_and_b32 v20, 31, v0
    v_lshl_add_u32 v20, v20, 7, s56
    v_accvgpr_write_b32 a250, v20
    s_lshl_b32 s56, s2, 2
    s_add_u32 s56, s56, s16
    s_mul_i32 s56, s56, 1024
    v_min_u32 v22, 7, v0
    v_lshl_add_u32 v27, v22, 7, s56
    v_mov_b32 v29, 0
    v_min_u32 v24, 1, v0
    v_xor_b32 v24, 1, v24
    v_accvgpr_write_b32 a252, v24
    s_lshl_b32 s21, s16, 12
    s_mov_b64 exec, 0
    s_cmp_eq_u32 s16, 0
    s_cbranch_scc1 L_pad0
    s_cmp_eq_u32 s16, 1
    s_cbranch_scc1 L_pad1
    s_cmp_eq_u32 s16, 2
    s_cbranch_scc1 L_pad2
    s_branch L_pad3
L_pad_ret:
    s_mov_b64 exec, -1
    s_add_u32 m0, s50, 0
    s_nop 0
    buffer_load_dwordx4 v2, s[8:11], s42 offen  lds
    s_add_u32 m0, s35, 65536
    s_nop 0
    buffer_load_dwordx4 v1, s[4:7], s27 offen offset:0 lds
    s_add_u32 m0, s51, 0
    s_nop 0
    buffer_load_dwordx4 v2, s[8:11], s43 offen  lds
    s_add_u32 m0, s36, 65536
    s_nop 0
    buffer_load_dwordx4 v1, s[4:7], s28 offen offset:0 lds
    s_add_u32 m0, s52, 0
    s_nop 0
    buffer_load_dwordx4 v2, s[8:11], s44 offen  lds
    s_add_u32 m0, s37, 65536
    s_nop 0
    buffer_load_dwordx4 v1, s[4:7], s29 offen offset:0 lds
    s_add_u32 m0, s53, 0
    s_nop 0
    buffer_load_dwordx4 v2, s[8:11], s45 offen  lds
    s_add_u32 m0, s38, 65536
    s_nop 0
    buffer_load_dwordx4 v1, s[4:7], s30 offen offset:0 lds
    s_add_u32 m0, s54, 0
    s_nop 0
    buffer_load_dwordx4 v2, s[8:11], s46 offen  lds
    s_add_u32 m0, s39, 65536
    s_nop 0
    buffer_load_dwordx4 v1, s[4:7], s31 offen offset:0 lds
    s_add_u32 m0, s55, 0
    s_nop 0
    buffer_load_dwordx4 v2, s[8:11], s47 offen  lds
    s_add_u32 m0, s49, 32768
    s_nop 0
    buffer_load_dwordx4 v28, s[8:11], s41 offen nt lds
    s_add_u32 m0, s34, 98176
    s_nop 0
    buffer_load_dwordx4 v1, s[4:7], s26 offen offset:128 lds
    s_add_u32 m0, s50, 32768
    s_nop 0
    buffer_load_dwordx4 v28, s[8:11], s42 offen  lds
    s_add_u32 m0, s35, 98176
    s_nop 0
    buffer_load_dwordx4 v1, s[4:7], s27 offen offset:128 lds
    s_add_u32 m0, s51, 32768
    s_nop 0
    buffer_load_dwordx4 v28, s[8:11], s43 offen  lds
    s_add_u32 m0, s36, 98176
    s_nop 0
    buffer_load_dwordx4 v1, s[4:7], s28 offen offset:128 lds
    s_add_u32 m0, s52, 32768
    s_nop 0
    buffer_load_dwordx4 v28, s[8:11], s44 offen  lds
    s_add_u32 m0, s37, 98176
    s_nop 0
    buffer_load_dwordx4 v1, s[4:7], s29 offen offset:128 lds
    s_add_u32 m0, s53, 32768
    s_nop 0
    buffer_load_dwordx4 v28, s[8:11], s45 offen  lds
    s_add_u32 m0, s38, 98176
    s_nop 0
    buffer_load_dwordx4 v1, s[4:7], s30 offen offset:128 lds
    v_add_u32 v2, 917504, v2
    s_branch L_main
.p2align 12
L_main:
L_pad0:
    s_cbranch_execz L_pad4
    s_waitcnt vmcnt(10)
    s_barrier
    ds_read_b128 a[0:3], v3 offset:0
    ds_read_b64_tr_b16 a[64:65], v7 offset:0
    ds_read_b64_tr_b16 a[66:67], v7 offset:1024
    ds_read_b128 a[4:7], v4 offset:0
    ds_read_b64_tr_b16 a[68:69], v7 offset:8192
    ds_read_b64_tr_b16 a[70:71], v7 offset:9216
    ds_read_b128 a[12:15], v4 offset:2048
    ds_read_b128 a[8:11], v3 offset:2048
    ds_read_b64_tr_b16 a[72:73], v8 offset:0
    ds_read_b64_tr_b16 a[74:75], v8 offset:1024
    ds_read_b64_tr_b16 a[76:77], v8 offset:8192
    ds_read_b64_tr_b16 a[78:79], v8 offset:9216
    s_waitcnt lgkmcnt(9)
    v_mfma_f32_16x16x32_bf16 v[32:35], a[64:67], a[0:3], 0
    ds_read_b64_tr_b16 a[80:81], v9 offset:0
    ds_read_b64_tr_b16 a[82:83], v9 offset:1024
    s_waitcnt lgkmcnt(8)
    v_mfma_f32_16x16x32_bf16 v[32:35], a[68:71], a[4:7], v[32:35]
    ds_read_b64_tr_b16 a[84:85], v9 offset:8192
    ds_read_b64_tr_b16 a[86:87], v9 offset:9216
    s_add_u32 m0, s54, 32768
    s_waitcnt lgkmcnt(9)
    v_mfma_f32_16x16x32_bf16 v[36:39], a[68:71], a[12:15], 0
    ds_read_b64_tr_b16 a[88:89], v10 offset:0
    ds_read_b64_tr_b16 a[90:91], v10 offset:1024
    buffer_load_dwordx4 v28, s[8:11], s46 offen  lds
    s_waitcnt lgkmcnt(10)
    v_mfma_f32_16x16x32_bf16 v[36:39], a[64:67], a[8:11], v[36:39]
    ds_read_b64_tr_b16 a[92:93], v10 offset:8192
    ds_read_b64_tr_b16 a[94:95], v10 offset:9216
    s_waitcnt lgkmcnt(10)
    v_mfma_f32_16x16x32_bf16 v[100:103], a[72:75], a[8:11], 0
    ds_read_b64_tr_b16 a[96:97], v11 offset:0
    ds_read_b64_tr_b16 a[98:99], v11 offset:1024
    s_waitcnt lgkmcnt(10)
    v_mfma_f32_16x16x32_bf16 v[100:103], a[76:79], a[12:15], v[100:103]
    ds_read_b64_tr_b16 a[100:101], v11 offset:8192
    ds_read_b64_tr_b16 a[102:103], v11 offset:9216
    s_add_u32 m0, s39, 98176
    v_mfma_f32_16x16x32_bf16 v[96:99], a[76:79], a[4:7], 0
    ds_read_b64_tr_b16 a[104:105], v12 offset:0
    ds_read_b64_tr_b16 a[106:107], v12 offset:1024
    buffer_load_dwordx4 v1, s[4:7], s31 offen offset:128 lds
    v_mfma_f32_16x16x32_bf16 v[96:99], a[72:75], a[0:3], v[96:99]
    ds_read_b64_tr_b16 a[108:109], v12 offset:8192
    ds_read_b64_tr_b16 a[110:111], v12 offset:9216
    s_waitcnt lgkmcnt(14)
    v_mfma_f32_16x16x32_bf16 v[160:163], a[80:83], a[0:3], 0
    ds_read_b64_tr_b16 a[112:113], v13 offset:0
    ds_read_b64_tr_b16 a[114:115], v13 offset:1024
    s_waitcnt lgkmcnt(14)
    v_mfma_f32_16x16x32_bf16 v[160:163], a[84:87], a[4:7], v[160:163]
    ds_read_b64_tr_b16 a[116:117], v13 offset:8192
    ds_read_b64_tr_b16 a[118:119], v13 offset:9216
    s_add_u32 m0, s55, 32768
    v_mfma_f32_16x16x32_bf16 v[164:167], a[84:87], a[12:15], 0
    ds_read_b128 a[16:19], v3 offset:4096
    buffer_load_dwordx4 v28, s[8:11], s47 offen  lds
    v_mfma_f32_16x16x32_bf16 v[164:167], a[80:83], a[8:11], v[164:167]
    ds_read_b128 a[20:23], v4 offset:4096
    s_waitcnt lgkmcnt(14)
    v_mfma_f32_16x16x32_bf16 v[68:71], a[88:91], a[8:11], 0
    ds_read_b128 a[28:31], v4 offset:6144
    v_mfma_f32_16x16x32_bf16 v[68:71], a[92:95], a[12:15], v[68:71]
    ds_read_b128 a[24:27], v3 offset:6144
    s_add_u32 m0, s32, 130816
    v_mfma_f32_16x16x32_bf16 v[64:67], a[92:95], a[4:7], 0
    ds_read_b128 a[32:35], v3 offset:8192
    buffer_load_dwordx4 v1, s[4:7], s24 offen offset:256 lds
    v_mfma_f32_16x16x32_bf16 v[64:67], a[88:91], a[0:3], v[64:67]
    ds_read_b128 a[36:39], v4 offset:8192
    s_waitcnt lgkmcnt(14)
    v_mfma_f32_16x16x32_bf16 v[128:131], a[96:99], a[0:3], 0
    ds_read_b128 a[44:47], v4 offset:10240
    v_mfma_f32_16x16x32_bf16 v[128:131], a[100:103], a[4:7], v[128:131]
    ds_read_b128 a[40:43], v3 offset:10240
    s_add_u32 m0, s33, 130816
    v_mfma_f32_16x16x32_bf16 v[132:135], a[100:103], a[12:15], 0
    ds_read_b128 a[48:51], v3 offset:12288
    buffer_load_dwordx4 v1, s[4:7], s25 offen offset:256 lds
    v_mfma_f32_16x16x32_bf16 v[132:135], a[96:99], a[8:11], v[132:135]
    ds_read_b128 a[52:55], v4 offset:12288
    s_waitcnt lgkmcnt(14)
    v_mfma_f32_16x16x32_bf16 v[196:199], a[104:107], a[8:11], 0
    ds_read_b128 a[60:63], v4 offset:14336
    v_mfma_f32_16x16x32_bf16 v[196:199], a[108:111], a[12:15], v[196:199]
    ds_read_b128 a[56:59], v3 offset:14336
    s_add_u32 m0, s34, 130816
    v_mfma_f32_16x16x32_bf16 v[192:195], a[108:111], a[4:7], 0
    buffer_load_dwordx4 v1, s[4:7], s26 offen offset:256 lds
    v_mfma_f32_16x16x32_bf16 v[192:195], a[104:107], a[0:3], v[192:195]
    s_waitcnt lgkmcnt(14)
    v_mfma_f32_16x16x32_bf16 v[224:227], a[112:115], a[0:3], 0
    s_waitcnt lgkmcnt(12)
    v_mfma_f32_16x16x32_bf16 v[224:227], a[116:119], a[4:7], v[224:227]
    s_add_u32 m0, s35, 130816
    v_mfma_f32_16x16x32_bf16 v[228:231], a[116:119], a[12:15], 0
    buffer_load_dwordx4 v1, s[4:7], s27 offen offset:256 lds
    v_mfma_f32_16x16x32_bf16 v[228:231], a[112:115], a[8:11], v[228:231]
    s_waitcnt lgkmcnt(11)
    v_mfma_f32_16x16x32_bf16 v[40:43], a[64:67], a[16:19], 0
    s_waitcnt lgkmcnt(10)
    v_mfma_f32_16x16x32_bf16 v[40:43], a[68:71], a[20:23], v[40:43]
    s_add_u32 m0, s36, 130816
    s_waitcnt lgkmcnt(9)
    v_mfma_f32_16x16x32_bf16 v[44:47], a[68:71], a[28:31], 0
    buffer_load_dwordx4 v1, s[4:7], s28 offen offset:256 lds
    s_waitcnt lgkmcnt(8)
    v_mfma_f32_16x16x32_bf16 v[44:47], a[64:67], a[24:27], v[44:47]
    v_mfma_f32_16x16x32_bf16 v[108:111], a[72:75], a[24:27], 0
    v_mfma_f32_16x16x32_bf16 v[108:111], a[76:79], a[28:31], v[108:111]
    s_add_u32 m0, s37, 130816
    v_mfma_f32_16x16x32_bf16 v[104:107], a[76:79], a[20:23], 0
    buffer_load_dwordx4 v1, s[4:7], s29 offen offset:256 lds
    v_mfma_f32_16x16x32_bf16 v[104:107], a[72:75], a[16:19], v[104:107]
    v_mfma_f32_16x16x32_bf16 v[168:171], a[80:83], a[16:19], 0
    v_mfma_f32_16x16x32_bf16 v[168:171], a[84:87], a[20:23], v[168:171]
    s_add_u32 m0, s38, 130816
    v_mfma_f32_16x16x32_bf16 v[172:175], a[84:87], a[28:31], 0
    buffer_load_dwordx4 v1, s[4:7], s30 offen offset:256 lds
    v_mfma_f32_16x16x32_bf16 v[172:175], a[80:83], a[24:27], v[172:175]
    v_mfma_f32_16x16x32_bf16 v[76:79], a[88:91], a[24:27], 0
    v_mfma_f32_16x16x32_bf16 v[76:79], a[92:95], a[28:31], v[76:79]
    s_add_u32 m0, s39, 130816
    v_mfma_f32_16x16x32_bf16 v[72:75], a[92:95], a[20:23], 0
    buffer_load_dwordx4 v1, s[4:7], s31 offen offset:256 lds
    v_mfma_f32_16x16x32_bf16 v[72:75], a[88:91], a[16:19], v[72:75]
    v_mfma_f32_16x16x32_bf16 v[136:139], a[96:99], a[16:19], 0
    v_mfma_f32_16x16x32_bf16 v[136:139], a[100:103], a[20:23], v[136:139]
    v_mfma_f32_16x16x32_bf16 v[140:143], a[100:103], a[28:31], 0
    v_mfma_f32_16x16x32_bf16 v[140:143], a[96:99], a[24:27], v[140:143]
    v_mfma_f32_16x16x32_bf16 v[204:207], a[104:107], a[24:27], 0
    v_mfma_f32_16x16x32_bf16 v[204:207], a[108:111], a[28:31], v[204:207]
    v_mfma_f32_16x16x32_bf16 v[200:203], a[108:111], a[20:23], 0
    v_mfma_f32_16x16x32_bf16 v[200:203], a[104:107], a[16:19], v[200:203]
    v_mfma_f32_16x16x32_bf16 v[232:235], a[112:115], a[16:19], 0
    v_mfma_f32_16x16x32_bf16 v[232:235], a[116:119], a[20:23], v[232:235]
    v_mfma_f32_16x16x32_bf16 v[236:239], a[116:119], a[28:31], 0
    v_mfma_f32_16x16x32_bf16 v[236:239], a[112:115], a[24:27], v[236:239]
    s_waitcnt lgkmcnt(7)
    v_mfma_f32_16x16x32_bf16 v[48:51], a[64:67], a[32:35], 0
    s_waitcnt lgkmcnt(6)
    v_mfma_f32_16x16x32_bf16 v[48:51], a[68:71], a[36:39], v[48:51]
    s_waitcnt lgkmcnt(5)
    v_mfma_f32_16x16x32_bf16 v[52:55], a[68:71], a[44:47], 0
    s_waitcnt lgkmcnt(4)
    v_mfma_f32_16x16x32_bf16 v[52:55], a[64:67], a[40:43], v[52:55]
    s_waitcnt vmcnt(8) lgkmcnt(0)
    s_barrier
    v_mfma_f32_16x16x32_bf16 v[116:119], a[72:75], a[40:43], 0
    s_add_u32 m0, s32, 65152
    ds_read_b128 a[120:123], v3 offset:32768
    v_mfma_f32_16x16x32_bf16 v[116:119], a[76:79], a[44:47], v[116:119]
    buffer_load_dwordx4 v1, s[4:7], s24 offen offset:384 lds
    ds_read_b64_tr_b16 a[184:185], v7 offset:32768
    v_mfma_f32_16x16x32_bf16 v[112:115], a[76:79], a[36:39], 0
    s_add_u32 m0, s33, 65152
    v_mfma_f32_16x16x32_bf16 v[112:115], a[72:75], a[32:35], v[112:115]
    buffer_load_dwordx4 v1, s[4:7], s25 offen offset:384 lds
    ds_read_b64_tr_b16 a[186:187], v7 offset:33792
    v_mfma_f32_16x16x32_bf16 v[176:179], a[80:83], a[32:35], 0
    s_add_u32 m0, s48, 0
    ds_read_b128 a[124:127], v4 offset:32768
    v_mfma_f32_16x16x32_bf16 v[176:179], a[84:87], a[36:39], v[176:179]
    buffer_load_dwordx4 v2, s[8:11], s40 offen nt lds
    v_mfma_f32_16x16x32_bf16 v[180:183], a[84:87], a[44:47], 0
    ds_read_b64_tr_b16 a[188:189], v7 offset:40960
    v_mfma_f32_16x16x32_bf16 v[180:183], a[80:83], a[40:43], v[180:183]
    ds_read_b64_tr_b16 a[190:191], v7 offset:41984
    v_mfma_f32_16x16x32_bf16 v[84:87], a[88:91], a[40:43], 0
    v_mfma_f32_16x16x32_bf16 v[84:87], a[92:95], a[44:47], v[84:87]
    ds_read_b128 a[132:135], v4 offset:34816
    v_mfma_f32_16x16x32_bf16 v[80:83], a[92:95], a[36:39], 0
    ds_read_b128 a[128:131], v3 offset:34816
    v_mfma_f32_16x16x32_bf16 v[80:83], a[88:91], a[32:35], v[80:83]
    v_mfma_f32_16x16x32_bf16 v[144:147], a[96:99], a[32:35], 0
    ds_read_b64_tr_b16 a[192:193], v8 offset:32768
    v_mfma_f32_16x16x32_bf16 v[144:147], a[100:103], a[36:39], v[144:147]
    ds_read_b64_tr_b16 a[194:195], v8 offset:33792
    v_mfma_f32_16x16x32_bf16 v[148:151], a[100:103], a[44:47], 0
    v_mfma_f32_16x16x32_bf16 v[148:151], a[96:99], a[40:43], v[148:151]
    s_add_u32 m0, s49, 0
    ds_read_b64_tr_b16 a[196:197], v8 offset:40960
    v_mfma_f32_16x16x32_bf16 v[212:215], a[104:107], a[40:43], 0
    buffer_load_dwordx4 v2, s[8:11], s41 offen nt lds
    ds_read_b64_tr_b16 a[198:199], v8 offset:41984
    v_mfma_f32_16x16x32_bf16 v[212:215], a[108:111], a[44:47], v[212:215]
    v_mfma_f32_16x16x32_bf16 v[208:211], a[108:111], a[36:39], 0
    ds_read_b64_tr_b16 a[200:201], v9 offset:32768
    v_mfma_f32_16x16x32_bf16 v[208:211], a[104:107], a[32:35], v[208:211]
    ds_read_b64_tr_b16 a[202:203], v9 offset:33792
    v_mfma_f32_16x16x32_bf16 v[240:243], a[112:115], a[32:35], 0
    v_mfma_f32_16x16x32_bf16 v[240:243], a[116:119], a[36:39], v[240:243]
    ds_read_b64_tr_b16 a[204:205], v9 offset:40960
    v_mfma_f32_16x16x32_bf16 v[244:247], a[116:119], a[44:47], 0
    ds_read_b64_tr_b16 a[206:207], v9 offset:41984
    v_mfma_f32_16x16x32_bf16 v[244:247], a[112:115], a[40:43], v[244:247]
    v_mfma_f32_16x16x32_bf16 v[56:59], a[64:67], a[48:51], 0
    ds_read_b64_tr_b16 a[208:209], v10 offset:32768
    v_mfma_f32_16x16x32_bf16 v[56:59], a[68:71], a[52:55], v[56:59]
    s_add_u32 m0, s50, 0
    ds_read_b64_tr_b16 a[210:211], v10 offset:33792
    v_mfma_f32_16x16x32_bf16 v[60:63], a[68:71], a[60:63], 0
    buffer_load_dwordx4 v2, s[8:11], s42 offen  lds
    v_mfma_f32_16x16x32_bf16 v[60:63], a[64:67], a[56:59], v[60:63]
    ds_read_b64_tr_b16 a[212:213], v10 offset:40960
    v_mfma_f32_16x16x32_bf16 v[124:127], a[72:75], a[56:59], 0
    ds_read_b64_tr_b16 a[214:215], v10 offset:41984
    v_mfma_f32_16x16x32_bf16 v[124:127], a[76:79], a[60:63], v[124:127]
    v_mfma_f32_16x16x32_bf16 v[120:123], a[76:79], a[52:55], 0
    ds_read_b64_tr_b16 a[216:217], v11 offset:32768
    v_mfma_f32_16x16x32_bf16 v[120:123], a[72:75], a[48:51], v[120:123]
    ds_read_b64_tr_b16 a[218:219], v11 offset:33792
    v_mfma_f32_16x16x32_bf16 v[184:187], a[80:83], a[48:51], 0
    v_mfma_f32_16x16x32_bf16 v[184:187], a[84:87], a[52:55], v[184:187]
    ds_read_b64_tr_b16 a[220:221], v11 offset:40960
    v_mfma_f32_16x16x32_bf16 v[188:191], a[84:87], a[60:63], 0
    ds_read_b64_tr_b16 a[222:223], v11 offset:41984
    v_mfma_f32_16x16x32_bf16 v[188:191], a[80:83], a[56:59], v[188:191]
    s_add_u32 m0, s51, 0
    v_mfma_f32_16x16x32_bf16 v[92:95], a[88:91], a[56:59], 0
    buffer_load_dwordx4 v2, s[8:11], s43 offen  lds
    ds_read_b64_tr_b16 a[224:225], v12 offset:32768
    v_mfma_f32_16x16x32_bf16 v[92:95], a[92:95], a[60:63], v[92:95]
    ds_read_b64_tr_b16 a[226:227], v12 offset:33792
    v_mfma_f32_16x16x32_bf16 v[88:91], a[92:95], a[52:55], 0
    v_mfma_f32_16x16x32_bf16 v[88:91], a[88:91], a[48:51], v[88:91]
    ds_read_b64_tr_b16 a[228:229], v12 offset:40960
    v_mfma_f32_16x16x32_bf16 v[152:155], a[96:99], a[48:51], 0
    ds_read_b64_tr_b16 a[230:231], v12 offset:41984
    v_mfma_f32_16x16x32_bf16 v[152:155], a[100:103], a[52:55], v[152:155]
    v_mfma_f32_16x16x32_bf16 v[156:159], a[100:103], a[60:63], 0
    ds_read_b64_tr_b16 a[232:233], v13 offset:32768
    v_mfma_f32_16x16x32_bf16 v[156:159], a[96:99], a[56:59], v[156:159]
    ds_read_b64_tr_b16 a[234:235], v13 offset:33792
    v_mfma_f32_16x16x32_bf16 v[220:223], a[104:107], a[56:59], 0
    s_add_u32 m0, s52, 0
    v_mfma_f32_16x16x32_bf16 v[220:223], a[108:111], a[60:63], v[220:223]
    buffer_load_dwordx4 v2, s[8:11], s44 offen  lds
    ds_read_b64_tr_b16 a[236:237], v13 offset:40960
    v_mfma_f32_16x16x32_bf16 v[216:219], a[108:111], a[52:55], 0
    ds_read_b64_tr_b16 a[238:239], v13 offset:41984
    v_mfma_f32_16x16x32_bf16 v[216:219], a[104:107], a[48:51], v[216:219]
    v_mfma_f32_16x16x32_bf16 v[248:251], a[112:115], a[48:51], 0
    v_mfma_f32_16x16x32_bf16 v[248:251], a[116:119], a[52:55], v[248:251]
    v_mfma_f32_16x16x32_bf16 v[252:255], a[116:119], a[60:63], 0
    v_mfma_f32_16x16x32_bf16 v[252:255], a[112:115], a[56:59], v[252:255]
    s_waitcnt lgkmcnt(14)
    v_mfma_f32_16x16x32_bf16 v[32:35], a[184:187], a[120:123], v[32:35]
    s_lshl_b32 s56, s16, 8
    v_mfma_f32_16x16x32_bf16 v[32:35], a[188:191], a[124:127], v[32:35]
    s_add_u32 m0, s53, 0
    ds_read_b128 a[136:139], v3 offset:36864
    s_add_u32 s56, s56, s2
    s_cmp_lt_u32 s56, 32
    s_cbranch_scc1 L_hs_add
L_hs_ret:
    v_mfma_f32_16x16x32_bf16 v[36:39], a[188:191], a[132:135], v[36:39]
    buffer_load_dwordx4 v2, s[8:11], s45 offen  lds
    v_mfma_f32_16x16x32_bf16 v[36:39], a[184:187], a[128:131], v[36:39]
    ds_read_b128 a[140:143], v4 offset:36864
    v_mfma_f32_16x16x32_bf16 v[100:103], a[192:195], a[128:131], v[100:103]
    v_mfma_f32_16x16x32_bf16 v[100:103], a[196:199], a[132:135], v[100:103]
    ds_read_b128 a[148:151], v4 offset:38912
    v_mfma_f32_16x16x32_bf16 v[96:99], a[196:199], a[124:127], v[96:99]
    v_mfma_f32_16x16x32_bf16 v[96:99], a[192:195], a[120:123], v[96:99]
    ds_read_b128 a[144:147], v3 offset:38912
    v_mfma_f32_16x16x32_bf16 v[160:163], a[200:203], a[120:123], v[160:163]
    v_mfma_f32_16x16x32_bf16 v[160:163], a[204:207], a[124:127], v[160:163]
    ds_read_b128 a[152:155], v3 offset:40960
    v_mfma_f32_16x16x32_bf16 v[164:167], a[204:207], a[132:135], v[164:167]
    s_add_u32 m0, s54, 0
    v_mfma_f32_16x16x32_bf16 v[164:167], a[200:203], a[128:131], v[164:167]
    buffer_load_dwordx4 v2, s[8:11], s46 offen  lds
    ds_read_b128 a[156:159], v4 offset:40960
    v_mfma_f32_16x16x32_bf16 v[68:71], a[208:211], a[128:131], v[68:71]
    s_waitcnt lgkmcnt(14)
    v_mfma_f32_16x16x32_bf16 v[68:71], a[212:215], a[132:135], v[68:71]
    ds_read_b128 a[164:167], v4 offset:43008
    v_mfma_f32_16x16x32_bf16 v[64:67], a[212:215], a[124:127], v[64:67]
    v_mfma_f32_16x16x32_bf16 v[64:67], a[208:211], a[120:123], v[64:67]
    ds_read_b128 a[160:163], v3 offset:43008
    v_mfma_f32_16x16x32_bf16 v[128:131], a[216:219], a[120:123], v[128:131]
    v_mfma_f32_16x16x32_bf16 v[128:131], a[220:223], a[124:127], v[128:131]
    ds_read_b128 a[168:171], v3 offset:45056
    v_mfma_f32_16x16x32_bf16 v[132:135], a[220:223], a[132:135], v[132:135]
    s_add_u32 m0, s55, 0
    v_mfma_f32_16x16x32_bf16 v[132:135], a[216:219], a[128:131], v[132:135]
    buffer_load_dwordx4 v2, s[8:11], s47 offen  lds
    ds_read_b128 a[172:175], v4 offset:45056
    s_waitcnt lgkmcnt(14)
    v_mfma_f32_16x16x32_bf16 v[196:199], a[224:227], a[128:131], v[196:199]
    v_add_u32 v2, 458752, v2
    v_mfma_f32_16x16x32_bf16 v[196:199], a[228:231], a[132:135], v[196:199]
    ds_read_b128 a[180:183], v4 offset:47104
    v_mfma_f32_16x16x32_bf16 v[192:195], a[228:231], a[124:127], v[192:195]
    v_mfma_f32_16x16x32_bf16 v[192:195], a[224:227], a[120:123], v[192:195]
    ds_read_b128 a[176:179], v3 offset:47104
    s_waitcnt lgkmcnt(14)
    v_mfma_f32_16x16x32_bf16 v[224:227], a[232:235], a[120:123], v[224:227]
    s_waitcnt lgkmcnt(12)
    v_mfma_f32_16x16x32_bf16 v[224:227], a[236:239], a[124:127], v[224:227]
    v_mfma_f32_16x16x32_bf16 v[228:231], a[236:239], a[132:135], v[228:231]
    s_add_u32 m0, s34, 65152
    v_mfma_f32_16x16x32_bf16 v[228:231], a[232:235], a[128:131], v[228:231]
    buffer_load_dwordx4 v1, s[4:7], s26 offen offset:384 lds
    s_waitcnt lgkmcnt(11)
    v_mfma_f32_16x16x32_bf16 v[40:43], a[184:187], a[136:139], v[40:43]
    s_waitcnt lgkmcnt(10)
    v_mfma_f32_16x16x32_bf16 v[40:43], a[188:191], a[140:143], v[40:43]
    s_waitcnt lgkmcnt(9)
    v_mfma_f32_16x16x32_bf16 v[44:47], a[188:191], a[148:151], v[44:47]
    s_waitcnt lgkmcnt(8)
    v_mfma_f32_16x16x32_bf16 v[44:47], a[184:187], a[144:147], v[44:47]
    v_mfma_f32_16x16x32_bf16 v[108:111], a[192:195], a[144:147], v[108:111]
    v_mfma_f32_16x16x32_bf16 v[108:111], a[196:199], a[148:151], v[108:111]
    s_add_u32 m0, s35, 65152
    v_mfma_f32_16x16x32_bf16 v[104:107], a[196:199], a[140:143], v[104:107]
    buffer_load_dwordx4 v1, s[4:7], s27 offen offset:384 lds
    v_mfma_f32_16x16x32_bf16 v[104:107], a[192:195], a[136:139], v[104:107]
    v_mfma_f32_16x16x32_bf16 v[168:171], a[200:203], a[136:139], v[168:171]
    v_mfma_f32_16x16x32_bf16 v[168:171], a[204:207], a[140:143], v[168:171]
    v_mfma_f32_16x16x32_bf16 v[172:175], a[204:207], a[148:151], v[172:175]
    v_mfma_f32_16x16x32_bf16 v[172:175], a[200:203], a[144:147], v[172:175]
    v_mfma_f32_16x16x32_bf16 v[76:79], a[208:211], a[144:147], v[76:79]
    s_add_u32 m0, s36, 65152
    v_mfma_f32_16x16x32_bf16 v[76:79], a[212:215], a[148:151], v[76:79]
    buffer_load_dwordx4 v1, s[4:7], s28 offen offset:384 lds
    v_mfma_f32_16x16x32_bf16 v[72:75], a[212:215], a[140:143], v[72:75]
    v_mfma_f32_16x16x32_bf16 v[72:75], a[208:211], a[136:139], v[72:75]
    v_mfma_f32_16x16x32_bf16 v[136:139], a[216:219], a[136:139], v[136:139]
    v_mfma_f32_16x16x32_bf16 v[136:139], a[220:223], a[140:143], v[136:139]
    v_mfma_f32_16x16x32_bf16 v[140:143], a[220:223], a[148:151], v[140:143]
    s_add_u32 m0, s37, 65152
    v_mfma_f32_16x16x32_bf16 v[140:143], a[216:219], a[144:147], v[140:143]
    buffer_load_dwordx4 v1, s[4:7], s29 offen offset:384 lds
    v_mfma_f32_16x16x32_bf16 v[204:207], a[224:227], a[144:147], v[204:207]
    v_mfma_f32_16x16x32_bf16 v[204:207], a[228:231], a[148:151], v[204:207]
    v_mfma_f32_16x16x32_bf16 v[200:203], a[228:231], a[140:143], v[200:203]
    v_mfma_f32_16x16x32_bf16 v[200:203], a[224:227], a[136:139], v[200:203]
    v_mfma_f32_16x16x32_bf16 v[232:235], a[232:235], a[136:139], v[232:235]
    s_add_u32 m0, s38, 65152
    v_mfma_f32_16x16x32_bf16 v[232:235], a[236:239], a[140:143], v[232:235]
    buffer_load_dwordx4 v1, s[4:7], s30 offen offset:384 lds
    v_mfma_f32_16x16x32_bf16 v[236:239], a[236:239], a[148:151], v[236:239]
    v_mfma_f32_16x16x32_bf16 v[236:239], a[232:235], a[144:147], v[236:239]
    s_waitcnt lgkmcnt(7)
    v_mfma_f32_16x16x32_bf16 v[48:51], a[184:187], a[152:155], v[48:51]
    s_waitcnt lgkmcnt(6)
    v_mfma_f32_16x16x32_bf16 v[48:51], a[188:191], a[156:159], v[48:51]
    s_add_u32 m0, s39, 65152
    s_waitcnt lgkmcnt(5)
    v_mfma_f32_16x16x32_bf16 v[52:55], a[188:191], a[164:167], v[52:55]
    buffer_load_dwordx4 v1, s[4:7], s31 offen offset:384 lds
    s_waitcnt lgkmcnt(4)
    v_mfma_f32_16x16x32_bf16 v[52:55], a[184:187], a[160:163], v[52:55]
    s_waitcnt vmcnt(6) lgkmcnt(0)
    s_barrier
    v_mfma_f32_16x16x32_bf16 v[116:119], a[192:195], a[160:163], v[116:119]
    s_add_u32 m0, s32, 97792
    ds_read_b128 a[0:3], v5 offset:0
    v_mfma_f32_16x16x32_bf16 v[116:119], a[196:199], a[164:167], v[116:119]
    buffer_load_dwordx4 v1, s[4:7], s24 offen offset:512 lds
    ds_read_b64_tr_b16 a[64:65], v7 offset:0
    v_mfma_f32_16x16x32_bf16 v[112:115], a[196:199], a[156:159], v[112:115]
    s_add_u32 m0, s33, 97792
    v_mfma_f32_16x16x32_bf16 v[112:115], a[192:195], a[152:155], v[112:115]
    buffer_load_dwordx4 v1, s[4:7], s25 offen offset:512 lds
    ds_read_b64_tr_b16 a[66:67], v7 offset:1024
    v_mfma_f32_16x16x32_bf16 v[176:179], a[200:203], a[152:155], v[176:179]
    s_add_u32 m0, s48, 32768
    ds_read_b128 a[4:7], v6 offset:0
    v_mfma_f32_16x16x32_bf16 v[176:179], a[204:207], a[156:159], v[176:179]
    buffer_load_dwordx4 v2, s[8:11], s40 offen nt lds
    v_mfma_f32_16x16x32_bf16 v[180:183], a[204:207], a[164:167], v[180:183]
    s_mov_b32 s56, 0
    ds_read_b64_tr_b16 a[68:69], v7 offset:8192
    v_mfma_f32_16x16x32_bf16 v[180:183], a[200:203], a[160:163], v[180:183]
    buffer_load_dword v31, v27, s[96:99], s56 offen
    ds_read_b64_tr_b16 a[70:71], v7 offset:9216
    v_mfma_f32_16x16x32_bf16 v[84:87], a[208:211], a[160:163], v[84:87]
    v_mfma_f32_16x16x32_bf16 v[84:87], a[212:215], a[164:167], v[84:87]
    ds_read_b128 a[12:15], v6 offset:2048
    v_mfma_f32_16x16x32_bf16 v[80:83], a[212:215], a[156:159], v[80:83]
    ds_read_b128 a[8:11], v5 offset:2048
    v_mfma_f32_16x16x32_bf16 v[80:83], a[208:211], a[152:155], v[80:83]
    v_mfma_f32_16x16x32_bf16 v[144:147], a[216:219], a[152:155], v[144:147]
    ds_read_b64_tr_b16 a[72:73], v8 offset:0
    v_mfma_f32_16x16x32_bf16 v[144:147], a[220:223], a[156:159], v[144:147]
    ds_read_b64_tr_b16 a[74:75], v8 offset:1024
    v_mfma_f32_16x16x32_bf16 v[148:151], a[220:223], a[164:167], v[148:151]
    v_mfma_f32_16x16x32_bf16 v[148:151], a[216:219], a[160:163], v[148:151]
    s_add_u32 m0, s49, 32768
    ds_read_b64_tr_b16 a[76:77], v8 offset:8192
    v_mfma_f32_16x16x32_bf16 v[212:215], a[224:227], a[160:163], v[212:215]
    buffer_load_dwordx4 v2, s[8:11], s41 offen nt lds
    ds_read_b64_tr_b16 a[78:79], v8 offset:9216
    v_mfma_f32_16x16x32_bf16 v[212:215], a[228:231], a[164:167], v[212:215]
    v_mfma_f32_16x16x32_bf16 v[208:211], a[228:231], a[156:159], v[208:211]
    ds_read_b64_tr_b16 a[80:81], v9 offset:0
    v_mfma_f32_16x16x32_bf16 v[208:211], a[224:227], a[152:155], v[208:211]
    ds_read_b64_tr_b16 a[82:83], v9 offset:1024
    v_mfma_f32_16x16x32_bf16 v[240:243], a[232:235], a[152:155], v[240:243]
    v_mfma_f32_16x16x32_bf16 v[240:243], a[236:239], a[156:159], v[240:243]
    ds_read_b64_tr_b16 a[84:85], v9 offset:8192
    v_mfma_f32_16x16x32_bf16 v[244:247], a[236:239], a[164:167], v[244:247]
    ds_read_b64_tr_b16 a[86:87], v9 offset:9216
    v_mfma_f32_16x16x32_bf16 v[244:247], a[232:235], a[160:163], v[244:247]
    v_mfma_f32_16x16x32_bf16 v[56:59], a[184:187], a[168:171], v[56:59]
    ds_read_b64_tr_b16 a[88:89], v10 offset:0
    v_mfma_f32_16x16x32_bf16 v[56:59], a[188:191], a[172:175], v[56:59]
    s_add_u32 m0, s50, 32768
    ds_read_b64_tr_b16 a[90:91], v10 offset:1024
    v_mfma_f32_16x16x32_bf16 v[60:63], a[188:191], a[180:183], v[60:63]
    buffer_load_dwordx4 v2, s[8:11], s42 offen  lds
    v_mfma_f32_16x16x32_bf16 v[60:63], a[184:187], a[176:179], v[60:63]
    ds_read_b64_tr_b16 a[92:93], v10 offset:8192
    v_mfma_f32_16x16x32_bf16 v[124:127], a[192:195], a[176:179], v[124:127]
    ds_read_b64_tr_b16 a[94:95], v10 offset:9216
    v_mfma_f32_16x16x32_bf16 v[124:127], a[196:199], a[180:183], v[124:127]
    v_mfma_f32_16x16x32_bf16 v[120:123], a[196:199], a[172:175], v[120:123]
    ds_read_b64_tr_b16 a[96:97], v11 offset:0
    v_mfma_f32_16x16x32_bf16 v[120:123], a[192:195], a[168:171], v[120:123]
    ds_read_b64_tr_b16 a[98:99], v11 offset:1024
    v_mfma_f32_16x16x32_bf16 v[184:187], a[200:203], a[168:171], v[184:187]
    v_mfma_f32_16x16x32_bf16 v[184:187], a[204:207], a[172:175], v[184:187]
    ds_read_b64_tr_b16 a[100:101], v11 offset:8192
    v_mfma_f32_16x16x32_bf16 v[188:191], a[204:207], a[180:183], v[188:191]
    ds_read_b64_tr_b16 a[102:103], v11 offset:9216
    v_mfma_f32_16x16x32_bf16 v[188:191], a[200:203], a[176:179], v[188:191]
    s_add_u32 m0, s51, 32768
    v_mfma_f32_16x16x32_bf16 v[92:95], a[208:211], a[176:179], v[92:95]
    buffer_load_dwordx4 v2, s[8:11], s43 offen  lds
    ds_read_b64_tr_b16 a[104:105], v12 offset:0
    v_mfma_f32_16x16x32_bf16 v[92:95], a[212:215], a[180:183], v[92:95]
    ds_read_b64_tr_b16 a[106:107], v12 offset:1024
    v_mfma_f32_16x16x32_bf16 v[88:91], a[212:215], a[172:175], v[88:91]
    v_mfma_f32_16x16x32_bf16 v[88:91], a[208:211], a[168:171], v[88:91]
    ds_read_b64_tr_b16 a[108:109], v12 offset:8192
    v_mfma_f32_16x16x32_bf16 v[152:155], a[216:219], a[168:171], v[152:155]
    ds_read_b64_tr_b16 a[110:111], v12 offset:9216
    v_mfma_f32_16x16x32_bf16 v[152:155], a[220:223], a[172:175], v[152:155]
    v_mfma_f32_16x16x32_bf16 v[156:159], a[220:223], a[180:183], v[156:159]
    ds_read_b64_tr_b16 a[112:113], v13 offset:0
    v_mfma_f32_16x16x32_bf16 v[156:159], a[216:219], a[176:179], v[156:159]
    ds_read_b64_tr_b16 a[114:115], v13 offset:1024
    v_mfma_f32_16x16x32_bf16 v[220:223], a[224:227], a[176:179], v[220:223]
    s_add_u32 m0, s52, 32768
    v_mfma_f32_16x16x32_bf16 v[220:223], a[228:231], a[180:183], v[220:223]
    buffer_load_dwordx4 v2, s[8:11], s44 offen  lds
    ds_read_b64_tr_b16 a[116:117], v13 offset:8192
    v_mfma_f32_16x16x32_bf16 v[216:219], a[228:231], a[172:175], v[216:219]
    ds_read_b64_tr_b16 a[118:119], v13 offset:9216
    v_mfma_f32_16x16x32_bf16 v[216:219], a[224:227], a[168:171], v[216:219]
    v_mfma_f32_16x16x32_bf16 v[248:251], a[232:235], a[168:171], v[248:251]
    v_mfma_f32_16x16x32_bf16 v[248:251], a[236:239], a[172:175], v[248:251]
    v_mfma_f32_16x16x32_bf16 v[252:255], a[236:239], a[180:183], v[252:255]
    v_mfma_f32_16x16x32_bf16 v[252:255], a[232:235], a[176:179], v[252:255]
    s_waitcnt lgkmcnt(14)
    v_mfma_f32_16x16x32_bf16 v[32:35], a[64:67], a[0:3], v[32:35]
    v_mfma_f32_16x16x32_bf16 v[32:35], a[68:71], a[4:7], v[32:35]
    s_add_u32 m0, s53, 32768
    ds_read_b128 a[16:19], v5 offset:4096
    v_mfma_f32_16x16x32_bf16 v[36:39], a[68:71], a[12:15], v[36:39]
    buffer_load_dwordx4 v2, s[8:11], s45 offen  lds
    v_mfma_f32_16x16x32_bf16 v[36:39], a[64:67], a[8:11], v[36:39]
    ds_read_b128 a[20:23], v6 offset:4096
    v_mfma_f32_16x16x32_bf16 v[100:103], a[72:75], a[8:11], v[100:103]
    v_mfma_f32_16x16x32_bf16 v[100:103], a[76:79], a[12:15], v[100:103]
    ds_read_b128 a[28:31], v6 offset:6144
    v_mfma_f32_16x16x32_bf16 v[96:99], a[76:79], a[4:7], v[96:99]
    v_mfma_f32_16x16x32_bf16 v[96:99], a[72:75], a[0:3], v[96:99]
    ds_read_b128 a[24:27], v5 offset:6144
    v_mfma_f32_16x16x32_bf16 v[160:163], a[80:83], a[0:3], v[160:163]
    v_mfma_f32_16x16x32_bf16 v[160:163], a[84:87], a[4:7], v[160:163]
    ds_read_b128 a[32:35], v5 offset:8192
    v_mfma_f32_16x16x32_bf16 v[164:167], a[84:87], a[12:15], v[164:167]
    s_add_u32 m0, s54, 32768
    v_mfma_f32_16x16x32_bf16 v[164:167], a[80:83], a[8:11], v[164:167]
    buffer_load_dwordx4 v2, s[8:11], s46 offen  lds
    ds_read_b128 a[36:39], v6 offset:8192
    v_mfma_f32_16x16x32_bf16 v[68:71], a[88:91], a[8:11], v[68:71]
    s_waitcnt lgkmcnt(14)
    v_mfma_f32_16x16x32_bf16 v[68:71], a[92:95], a[12:15], v[68:71]
    ds_read_b128 a[44:47], v6 offset:10240
    v_mfma_f32_16x16x32_bf16 v[64:67], a[92:95], a[4:7], v[64:67]
    v_mfma_f32_16x16x32_bf16 v[64:67], a[88:91], a[0:3], v[64:67]
    ds_read_b128 a[40:43], v5 offset:10240
    v_mfma_f32_16x16x32_bf16 v[128:131], a[96:99], a[0:3], v[128:131]
    v_mfma_f32_16x16x32_bf16 v[128:131], a[100:103], a[4:7], v[128:131]
    ds_read_b128 a[48:51], v5 offset:12288
    v_mfma_f32_16x16x32_bf16 v[132:135], a[100:103], a[12:15], v[132:135]
    s_add_u32 m0, s55, 32768
    v_mfma_f32_16x16x32_bf16 v[132:135], a[96:99], a[8:11], v[132:135]
    buffer_load_dwordx4 v2, s[8:11], s47 offen  lds
    ds_read_b128 a[52:55], v6 offset:12288
    s_waitcnt lgkmcnt(14)
    v_mfma_f32_16x16x32_bf16 v[196:199], a[104:107], a[8:11], v[196:199]
    v_add_u32 v2, 458752, v2
    v_mfma_f32_16x16x32_bf16 v[196:199], a[108:111], a[12:15], v[196:199]
    ds_read_b128 a[60:63], v6 offset:14336
    v_mfma_f32_16x16x32_bf16 v[192:195], a[108:111], a[4:7], v[192:195]
    v_mfma_f32_16x16x32_bf16 v[192:195], a[104:107], a[0:3], v[192:195]
    ds_read_b128 a[56:59], v5 offset:14336
    s_waitcnt lgkmcnt(14)
    v_mfma_f32_16x16x32_bf16 v[224:227], a[112:115], a[0:3], v[224:227]
    s_waitcnt lgkmcnt(12)
    v_mfma_f32_16x16x32_bf16 v[224:227], a[116:119], a[4:7], v[224:227]
    v_mfma_f32_16x16x32_bf16 v[228:231], a[116:119], a[12:15], v[228:231]
    s_add_u32 m0, s34, 97792
    v_mfma_f32_16x16x32_bf16 v[228:231], a[112:115], a[8:11], v[228:231]
    buffer_load_dwordx4 v1, s[4:7], s26 offen offset:512 lds
    s_waitcnt lgkmcnt(11)
    v_mfma_f32_16x16x32_bf16 v[40:43], a[64:67], a[16:19], v[40:43]
    s_waitcnt lgkmcnt(10)
    v_mfma_f32_16x16x32_bf16 v[40:43], a[68:71], a[20:23], v[40:43]
    s_waitcnt lgkmcnt(9)
    v_mfma_f32_16x16x32_bf16 v[44:47], a[68:71], a[28:31], v[44:47]
    s_waitcnt lgkmcnt(8)
    v_mfma_f32_16x16x32_bf16 v[44:47], a[64:67], a[24:27], v[44:47]
    v_mfma_f32_16x16x32_bf16 v[108:111], a[72:75], a[24:27], v[108:111]
    v_mfma_f32_16x16x32_bf16 v[108:111], a[76:79], a[28:31], v[108:111]
    s_add_u32 m0, s35, 97792
    v_mfma_f32_16x16x32_bf16 v[104:107], a[76:79], a[20:23], v[104:107]
    buffer_load_dwordx4 v1, s[4:7], s27 offen offset:512 lds
    v_mfma_f32_16x16x32_bf16 v[104:107], a[72:75], a[16:19], v[104:107]
    v_mfma_f32_16x16x32_bf16 v[168:171], a[80:83], a[16:19], v[168:171]
    v_mfma_f32_16x16x32_bf16 v[168:171], a[84:87], a[20:23], v[168:171]
    v_mfma_f32_16x16x32_bf16 v[172:175], a[84:87], a[28:31], v[172:175]
    v_mfma_f32_16x16x32_bf16 v[172:175], a[80:83], a[24:27], v[172:175]
    v_mfma_f32_16x16x32_bf16 v[76:79], a[88:91], a[24:27], v[76:79]
    s_add_u32 m0, s36, 97792
    v_mfma_f32_16x16x32_bf16 v[76:79], a[92:95], a[28:31], v[76:79]
    buffer_load_dwordx4 v1, s[4:7], s28 offen offset:512 lds
    v_mfma_f32_16x16x32_bf16 v[72:75], a[92:95], a[20:23], v[72:75]
    v_mfma_f32_16x16x32_bf16 v[72:75], a[88:91], a[16:19], v[72:75]
    v_mfma_f32_16x16x32_bf16 v[136:139], a[96:99], a[16:19], v[136:139]
    v_mfma_f32_16x16x32_bf16 v[136:139], a[100:103], a[20:23], v[136:139]
    v_mfma_f32_16x16x32_bf16 v[140:143], a[100:103], a[28:31], v[140:143]
    s_add_u32 m0, s37, 97792
    v_mfma_f32_16x16x32_bf16 v[140:143], a[96:99], a[24:27], v[140:143]
    buffer_load_dwordx4 v1, s[4:7], s29 offen offset:512 lds
L_pad1:
    s_cbranch_execz L_pad5
    v_mfma_f32_16x16x32_bf16 v[204:207], a[104:107], a[24:27], v[204:207]
    v_mfma_f32_16x16x32_bf16 v[204:207], a[108:111], a[28:31], v[204:207]
    v_mfma_f32_16x16x32_bf16 v[200:203], a[108:111], a[20:23], v[200:203]
    v_mfma_f32_16x16x32_bf16 v[200:203], a[104:107], a[16:19], v[200:203]
    v_mfma_f32_16x16x32_bf16 v[232:235], a[112:115], a[16:19], v[232:235]
    s_add_u32 m0, s38, 97792
    v_mfma_f32_16x16x32_bf16 v[232:235], a[116:119], a[20:23], v[232:235]
    buffer_load_dwordx4 v1, s[4:7], s30 offen offset:512 lds
    v_mfma_f32_16x16x32_bf16 v[236:239], a[116:119], a[28:31], v[236:239]
    v_mfma_f32_16x16x32_bf16 v[236:239], a[112:115], a[24:27], v[236:239]
    s_waitcnt lgkmcnt(7)
    v_mfma_f32_16x16x32_bf16 v[48:51], a[64:67], a[32:35], v[48:51]
    s_waitcnt lgkmcnt(6)
    v_mfma_f32_16x16x32_bf16 v[48:51], a[68:71], a[36:39], v[48:51]
    s_add_u32 m0, s39, 97792
    s_waitcnt lgkmcnt(5)
    v_mfma_f32_16x16x32_bf16 v[52:55], a[68:71], a[44:47], v[52:55]
    buffer_load_dwordx4 v1, s[4:7], s31 offen offset:512 lds
    s_waitcnt lgkmcnt(4)
    v_mfma_f32_16x16x32_bf16 v[52:55], a[64:67], a[40:43], v[52:55]
    s_waitcnt vmcnt(6) lgkmcnt(0)
    s_barrier
    v_mfma_f32_16x16x32_bf16 v[116:119], a[72:75], a[40:43], v[116:119]
    s_add_u32 m0, s32, 130432
    ds_read_b128 a[120:123], v3 offset:0
    v_mfma_f32_16x16x32_bf16 v[116:119], a[76:79], a[44:47], v[116:119]
    buffer_load_dwordx4 v1, s[4:7], s24 offen offset:640 lds
    ds_read_b64_tr_b16 a[184:185], v7 offset:32768
    v_mfma_f32_16x16x32_bf16 v[112:115], a[76:79], a[36:39], v[112:115]
    s_add_u32 m0, s33, 130432
    v_mfma_f32_16x16x32_bf16 v[112:115], a[72:75], a[32:35], v[112:115]
    buffer_load_dwordx4 v1, s[4:7], s25 offen offset:640 lds
    ds_read_b64_tr_b16 a[186:187], v7 offset:33792
    v_mfma_f32_16x16x32_bf16 v[176:179], a[80:83], a[32:35], v[176:179]
    s_add_u32 m0, s48, 0
    ds_read_b128 a[124:127], v4 offset:0
    v_mfma_f32_16x16x32_bf16 v[176:179], a[84:87], a[36:39], v[176:179]
    buffer_load_dwordx4 v2, s[8:11], s40 offen nt lds
    v_mfma_f32_16x16x32_bf16 v[180:183], a[84:87], a[44:47], v[180:183]
    s_mov_b32 s56, 1048576
    ds_read_b64_tr_b16 a[188:189], v7 offset:40960
    v_mfma_f32_16x16x32_bf16 v[180:183], a[80:83], a[40:43], v[180:183]
    buffer_load_dword v31, v27, s[96:99], s56 offen
    ds_read_b64_tr_b16 a[190:191], v7 offset:41984
    v_mfma_f32_16x16x32_bf16 v[84:87], a[88:91], a[40:43], v[84:87]
    v_mfma_f32_16x16x32_bf16 v[84:87], a[92:95], a[44:47], v[84:87]
    ds_read_b128 a[132:135], v4 offset:2048
    v_mfma_f32_16x16x32_bf16 v[80:83], a[92:95], a[36:39], v[80:83]
    ds_read_b128 a[128:131], v3 offset:2048
    v_mfma_f32_16x16x32_bf16 v[80:83], a[88:91], a[32:35], v[80:83]
    v_mfma_f32_16x16x32_bf16 v[144:147], a[96:99], a[32:35], v[144:147]
    ds_read_b64_tr_b16 a[192:193], v8 offset:32768
    v_mfma_f32_16x16x32_bf16 v[144:147], a[100:103], a[36:39], v[144:147]
    ds_read_b64_tr_b16 a[194:195], v8 offset:33792
    v_mfma_f32_16x16x32_bf16 v[148:151], a[100:103], a[44:47], v[148:151]
    v_mfma_f32_16x16x32_bf16 v[148:151], a[96:99], a[40:43], v[148:151]
    s_add_u32 m0, s49, 0
    ds_read_b64_tr_b16 a[196:197], v8 offset:40960
    v_mfma_f32_16x16x32_bf16 v[212:215], a[104:107], a[40:43], v[212:215]
    buffer_load_dwordx4 v2, s[8:11], s41 offen nt lds
    ds_read_b64_tr_b16 a[198:199], v8 offset:41984
    v_mfma_f32_16x16x32_bf16 v[212:215], a[108:111], a[44:47], v[212:215]
    v_mfma_f32_16x16x32_bf16 v[208:211], a[108:111], a[36:39], v[208:211]
    ds_read_b64_tr_b16 a[200:201], v9 offset:32768
    v_mfma_f32_16x16x32_bf16 v[208:211], a[104:107], a[32:35], v[208:211]
    ds_read_b64_tr_b16 a[202:203], v9 offset:33792
    v_mfma_f32_16x16x32_bf16 v[240:243], a[112:115], a[32:35], v[240:243]
    v_mfma_f32_16x16x32_bf16 v[240:243], a[116:119], a[36:39], v[240:243]
    ds_read_b64_tr_b16 a[204:205], v9 offset:40960
    v_mfma_f32_16x16x32_bf16 v[244:247], a[116:119], a[44:47], v[244:247]
    ds_read_b64_tr_b16 a[206:207], v9 offset:41984
    v_mfma_f32_16x16x32_bf16 v[244:247], a[112:115], a[40:43], v[244:247]
    v_mfma_f32_16x16x32_bf16 v[56:59], a[64:67], a[48:51], v[56:59]
    ds_read_b64_tr_b16 a[208:209], v10 offset:32768
    v_mfma_f32_16x16x32_bf16 v[56:59], a[68:71], a[52:55], v[56:59]
    s_add_u32 m0, s50, 0
    ds_read_b64_tr_b16 a[210:211], v10 offset:33792
    v_mfma_f32_16x16x32_bf16 v[60:63], a[68:71], a[60:63], v[60:63]
    buffer_load_dwordx4 v2, s[8:11], s42 offen  lds
    v_mfma_f32_16x16x32_bf16 v[60:63], a[64:67], a[56:59], v[60:63]
    ds_read_b64_tr_b16 a[212:213], v10 offset:40960
    v_mfma_f32_16x16x32_bf16 v[124:127], a[72:75], a[56:59], v[124:127]
    ds_read_b64_tr_b16 a[214:215], v10 offset:41984
    v_mfma_f32_16x16x32_bf16 v[124:127], a[76:79], a[60:63], v[124:127]
    v_mfma_f32_16x16x32_bf16 v[120:123], a[76:79], a[52:55], v[120:123]
    ds_read_b64_tr_b16 a[216:217], v11 offset:32768
    v_mfma_f32_16x16x32_bf16 v[120:123], a[72:75], a[48:51], v[120:123]
    ds_read_b64_tr_b16 a[218:219], v11 offset:33792
    v_mfma_f32_16x16x32_bf16 v[184:187], a[80:83], a[48:51], v[184:187]
    v_mfma_f32_16x16x32_bf16 v[184:187], a[84:87], a[52:55], v[184:187]
    ds_read_b64_tr_b16 a[220:221], v11 offset:40960
    v_mfma_f32_16x16x32_bf16 v[188:191], a[84:87], a[60:63], v[188:191]
    ds_read_b64_tr_b16 a[222:223], v11 offset:41984
    v_mfma_f32_16x16x32_bf16 v[188:191], a[80:83], a[56:59], v[188:191]
    s_add_u32 m0, s51, 0
    v_mfma_f32_16x16x32_bf16 v[92:95], a[88:91], a[56:59], v[92:95]
    buffer_load_dwordx4 v2, s[8:11], s43 offen  lds
    ds_read_b64_tr_b16 a[224:225], v12 offset:32768
    v_mfma_f32_16x16x32_bf16 v[92:95], a[92:95], a[60:63], v[92:95]
    ds_read_b64_tr_b16 a[226:227], v12 offset:33792
    v_mfma_f32_16x16x32_bf16 v[88:91], a[92:95], a[52:55], v[88:91]
    v_mfma_f32_16x16x32_bf16 v[88:91], a[88:91], a[48:51], v[88:91]
    ds_read_b64_tr_b16 a[228:229], v12 offset:40960
    v_mfma_f32_16x16x32_bf16 v[152:155], a[96:99], a[48:51], v[152:155]
    ds_read_b64_tr_b16 a[230:231], v12 offset:41984
    v_mfma_f32_16x16x32_bf16 v[152:155], a[100:103], a[52:55], v[152:155]
    v_mfma_f32_16x16x32_bf16 v[156:159], a[100:103], a[60:63], v[156:159]
    ds_read_b64_tr_b16 a[232:233], v13 offset:32768
    v_mfma_f32_16x16x32_bf16 v[156:159], a[96:99], a[56:59], v[156:159]
    ds_read_b64_tr_b16 a[234:235], v13 offset:33792
    v_mfma_f32_16x16x32_bf16 v[220:223], a[104:107], a[56:59], v[220:223]
    s_add_u32 m0, s52, 0
    v_mfma_f32_16x16x32_bf16 v[220:223], a[108:111], a[60:63], v[220:223]
    buffer_load_dwordx4 v2, s[8:11], s44 offen  lds
    ds_read_b64_tr_b16 a[236:237], v13 offset:40960
    v_mfma_f32_16x16x32_bf16 v[216:219], a[108:111], a[52:55], v[216:219]
    ds_read_b64_tr_b16 a[238:239], v13 offset:41984
    v_mfma_f32_16x16x32_bf16 v[216:219], a[104:107], a[48:51], v[216:219]
    v_mfma_f32_16x16x32_bf16 v[248:251], a[112:115], a[48:51], v[248:251]
    v_mfma_f32_16x16x32_bf16 v[248:251], a[116:119], a[52:55], v[248:251]
    v_mfma_f32_16x16x32_bf16 v[252:255], a[116:119], a[60:63], v[252:255]
    v_mfma_f32_16x16x32_bf16 v[252:255], a[112:115], a[56:59], v[252:255]
    s_waitcnt lgkmcnt(14)
    v_mfma_f32_16x16x32_bf16 v[32:35], a[184:187], a[120:123], v[32:35]
    v_mfma_f32_16x16x32_bf16 v[32:35], a[188:191], a[124:127], v[32:35]
    s_add_u32 m0, s53, 0
    ds_read_b128 a[136:139], v3 offset:4096
    v_mfma_f32_16x16x32_bf16 v[36:39], a[188:191], a[132:135], v[36:39]
    buffer_load_dwordx4 v2, s[8:11], s45 offen  lds
    v_mfma_f32_16x16x32_bf16 v[36:39], a[184:187], a[128:131], v[36:39]
    ds_read_b128 a[140:143], v4 offset:4096
    v_mfma_f32_16x16x32_bf16 v[100:103], a[192:195], a[128:131], v[100:103]
    v_mfma_f32_16x16x32_bf16 v[100:103], a[196:199], a[132:135], v[100:103]
    ds_read_b128 a[148:151], v4 offset:6144
    v_mfma_f32_16x16x32_bf16 v[96:99], a[196:199], a[124:127], v[96:99]
    v_mfma_f32_16x16x32_bf16 v[96:99], a[192:195], a[120:123], v[96:99]
    ds_read_b128 a[144:147], v3 offset:6144
    v_mfma_f32_16x16x32_bf16 v[160:163], a[200:203], a[120:123], v[160:163]
    v_mfma_f32_16x16x32_bf16 v[160:163], a[204:207], a[124:127], v[160:163]
    ds_read_b128 a[152:155], v3 offset:8192
    v_mfma_f32_16x16x32_bf16 v[164:167], a[204:207], a[132:135], v[164:167]
    s_add_u32 m0, s54, 0
    v_mfma_f32_16x16x32_bf16 v[164:167], a[200:203], a[128:131], v[164:167]
    buffer_load_dwordx4 v2, s[8:11], s46 offen  lds
    ds_read_b128 a[156:159], v4 offset:8192
    v_mfma_f32_16x16x32_bf16 v[68:71], a[208:211], a[128:131], v[68:71]
    s_waitcnt lgkmcnt(14)
    v_mfma_f32_16x16x32_bf16 v[68:71], a[212:215], a[132:135], v[68:71]
    ds_read_b128 a[164:167], v4 offset:10240
    v_mfma_f32_16x16x32_bf16 v[64:67], a[212:215], a[124:127], v[64:67]
    v_mfma_f32_16x16x32_bf16 v[64:67], a[208:211], a[120:123], v[64:67]
    ds_read_b128 a[160:163], v3 offset:10240
    v_mfma_f32_16x16x32_bf16 v[128:131], a[216:219], a[120:123], v[128:131]
    v_mfma_f32_16x16x32_bf16 v[128:131], a[220:223], a[124:127], v[128:131]
    ds_read_b128 a[168:171], v3 offset:12288
    v_mfma_f32_16x16x32_bf16 v[132:135], a[220:223], a[132:135], v[132:135]
    s_add_u32 m0, s55, 0
    v_mfma_f32_16x16x32_bf16 v[132:135], a[216:219], a[128:131], v[132:135]
    buffer_load_dwordx4 v2, s[8:11], s47 offen  lds
    ds_read_b128 a[172:175], v4 offset:12288
    s_waitcnt lgkmcnt(14)
    v_mfma_f32_16x16x32_bf16 v[196:199], a[224:227], a[128:131], v[196:199]
    v_add_u32 v2, 458752, v2
    v_mfma_f32_16x16x32_bf16 v[196:199], a[228:231], a[132:135], v[196:199]
    ds_read_b128 a[180:183], v4 offset:14336
    v_mfma_f32_16x16x32_bf16 v[192:195], a[228:231], a[124:127], v[192:195]
    v_mfma_f32_16x16x32_bf16 v[192:195], a[224:227], a[120:123], v[192:195]
    ds_read_b128 a[176:179], v3 offset:14336
    s_waitcnt lgkmcnt(14)
    v_mfma_f32_16x16x32_bf16 v[224:227], a[232:235], a[120:123], v[224:227]
    s_waitcnt lgkmcnt(12)
    v_mfma_f32_16x16x32_bf16 v[224:227], a[236:239], a[124:127], v[224:227]
    v_mfma_f32_16x16x32_bf16 v[228:231], a[236:239], a[132:135], v[228:231]
    s_add_u32 m0, s34, 130432
    v_mfma_f32_16x16x32_bf16 v[228:231], a[232:235], a[128:131], v[228:231]
    buffer_load_dwordx4 v1, s[4:7], s26 offen offset:640 lds
    s_waitcnt lgkmcnt(11)
    v_mfma_f32_16x16x32_bf16 v[40:43], a[184:187], a[136:139], v[40:43]
    s_waitcnt lgkmcnt(10)
    v_mfma_f32_16x16x32_bf16 v[40:43], a[188:191], a[140:143], v[40:43]
    s_waitcnt lgkmcnt(9)
    v_mfma_f32_16x16x32_bf16 v[44:47], a[188:191], a[148:151], v[44:47]
    s_waitcnt lgkmcnt(8)
    v_mfma_f32_16x16x32_bf16 v[44:47], a[184:187], a[144:147], v[44:47]
    v_mfma_f32_16x16x32_bf16 v[108:111], a[192:195], a[144:147], v[108:111]
    v_mfma_f32_16x16x32_bf16 v[108:111], a[196:199], a[148:151], v[108:111]
    s_add_u32 m0, s35, 130432
    v_mfma_f32_16x16x32_bf16 v[104:107], a[196:199], a[140:143], v[104:107]
    buffer_load_dwordx4 v1, s[4:7], s27 offen offset:640 lds
    v_mfma_f32_16x16x32_bf16 v[104:107], a[192:195], a[136:139], v[104:107]
    v_mfma_f32_16x16x32_bf16 v[168:171], a[200:203], a[136:139], v[168:171]
    v_mfma_f32_16x16x32_bf16 v[168:171], a[204:207], a[140:143], v[168:171]
    v_mfma_f32_16x16x32_bf16 v[172:175], a[204:207], a[148:151], v[172:175]
    v_mfma_f32_16x16x32_bf16 v[172:175], a[200:203], a[144:147], v[172:175]
    v_mfma_f32_16x16x32_bf16 v[76:79], a[208:211], a[144:147], v[76:79]
    s_add_u32 m0, s36, 130432
    v_mfma_f32_16x16x32_bf16 v[76:79], a[212:215], a[148:151], v[76:79]
    buffer_load_dwordx4 v1, s[4:7], s28 offen offset:640 lds
    v_mfma_f32_16x16x32_bf16 v[72:75], a[212:215], a[140:143], v[72:75]
    v_mfma_f32_16x16x32_bf16 v[72:75], a[208:211], a[136:139], v[72:75]
    v_mfma_f32_16x16x32_bf16 v[136:139], a[216:219], a[136:139], v[136:139]
    v_mfma_f32_16x16x32_bf16 v[136:139], a[220:223], a[140:143], v[136:139]
    v_mfma_f32_16x16x32_bf16 v[140:143], a[220:223], a[148:151], v[140:143]
    s_add_u32 m0, s37, 130432
    v_mfma_f32_16x16x32_bf16 v[140:143], a[216:219], a[144:147], v[140:143]
    buffer_load_dwordx4 v1, s[4:7], s29 offen offset:640 lds
    v_mfma_f32_16x16x32_bf16 v[204:207], a[224:227], a[144:147], v[204:207]
    v_mfma_f32_16x16x32_bf16 v[204:207], a[228:231], a[148:151], v[204:207]
    v_mfma_f32_16x16x32_bf16 v[200:203], a[228:231], a[140:143], v[200:203]
    v_mfma_f32_16x16x32_bf16 v[200:203], a[224:227], a[136:139], v[200:203]
    v_mfma_f32_16x16x32_bf16 v[232:235], a[232:235], a[136:139], v[232:235]
    s_add_u32 m0, s38, 130432
    v_mfma_f32_16x16x32_bf16 v[232:235], a[236:239], a[140:143], v[232:235]
    buffer_load_dwordx4 v1, s[4:7], s30 offen offset:640 lds
    v_mfma_f32_16x16x32_bf16 v[236:239], a[236:239], a[148:151], v[236:239]
    v_mfma_f32_16x16x32_bf16 v[236:239], a[232:235], a[144:147], v[236:239]
    s_waitcnt lgkmcnt(7)
    v_mfma_f32_16x16x32_bf16 v[48:51], a[184:187], a[152:155], v[48:51]
    s_waitcnt lgkmcnt(6)
    v_mfma_f32_16x16x32_bf16 v[48:51], a[188:191], a[156:159], v[48:51]
    s_add_u32 m0, s39, 130432
    s_waitcnt lgkmcnt(5)
    v_mfma_f32_16x16x32_bf16 v[52:55], a[188:191], a[164:167], v[52:55]
    buffer_load_dwordx4 v1, s[4:7], s31 offen offset:640 lds
    s_waitcnt lgkmcnt(4)
    v_mfma_f32_16x16x32_bf16 v[52:55], a[184:187], a[160:163], v[52:55]
    s_waitcnt vmcnt(6) lgkmcnt(0)
    s_barrier
    v_mfma_f32_16x16x32_bf16 v[116:119], a[192:195], a[160:163], v[116:119]
    s_add_u32 m0, s32, 64768
    ds_read_b128 a[0:3], v3 offset:32768
    v_mfma_f32_16x16x32_bf16 v[116:119], a[196:199], a[164:167], v[116:119]
    buffer_load_dwordx4 v1, s[4:7], s24 offen offset:768 lds
    ds_read_b64_tr_b16 a[64:65], v7 offset:0
    v_mfma_f32_16x16x32_bf16 v[112:115], a[196:199], a[156:159], v[112:115]
    s_add_u32 m0, s33, 64768
    v_mfma_f32_16x16x32_bf16 v[112:115], a[192:195], a[152:155], v[112:115]
    buffer_load_dwordx4 v1, s[4:7], s25 offen offset:768 lds
    ds_read_b64_tr_b16 a[66:67], v7 offset:1024
    v_mfma_f32_16x16x32_bf16 v[176:179], a[200:203], a[152:155], v[176:179]
    s_add_u32 m0, s48, 32768
    ds_read_b128 a[4:7], v4 offset:32768
    v_mfma_f32_16x16x32_bf16 v[176:179], a[204:207], a[156:159], v[176:179]
    buffer_load_dwordx4 v2, s[8:11], s40 offen nt lds
    v_mfma_f32_16x16x32_bf16 v[180:183], a[204:207], a[164:167], v[180:183]
    s_mov_b32 s56, 2097152
    ds_read_b64_tr_b16 a[68:69], v7 offset:8192
    v_mfma_f32_16x16x32_bf16 v[180:183], a[200:203], a[160:163], v[180:183]
    buffer_load_dword v31, v27, s[96:99], s56 offen
    ds_read_b64_tr_b16 a[70:71], v7 offset:9216
    v_mfma_f32_16x16x32_bf16 v[84:87], a[208:211], a[160:163], v[84:87]
    v_mfma_f32_16x16x32_bf16 v[84:87], a[212:215], a[164:167], v[84:87]
    ds_read_b128 a[12:15], v4 offset:34816
    v_mfma_f32_16x16x32_bf16 v[80:83], a[212:215], a[156:159], v[80:83]
    ds_read_b128 a[8:11], v3 offset:34816
    v_mfma_f32_16x16x32_bf16 v[80:83], a[208:211], a[152:155], v[80:83]
    v_mfma_f32_16x16x32_bf16 v[144:147], a[216:219], a[152:155], v[144:147]
    ds_read_b64_tr_b16 a[72:73], v8 offset:0
    v_mfma_f32_16x16x32_bf16 v[144:147], a[220:223], a[156:159], v[144:147]
    ds_read_b64_tr_b16 a[74:75], v8 offset:1024
    v_mfma_f32_16x16x32_bf16 v[148:151], a[220:223], a[164:167], v[148:151]
    v_mfma_f32_16x16x32_bf16 v[148:151], a[216:219], a[160:163], v[148:151]
    s_add_u32 m0, s49, 32768
    ds_read_b64_tr_b16 a[76:77], v8 offset:8192
    v_mfma_f32_16x16x32_bf16 v[212:215], a[224:227], a[160:163], v[212:215]
    buffer_load_dwordx4 v2, s[8:11], s41 offen nt lds
    ds_read_b64_tr_b16 a[78:79], v8 offset:9216
    v_mfma_f32_16x16x32_bf16 v[212:215], a[228:231], a[164:167], v[212:215]
    v_mfma_f32_16x16x32_bf16 v[208:211], a[228:231], a[156:159], v[208:211]
    ds_read_b64_tr_b16 a[80:81], v9 offset:0
    v_mfma_f32_16x16x32_bf16 v[208:211], a[224:227], a[152:155], v[208:211]
    ds_read_b64_tr_b16 a[82:83], v9 offset:1024
    v_mfma_f32_16x16x32_bf16 v[240:243], a[232:235], a[152:155], v[240:243]
    v_mfma_f32_16x16x32_bf16 v[240:243], a[236:239], a[156:159], v[240:243]
    ds_read_b64_tr_b16 a[84:85], v9 offset:8192
    v_mfma_f32_16x16x32_bf16 v[244:247], a[236:239], a[164:167], v[244:247]
    ds_read_b64_tr_b16 a[86:87], v9 offset:9216
    v_mfma_f32_16x16x32_bf16 v[244:247], a[232:235], a[160:163], v[244:247]
    v_mfma_f32_16x16x32_bf16 v[56:59], a[184:187], a[168:171], v[56:59]
    ds_read_b64_tr_b16 a[88:89], v10 offset:0
    v_mfma_f32_16x16x32_bf16 v[56:59], a[188:191], a[172:175], v[56:59]
    s_add_u32 m0, s50, 32768
    ds_read_b64_tr_b16 a[90:91], v10 offset:1024
    v_mfma_f32_16x16x32_bf16 v[60:63], a[188:191], a[180:183], v[60:63]
    buffer_load_dwordx4 v2, s[8:11], s42 offen  lds
    v_mfma_f32_16x16x32_bf16 v[60:63], a[184:187], a[176:179], v[60:63]
    ds_read_b64_tr_b16 a[92:93], v10 offset:8192
    v_mfma_f32_16x16x32_bf16 v[124:127], a[192:195], a[176:179], v[124:127]
    ds_read_b64_tr_b16 a[94:95], v10 offset:9216
    v_mfma_f32_16x16x32_bf16 v[124:127], a[196:199], a[180:183], v[124:127]
    v_mfma_f32_16x16x32_bf16 v[120:123], a[196:199], a[172:175], v[120:123]
    ds_read_b64_tr_b16 a[96:97], v11 offset:0
    v_mfma_f32_16x16x32_bf16 v[120:123], a[192:195], a[168:171], v[120:123]
    ds_read_b64_tr_b16 a[98:99], v11 offset:1024
    v_mfma_f32_16x16x32_bf16 v[184:187], a[200:203], a[168:171], v[184:187]
    v_mfma_f32_16x16x32_bf16 v[184:187], a[204:207], a[172:175], v[184:187]
    ds_read_b64_tr_b16 a[100:101], v11 offset:8192
    v_mfma_f32_16x16x32_bf16 v[188:191], a[204:207], a[180:183], v[188:191]
    ds_read_b64_tr_b16 a[102:103], v11 offset:9216
    v_mfma_f32_16x16x32_bf16 v[188:191], a[200:203], a[176:179], v[188:191]
    s_add_u32 m0, s51, 32768
    v_mfma_f32_16x16x32_bf16 v[92:95], a[208:211], a[176:179], v[92:95]
    buffer_load_dwordx4 v2, s[8:11], s43 offen  lds
    ds_read_b64_tr_b16 a[104:105], v12 offset:0
    v_mfma_f32_16x16x32_bf16 v[92:95], a[212:215], a[180:183], v[92:95]
    ds_read_b64_tr_b16 a[106:107], v12 offset:1024
    v_mfma_f32_16x16x32_bf16 v[88:91], a[212:215], a[172:175], v[88:91]
    v_mfma_f32_16x16x32_bf16 v[88:91], a[208:211], a[168:171], v[88:91]
    ds_read_b64_tr_b16 a[108:109], v12 offset:8192
    v_mfma_f32_16x16x32_bf16 v[152:155], a[216:219], a[168:171], v[152:155]
    ds_read_b64_tr_b16 a[110:111], v12 offset:9216
    v_mfma_f32_16x16x32_bf16 v[152:155], a[220:223], a[172:175], v[152:155]
    v_mfma_f32_16x16x32_bf16 v[156:159], a[220:223], a[180:183], v[156:159]
    ds_read_b64_tr_b16 a[112:113], v13 offset:0
    v_mfma_f32_16x16x32_bf16 v[156:159], a[216:219], a[176:179], v[156:159]
    ds_read_b64_tr_b16 a[114:115], v13 offset:1024
    v_mfma_f32_16x16x32_bf16 v[220:223], a[224:227], a[176:179], v[220:223]
    s_add_u32 m0, s52, 32768
    v_mfma_f32_16x16x32_bf16 v[220:223], a[228:231], a[180:183], v[220:223]
    buffer_load_dwordx4 v2, s[8:11], s44 offen  lds
    ds_read_b64_tr_b16 a[116:117], v13 offset:8192
    v_mfma_f32_16x16x32_bf16 v[216:219], a[228:231], a[172:175], v[216:219]
    ds_read_b64_tr_b16 a[118:119], v13 offset:9216
    v_mfma_f32_16x16x32_bf16 v[216:219], a[224:227], a[168:171], v[216:219]
    v_mfma_f32_16x16x32_bf16 v[248:251], a[232:235], a[168:171], v[248:251]
    v_mfma_f32_16x16x32_bf16 v[248:251], a[236:239], a[172:175], v[248:251]
    v_mfma_f32_16x16x32_bf16 v[252:255], a[236:239], a[180:183], v[252:255]
    v_mfma_f32_16x16x32_bf16 v[252:255], a[232:235], a[176:179], v[252:255]
    s_waitcnt lgkmcnt(14)
    v_mfma_f32_16x16x32_bf16 v[32:35], a[64:67], a[0:3], v[32:35]
    v_mfma_f32_16x16x32_bf16 v[32:35], a[68:71], a[4:7], v[32:35]
    s_add_u32 m0, s53, 32768
    ds_read_b128 a[16:19], v3 offset:36864
    v_mfma_f32_16x16x32_bf16 v[36:39], a[68:71], a[12:15], v[36:39]
    buffer_load_dwordx4 v2, s[8:11], s45 offen  lds
    v_mfma_f32_16x16x32_bf16 v[36:39], a[64:67], a[8:11], v[36:39]
    ds_read_b128 a[20:23], v4 offset:36864
    v_mfma_f32_16x16x32_bf16 v[100:103], a[72:75], a[8:11], v[100:103]
    v_mfma_f32_16x16x32_bf16 v[100:103], a[76:79], a[12:15], v[100:103]
    ds_read_b128 a[28:31], v4 offset:38912
    v_mfma_f32_16x16x32_bf16 v[96:99], a[76:79], a[4:7], v[96:99]
    v_mfma_f32_16x16x32_bf16 v[96:99], a[72:75], a[0:3], v[96:99]
    ds_read_b128 a[24:27], v3 offset:38912
    v_mfma_f32_16x16x32_bf16 v[160:163], a[80:83], a[0:3], v[160:163]
    v_mfma_f32_16x16x32_bf16 v[160:163], a[84:87], a[4:7], v[160:163]
    ds_read_b128 a[32:35], v3 offset:40960
    v_mfma_f32_16x16x32_bf16 v[164:167], a[84:87], a[12:15], v[164:167]
    s_add_u32 m0, s54, 32768
    v_mfma_f32_16x16x32_bf16 v[164:167], a[80:83], a[8:11], v[164:167]
    buffer_load_dwordx4 v2, s[8:11], s46 offen  lds
    ds_read_b128 a[36:39], v4 offset:40960
    v_mfma_f32_16x16x32_bf16 v[68:71], a[88:91], a[8:11], v[68:71]
    s_waitcnt lgkmcnt(14)
    v_mfma_f32_16x16x32_bf16 v[68:71], a[92:95], a[12:15], v[68:71]
    ds_read_b128 a[44:47], v4 offset:43008
    v_mfma_f32_16x16x32_bf16 v[64:67], a[92:95], a[4:7], v[64:67]
    v_mfma_f32_16x16x32_bf16 v[64:67], a[88:91], a[0:3], v[64:67]
    ds_read_b128 a[40:43], v3 offset:43008
    v_mfma_f32_16x16x32_bf16 v[128:131], a[96:99], a[0:3], v[128:131]
    v_mfma_f32_16x16x32_bf16 v[128:131], a[100:103], a[4:7], v[128:131]
    ds_read_b128 a[48:51], v3 offset:45056
    v_mfma_f32_16x16x32_bf16 v[132:135], a[100:103], a[12:15], v[132:135]
    s_add_u32 m0, s55, 32768
    v_mfma_f32_16x16x32_bf16 v[132:135], a[96:99], a[8:11], v[132:135]
    buffer_load_dwordx4 v2, s[8:11], s47 offen  lds
    ds_read_b128 a[52:55], v4 offset:45056
    s_waitcnt lgkmcnt(14)
    v_mfma_f32_16x16x32_bf16 v[196:199], a[104:107], a[8:11], v[196:199]
    v_add_u32 v2, 458752, v2
    v_mfma_f32_16x16x32_bf16 v[196:199], a[108:111], a[12:15], v[196:199]
    ds_read_b128 a[60:63], v4 offset:47104
    v_mfma_f32_16x16x32_bf16 v[192:195], a[108:111], a[4:7], v[192:195]
    v_mfma_f32_16x16x32_bf16 v[192:195], a[104:107], a[0:3], v[192:195]
    ds_read_b128 a[56:59], v3 offset:47104
    s_waitcnt lgkmcnt(14)
    v_mfma_f32_16x16x32_bf16 v[224:227], a[112:115], a[0:3], v[224:227]
    s_waitcnt lgkmcnt(12)
    v_mfma_f32_16x16x32_bf16 v[224:227], a[116:119], a[4:7], v[224:227]
    v_mfma_f32_16x16x32_bf16 v[228:231], a[116:119], a[12:15], v[228:231]
    s_add_u32 m0, s34, 64768
    v_mfma_f32_16x16x32_bf16 v[228:231], a[112:115], a[8:11], v[228:231]
    buffer_load_dwordx4 v1, s[4:7], s26 offen offset:768 lds
    s_waitcnt lgkmcnt(11)
    v_mfma_f32_16x16x32_bf16 v[40:43], a[64:67], a[16:19], v[40:43]
    s_waitcnt lgkmcnt(10)
    v_mfma_f32_16x16x32_bf16 v[40:43], a[68:71], a[20:23], v[40:43]
    s_waitcnt lgkmcnt(9)
    v_mfma_f32_16x16x32_bf16 v[44:47], a[68:71], a[28:31], v[44:47]
    s_waitcnt lgkmcnt(8)
    v_mfma_f32_16x16x32_bf16 v[44:47], a[64:67], a[24:27], v[44:47]
    v_mfma_f32_16x16x32_bf16 v[108:111], a[72:75], a[24:27], v[108:111]
    v_mfma_f32_16x16x32_bf16 v[108:111], a[76:79], a[28:31], v[108:111]
    s_add_u32 m0, s35, 64768
    v_mfma_f32_16x16x32_bf16 v[104:107], a[76:79], a[20:23], v[104:107]
    buffer_load_dwordx4 v1, s[4:7], s27 offen offset:768 lds
    v_mfma_f32_16x16x32_bf16 v[104:107], a[72:75], a[16:19], v[104:107]
    v_mfma_f32_16x16x32_bf16 v[168:171], a[80:83], a[16:19], v[168:171]
    v_mfma_f32_16x16x32_bf16 v[168:171], a[84:87], a[20:23], v[168:171]
    v_mfma_f32_16x16x32_bf16 v[172:175], a[84:87], a[28:31], v[172:175]
    v_mfma_f32_16x16x32_bf16 v[172:175], a[80:83], a[24:27], v[172:175]
    v_mfma_f32_16x16x32_bf16 v[76:79], a[88:91], a[24:27], v[76:79]
    s_add_u32 m0, s36, 64768
    v_mfma_f32_16x16x32_bf16 v[76:79], a[92:95], a[28:31], v[76:79]
    buffer_load_dwordx4 v1, s[4:7], s28 offen offset:768 lds
    v_mfma_f32_16x16x32_bf16 v[72:75], a[92:95], a[20:23], v[72:75]
    v_mfma_f32_16x16x32_bf16 v[72:75], a[88:91], a[16:19], v[72:75]
    v_mfma_f32_16x16x32_bf16 v[136:139], a[96:99], a[16:19], v[136:139]
    v_mfma_f32_16x16x32_bf16 v[136:139], a[100:103], a[20:23], v[136:139]
    v_mfma_f32_16x16x32_bf16 v[140:143], a[100:103], a[28:31], v[140:143]
    s_add_u32 m0, s37, 64768
    v_mfma_f32_16x16x32_bf16 v[140:143], a[96:99], a[24:27], v[140:143]
    buffer_load_dwordx4 v1, s[4:7], s29 offen offset:768 lds
    v_mfma_f32_16x16x32_bf16 v[204:207], a[104:107], a[24:27], v[204:207]
    v_mfma_f32_16x16x32_bf16 v[204:207], a[108:111], a[28:31], v[204:207]
    v_mfma_f32_16x16x32_bf16 v[200:203], a[108:111], a[20:23], v[200:203]
    v_mfma_f32_16x16x32_bf16 v[200:203], a[104:107], a[16:19], v[200:203]
    v_mfma_f32_16x16x32_bf16 v[232:235], a[112:115], a[16:19], v[232:235]
    s_add_u32 m0, s38, 64768
    v_mfma_f32_16x16x32_bf16 v[232:235], a[116:119], a[20:23], v[232:235]
    buffer_load_dwordx4 v1, s[4:7], s30 offen offset:768 lds
    v_mfma_f32_16x16x32_bf16 v[236:239], a[116:119], a[28:31], v[236:239]
    v_mfma_f32_16x16x32_bf16 v[236:239], a[112:115], a[24:27], v[236:239]
    s_waitcnt lgkmcnt(7)
    v_mfma_f32_16x16x32_bf16 v[48:51], a[64:67], a[32:35], v[48:51]
    s_waitcnt lgkmcnt(6)
    v_mfma_f32_16x16x32_bf16 v[48:51], a[68:71], a[36:39], v[48:51]
    s_add_u32 m0, s39, 64768
    s_waitcnt lgkmcnt(5)
    v_mfma_f32_16x16x32_bf16 v[52:55], a[68:71], a[44:47], v[52:55]
    buffer_load_dwordx4 v1, s[4:7], s31 offen offset:768 lds
    s_waitcnt lgkmcnt(4)
    v_mfma_f32_16x16x32_bf16 v[52:55], a[64:67], a[40:43], v[52:55]
    s_waitcnt vmcnt(6) lgkmcnt(0)
    s_barrier
    v_mfma_f32_16x16x32_bf16 v[116:119], a[72:75], a[40:43], v[116:119]
    s_add_u32 m0, s32, 97408
    ds_read_b128 a[120:123], v5 offset:0
    v_mfma_f32_16x16x32_bf16 v[116:119], a[76:79], a[44:47], v[116:119]
    buffer_load_dwordx4 v1, s[4:7], s24 offen offset:896 lds
    ds_read_b64_tr_b16 a[184:185], v7 offset:32768
    v_mfma_f32_16x16x32_bf16 v[112:115], a[76:79], a[36:39], v[112:115]
    s_add_u32 m0, s33, 97408
    v_mfma_f32_16x16x32_bf16 v[112:115], a[72:75], a[32:35], v[112:115]
    buffer_load_dwordx4 v1, s[4:7], s25 offen offset:896 lds
    ds_read_b64_tr_b16 a[186:187], v7 offset:33792
    v_mfma_f32_16x16x32_bf16 v[176:179], a[80:83], a[32:35], v[176:179]
    s_add_u32 m0, s48, 0
    ds_read_b128 a[124:127], v6 offset:0
    v_mfma_f32_16x16x32_bf16 v[176:179], a[84:87], a[36:39], v[176:179]
    buffer_load_dwordx4 v2, s[8:11], s40 offen nt lds
    v_mfma_f32_16x16x32_bf16 v[180:183], a[84:87], a[44:47], v[180:183]
    s_mov_b32 s56, 3145728
    ds_read_b64_tr_b16 a[188:189], v7 offset:40960
    v_mfma_f32_16x16x32_bf16 v[180:183], a[80:83], a[40:43], v[180:183]
    buffer_load_dword v31, v27, s[96:99], s56 offen
    ds_read_b64_tr_b16 a[190:191], v7 offset:41984
    v_mfma_f32_16x16x32_bf16 v[84:87], a[88:91], a[40:43], v[84:87]
    v_mfma_f32_16x16x32_bf16 v[84:87], a[92:95], a[44:47], v[84:87]
    ds_read_b128 a[132:135], v6 offset:2048
    v_mfma_f32_16x16x32_bf16 v[80:83], a[92:95], a[36:39], v[80:83]
    ds_read_b128 a[128:131], v5 offset:2048
    v_mfma_f32_16x16x32_bf16 v[80:83], a[88:91], a[32:35], v[80:83]
    v_mfma_f32_16x16x32_bf16 v[144:147], a[96:99], a[32:35], v[144:147]
    ds_read_b64_tr_b16 a[192:193], v8 offset:32768
    v_mfma_f32_16x16x32_bf16 v[144:147], a[100:103], a[36:39], v[144:147]
    ds_read_b64_tr_b16 a[194:195], v8 offset:33792
    v_mfma_f32_16x16x32_bf16 v[148:151], a[100:103], a[44:47], v[148:151]
    v_mfma_f32_16x16x32_bf16 v[148:151], a[96:99], a[40:43], v[148:151]
    s_add_u32 m0, s49, 0
    ds_read_b64_tr_b16 a[196:197], v8 offset:40960
    v_mfma_f32_16x16x32_bf16 v[212:215], a[104:107], a[40:43], v[212:215]
    buffer_load_dwordx4 v2, s[8:11], s41 offen nt lds
    ds_read_b64_tr_b16 a[198:199], v8 offset:41984
    v_mfma_f32_16x16x32_bf16 v[212:215], a[108:111], a[44:47], v[212:215]
    v_mfma_f32_16x16x32_bf16 v[208:211], a[108:111], a[36:39], v[208:211]
    ds_read_b64_tr_b16 a[200:201], v9 offset:32768
    v_mfma_f32_16x16x32_bf16 v[208:211], a[104:107], a[32:35], v[208:211]
    ds_read_b64_tr_b16 a[202:203], v9 offset:33792
    v_mfma_f32_16x16x32_bf16 v[240:243], a[112:115], a[32:35], v[240:243]
    v_mfma_f32_16x16x32_bf16 v[240:243], a[116:119], a[36:39], v[240:243]
    ds_read_b64_tr_b16 a[204:205], v9 offset:40960
    v_mfma_f32_16x16x32_bf16 v[244:247], a[116:119], a[44:47], v[244:247]
    ds_read_b64_tr_b16 a[206:207], v9 offset:41984
    v_mfma_f32_16x16x32_bf16 v[244:247], a[112:115], a[40:43], v[244:247]
    v_mfma_f32_16x16x32_bf16 v[56:59], a[64:67], a[48:51], v[56:59]
    ds_read_b64_tr_b16 a[208:209], v10 offset:32768
    v_mfma_f32_16x16x32_bf16 v[56:59], a[68:71], a[52:55], v[56:59]
    s_add_u32 m0, s50, 0
    ds_read_b64_tr_b16 a[210:211], v10 offset:33792
    v_mfma_f32_16x16x32_bf16 v[60:63], a[68:71], a[60:63], v[60:63]
    buffer_load_dwordx4 v2, s[8:11], s42 offen  lds
    v_mfma_f32_16x16x32_bf16 v[60:63], a[64:67], a[56:59], v[60:63]
    ds_read_b64_tr_b16 a[212:213], v10 offset:40960
    v_mfma_f32_16x16x32_bf16 v[124:127], a[72:75], a[56:59], v[124:127]
    ds_read_b64_tr_b16 a[214:215], v10 offset:41984
    v_mfma_f32_16x16x32_bf16 v[124:127], a[76:79], a[60:63], v[124:127]
    v_mfma_f32_16x16x32_bf16 v[120:123], a[76:79], a[52:55], v[120:123]
    ds_read_b64_tr_b16 a[216:217], v11 offset:32768
    v_mfma_f32_16x16x32_bf16 v[120:123], a[72:75], a[48:51], v[120:123]
    ds_read_b64_tr_b16 a[218:219], v11 offset:33792
    v_mfma_f32_16x16x32_bf16 v[184:187], a[80:83], a[48:51], v[184:187]
    v_mfma_f32_16x16x32_bf16 v[184:187], a[84:87], a[52:55], v[184:187]
    ds_read_b64_tr_b16 a[220:221], v11 offset:40960
    v_mfma_f32_16x16x32_bf16 v[188:191], a[84:87], a[60:63], v[188:191]
    ds_read_b64_tr_b16 a[222:223], v11 offset:41984
    v_mfma_f32_16x16x32_bf16 v[188:191], a[80:83], a[56:59], v[188:191]
    s_add_u32 m0, s51, 0
    v_mfma_f32_16x16x32_bf16 v[92:95], a[88:91], a[56:59], v[92:95]
    buffer_load_dwordx4 v2, s[8:11], s43 offen  lds
    ds_read_b64_tr_b16 a[224:225], v12 offset:32768
    v_mfma_f32_16x16x32_bf16 v[92:95], a[92:95], a[60:63], v[92:95]
    ds_read_b64_tr_b16 a[226:227], v12 offset:33792
    v_mfma_f32_16x16x32_bf16 v[88:91], a[92:95], a[52:55], v[88:91]
    v_mfma_f32_16x16x32_bf16 v[88:91], a[88:91], a[48:51], v[88:91]
    ds_read_b64_tr_b16 a[228:229], v12 offset:40960
    v_mfma_f32_16x16x32_bf16 v[152:155], a[96:99], a[48:51], v[152:155]
    ds_read_b64_tr_b16 a[230:231], v12 offset:41984
    v_mfma_f32_16x16x32_bf16 v[152:155], a[100:103], a[52:55], v[152:155]
    v_mfma_f32_16x16x32_bf16 v[156:159], a[100:103], a[60:63], v[156:159]
    ds_read_b64_tr_b16 a[232:233], v13 offset:32768
    v_mfma_f32_16x16x32_bf16 v[156:159], a[96:99], a[56:59], v[156:159]
    ds_read_b64_tr_b16 a[234:235], v13 offset:33792
    v_mfma_f32_16x16x32_bf16 v[220:223], a[104:107], a[56:59], v[220:223]
    s_add_u32 m0, s52, 0
    v_mfma_f32_16x16x32_bf16 v[220:223], a[108:111], a[60:63], v[220:223]
    buffer_load_dwordx4 v2, s[8:11], s44 offen  lds
    ds_read_b64_tr_b16 a[236:237], v13 offset:40960
    v_mfma_f32_16x16x32_bf16 v[216:219], a[108:111], a[52:55], v[216:219]
    ds_read_b64_tr_b16 a[238:239], v13 offset:41984
    v_mfma_f32_16x16x32_bf16 v[216:219], a[104:107], a[48:51], v[216:219]
    v_mfma_f32_16x16x32_bf16 v[248:251], a[112:115], a[48:51], v[248:251]
    v_mfma_f32_16x16x32_bf16 v[248:251], a[116:119], a[52:55], v[248:251]
    v_mfma_f32_16x16x32_bf16 v[252:255], a[116:119], a[60:63], v[252:255]
    v_mfma_f32_16x16x32_bf16 v[252:255], a[112:115], a[56:59], v[252:255]
    s_waitcnt lgkmcnt(14)
    v_mfma_f32_16x16x32_bf16 v[32:35], a[184:187], a[120:123], v[32:35]
L_pad2:
    s_cbranch_execz L_pad6
    v_mfma_f32_16x16x32_bf16 v[32:35], a[188:191], a[124:127], v[32:35]
    s_add_u32 m0, s53, 0
    ds_read_b128 a[136:139], v5 offset:4096
    v_mfma_f32_16x16x32_bf16 v[36:39], a[188:191], a[132:135], v[36:39]
    buffer_load_dwordx4 v2, s[8:11], s45 offen  lds
    v_mfma_f32_16x16x32_bf16 v[36:39], a[184:187], a[128:131], v[36:39]
    ds_read_b128 a[140:143], v6 offset:4096
    v_mfma_f32_16x16x32_bf16 v[100:103], a[192:195], a[128:131], v[100:103]
    v_mfma_f32_16x16x32_bf16 v[100:103], a[196:199], a[132:135], v[100:103]
    ds_read_b128 a[148:151], v6 offset:6144
    v_mfma_f32_16x16x32_bf16 v[96:99], a[196:199], a[124:127], v[96:99]
    v_mfma_f32_16x16x32_bf16 v[96:99], a[192:195], a[120:123], v[96:99]
    ds_read_b128 a[144:147], v5 offset:6144
    v_mfma_f32_16x16x32_bf16 v[160:163], a[200:203], a[120:123], v[160:163]
    v_mfma_f32_16x16x32_bf16 v[160:163], a[204:207], a[124:127], v[160:163]
    ds_read_b128 a[152:155], v5 offset:8192
    v_mfma_f32_16x16x32_bf16 v[164:167], a[204:207], a[132:135], v[164:167]
    s_add_u32 m0, s54, 0
    v_mfma_f32_16x16x32_bf16 v[164:167], a[200:203], a[128:131], v[164:167]
    buffer_load_dwordx4 v2, s[8:11], s46 offen  lds
    ds_read_b128 a[156:159], v6 offset:8192
    v_mfma_f32_16x16x32_bf16 v[68:71], a[208:211], a[128:131], v[68:71]
    s_waitcnt lgkmcnt(14)
    v_mfma_f32_16x16x32_bf16 v[68:71], a[212:215], a[132:135], v[68:71]
    ds_read_b128 a[164:167], v6 offset:10240
    v_mfma_f32_16x16x32_bf16 v[64:67], a[212:215], a[124:127], v[64:67]
    v_mfma_f32_16x16x32_bf16 v[64:67], a[208:211], a[120:123], v[64:67]
    ds_read_b128 a[160:163], v5 offset:10240
    v_mfma_f32_16x16x32_bf16 v[128:131], a[216:219], a[120:123], v[128:131]
    v_mfma_f32_16x16x32_bf16 v[128:131], a[220:223], a[124:127], v[128:131]
    ds_read_b128 a[168:171], v5 offset:12288
    v_mfma_f32_16x16x32_bf16 v[132:135], a[220:223], a[132:135], v[132:135]
    s_add_u32 m0, s55, 0
    v_mfma_f32_16x16x32_bf16 v[132:135], a[216:219], a[128:131], v[132:135]
    buffer_load_dwordx4 v2, s[8:11], s47 offen  lds
    ds_read_b128 a[172:175], v6 offset:12288
    s_waitcnt lgkmcnt(14)
    v_mfma_f32_16x16x32_bf16 v[196:199], a[224:227], a[128:131], v[196:199]
    v_add_u32 v2, 458752, v2
    v_mfma_f32_16x16x32_bf16 v[196:199], a[228:231], a[132:135], v[196:199]
    ds_read_b128 a[180:183], v6 offset:14336
    v_mfma_f32_16x16x32_bf16 v[192:195], a[228:231], a[124:127], v[192:195]
    v_mfma_f32_16x16x32_bf16 v[192:195], a[224:227], a[120:123], v[192:195]
    ds_read_b128 a[176:179], v5 offset:14336
    s_waitcnt lgkmcnt(14)
    v_mfma_f32_16x16x32_bf16 v[224:227], a[232:235], a[120:123], v[224:227]
    s_waitcnt lgkmcnt(12)
    v_mfma_f32_16x16x32_bf16 v[224:227], a[236:239], a[124:127], v[224:227]
    v_mfma_f32_16x16x32_bf16 v[228:231], a[236:239], a[132:135], v[228:231]
    s_add_u32 m0, s34, 97408
    v_mfma_f32_16x16x32_bf16 v[228:231], a[232:235], a[128:131], v[228:231]
    buffer_load_dwordx4 v1, s[4:7], s26 offen offset:896 lds
    s_waitcnt lgkmcnt(11)
    v_mfma_f32_16x16x32_bf16 v[40:43], a[184:187], a[136:139], v[40:43]
    s_waitcnt lgkmcnt(10)
    v_mfma_f32_16x16x32_bf16 v[40:43], a[188:191], a[140:143], v[40:43]
    s_waitcnt lgkmcnt(9)
    v_mfma_f32_16x16x32_bf16 v[44:47], a[188:191], a[148:151], v[44:47]
    s_waitcnt lgkmcnt(8)
    v_mfma_f32_16x16x32_bf16 v[44:47], a[184:187], a[144:147], v[44:47]
    v_mfma_f32_16x16x32_bf16 v[108:111], a[192:195], a[144:147], v[108:111]
    v_mfma_f32_16x16x32_bf16 v[108:111], a[196:199], a[148:151], v[108:111]
    s_add_u32 m0, s35, 97408
    v_mfma_f32_16x16x32_bf16 v[104:107], a[196:199], a[140:143], v[104:107]
    buffer_load_dwordx4 v1, s[4:7], s27 offen offset:896 lds
    v_mfma_f32_16x16x32_bf16 v[104:107], a[192:195], a[136:139], v[104:107]
    v_mfma_f32_16x16x32_bf16 v[168:171], a[200:203], a[136:139], v[168:171]
    v_mfma_f32_16x16x32_bf16 v[168:171], a[204:207], a[140:143], v[168:171]
    v_mfma_f32_16x16x32_bf16 v[172:175], a[204:207], a[148:151], v[172:175]
    v_mfma_f32_16x16x32_bf16 v[172:175], a[200:203], a[144:147], v[172:175]
    v_mfma_f32_16x16x32_bf16 v[76:79], a[208:211], a[144:147], v[76:79]
    s_add_u32 m0, s36, 97408
    v_mfma_f32_16x16x32_bf16 v[76:79], a[212:215], a[148:151], v[76:79]
    buffer_load_dwordx4 v1, s[4:7], s28 offen offset:896 lds
    v_mfma_f32_16x16x32_bf16 v[72:75], a[212:215], a[140:143], v[72:75]
    v_mfma_f32_16x16x32_bf16 v[72:75], a[208:211], a[136:139], v[72:75]
    v_mfma_f32_16x16x32_bf16 v[136:139], a[216:219], a[136:139], v[136:139]
    v_mfma_f32_16x16x32_bf16 v[136:139], a[220:223], a[140:143], v[136:139]
    v_mfma_f32_16x16x32_bf16 v[140:143], a[220:223], a[148:151], v[140:143]
    s_add_u32 m0, s37, 97408
    v_mfma_f32_16x16x32_bf16 v[140:143], a[216:219], a[144:147], v[140:143]
    buffer_load_dwordx4 v1, s[4:7], s29 offen offset:896 lds
    v_mfma_f32_16x16x32_bf16 v[204:207], a[224:227], a[144:147], v[204:207]
    v_mfma_f32_16x16x32_bf16 v[204:207], a[228:231], a[148:151], v[204:207]
    v_mfma_f32_16x16x32_bf16 v[200:203], a[228:231], a[140:143], v[200:203]
    v_mfma_f32_16x16x32_bf16 v[200:203], a[224:227], a[136:139], v[200:203]
    v_mfma_f32_16x16x32_bf16 v[232:235], a[232:235], a[136:139], v[232:235]
    s_add_u32 m0, s38, 97408
    v_mfma_f32_16x16x32_bf16 v[232:235], a[236:239], a[140:143], v[232:235]
    buffer_load_dwordx4 v1, s[4:7], s30 offen offset:896 lds
    v_mfma_f32_16x16x32_bf16 v[236:239], a[236:239], a[148:151], v[236:239]
    v_mfma_f32_16x16x32_bf16 v[236:239], a[232:235], a[144:147], v[236:239]
    s_waitcnt lgkmcnt(7)
    v_mfma_f32_16x16x32_bf16 v[48:51], a[184:187], a[152:155], v[48:51]
    s_waitcnt lgkmcnt(6)
    v_mfma_f32_16x16x32_bf16 v[48:51], a[188:191], a[156:159], v[48:51]
    s_add_u32 m0, s39, 97408
    s_waitcnt lgkmcnt(5)
    v_mfma_f32_16x16x32_bf16 v[52:55], a[188:191], a[164:167], v[52:55]
    buffer_load_dwordx4 v1, s[4:7], s31 offen offset:896 lds
    s_waitcnt lgkmcnt(4)
    v_mfma_f32_16x16x32_bf16 v[52:55], a[184:187], a[160:163], v[52:55]
    s_waitcnt vmcnt(6) lgkmcnt(0)
    s_barrier
    v_mfma_f32_16x16x32_bf16 v[116:119], a[192:195], a[160:163], v[116:119]
    s_add_u32 m0, s32, 130048
    ds_read_b128 a[0:3], v3 offset:0
    v_mfma_f32_16x16x32_bf16 v[116:119], a[196:199], a[164:167], v[116:119]
    buffer_load_dwordx4 v1, s[4:7], s24 offen offset:1024 lds
    ds_read_b64_tr_b16 a[64:65], v7 offset:0
    v_mfma_f32_16x16x32_bf16 v[112:115], a[196:199], a[156:159], v[112:115]
    s_add_u32 m0, s33, 130048
    v_mfma_f32_16x16x32_bf16 v[112:115], a[192:195], a[152:155], v[112:115]
    buffer_load_dwordx4 v1, s[4:7], s25 offen offset:1024 lds
    ds_read_b64_tr_b16 a[66:67], v7 offset:1024
    v_mfma_f32_16x16x32_bf16 v[176:179], a[200:203], a[152:155], v[176:179]
    s_add_u32 m0, s48, 32768
    ds_read_b128 a[4:7], v4 offset:0
    v_mfma_f32_16x16x32_bf16 v[176:179], a[204:207], a[156:159], v[176:179]
    buffer_load_dwordx4 v2, s[8:11], s40 offen nt lds
    v_mfma_f32_16x16x32_bf16 v[180:183], a[204:207], a[164:167], v[180:183]
    s_mov_b32 s56, 4194304
    ds_read_b64_tr_b16 a[68:69], v7 offset:8192
    v_mfma_f32_16x16x32_bf16 v[180:183], a[200:203], a[160:163], v[180:183]
    buffer_load_dword v31, v27, s[96:99], s56 offen
    ds_read_b64_tr_b16 a[70:71], v7 offset:9216
    v_mfma_f32_16x16x32_bf16 v[84:87], a[208:211], a[160:163], v[84:87]
    v_mfma_f32_16x16x32_bf16 v[84:87], a[212:215], a[164:167], v[84:87]
    ds_read_b128 a[12:15], v4 offset:2048
    v_mfma_f32_16x16x32_bf16 v[80:83], a[212:215], a[156:159], v[80:83]
    ds_read_b128 a[8:11], v3 offset:2048
    v_mfma_f32_16x16x32_bf16 v[80:83], a[208:211], a[152:155], v[80:83]
    v_mfma_f32_16x16x32_bf16 v[144:147], a[216:219], a[152:155], v[144:147]
    ds_read_b64_tr_b16 a[72:73], v8 offset:0
    v_mfma_f32_16x16x32_bf16 v[144:147], a[220:223], a[156:159], v[144:147]
    ds_read_b64_tr_b16 a[74:75], v8 offset:1024
    v_mfma_f32_16x16x32_bf16 v[148:151], a[220:223], a[164:167], v[148:151]
    v_mfma_f32_16x16x32_bf16 v[148:151], a[216:219], a[160:163], v[148:151]
    s_add_u32 m0, s49, 32768
    ds_read_b64_tr_b16 a[76:77], v8 offset:8192
    v_mfma_f32_16x16x32_bf16 v[212:215], a[224:227], a[160:163], v[212:215]
    buffer_load_dwordx4 v2, s[8:11], s41 offen nt lds
    ds_read_b64_tr_b16 a[78:79], v8 offset:9216
    v_mfma_f32_16x16x32_bf16 v[212:215], a[228:231], a[164:167], v[212:215]
    v_mfma_f32_16x16x32_bf16 v[208:211], a[228:231], a[156:159], v[208:211]
    ds_read_b64_tr_b16 a[80:81], v9 offset:0
    v_mfma_f32_16x16x32_bf16 v[208:211], a[224:227], a[152:155], v[208:211]
    ds_read_b64_tr_b16 a[82:83], v9 offset:1024
    v_mfma_f32_16x16x32_bf16 v[240:243], a[232:235], a[152:155], v[240:243]
    v_mfma_f32_16x16x32_bf16 v[240:243], a[236:239], a[156:159], v[240:243]
    ds_read_b64_tr_b16 a[84:85], v9 offset:8192
    v_mfma_f32_16x16x32_bf16 v[244:247], a[236:239], a[164:167], v[244:247]
    ds_read_b64_tr_b16 a[86:87], v9 offset:9216
    v_mfma_f32_16x16x32_bf16 v[244:247], a[232:235], a[160:163], v[244:247]
    v_mfma_f32_16x16x32_bf16 v[56:59], a[184:187], a[168:171], v[56:59]
    ds_read_b64_tr_b16 a[88:89], v10 offset:0
    v_mfma_f32_16x16x32_bf16 v[56:59], a[188:191], a[172:175], v[56:59]
    s_add_u32 m0, s50, 32768
    ds_read_b64_tr_b16 a[90:91], v10 offset:1024
    v_mfma_f32_16x16x32_bf16 v[60:63], a[188:191], a[180:183], v[60:63]
    buffer_load_dwordx4 v2, s[8:11], s42 offen  lds
    v_mfma_f32_16x16x32_bf16 v[60:63], a[184:187], a[176:179], v[60:63]
    ds_read_b64_tr_b16 a[92:93], v10 offset:8192
    v_mfma_f32_16x16x32_bf16 v[124:127], a[192:195], a[176:179], v[124:127]
    ds_read_b64_tr_b16 a[94:95], v10 offset:9216
    v_mfma_f32_16x16x32_bf16 v[124:127], a[196:199], a[180:183], v[124:127]
    v_mfma_f32_16x16x32_bf16 v[120:123], a[196:199], a[172:175], v[120:123]
    ds_read_b64_tr_b16 a[96:97], v11 offset:0
    v_mfma_f32_16x16x32_bf16 v[120:123], a[192:195], a[168:171], v[120:123]
    ds_read_b64_tr_b16 a[98:99], v11 offset:1024
    v_mfma_f32_16x16x32_bf16 v[184:187], a[200:203], a[168:171], v[184:187]
    v_mfma_f32_16x16x32_bf16 v[184:187], a[204:207], a[172:175], v[184:187]
    ds_read_b64_tr_b16 a[100:101], v11 offset:8192
    v_mfma_f32_16x16x32_bf16 v[188:191], a[204:207], a[180:183], v[188:191]
    ds_read_b64_tr_b16 a[102:103], v11 offset:9216
    v_mfma_f32_16x16x32_bf16 v[188:191], a[200:203], a[176:179], v[188:191]
    s_add_u32 m0, s51, 32768
    v_mfma_f32_16x16x32_bf16 v[92:95], a[208:211], a[176:179], v[92:95]
    buffer_load_dwordx4 v2, s[8:11], s43 offen  lds
    ds_read_b64_tr_b16 a[104:105], v12 offset:0
    v_mfma_f32_16x16x32_bf16 v[92:95], a[212:215], a[180:183], v[92:95]
    ds_read_b64_tr_b16 a[106:107], v12 offset:1024
    v_mfma_f32_16x16x32_bf16 v[88:91], a[212:215], a[172:175], v[88:91]
    v_mfma_f32_16x16x32_bf16 v[88:91], a[208:211], a[168:171], v[88:91]
    ds_read_b64_tr_b16 a[108:109], v12 offset:8192
    v_mfma_f32_16x16x32_bf16 v[152:155], a[216:219], a[168:171], v[152:155]
    ds_read_b64_tr_b16 a[110:111], v12 offset:9216
    v_mfma_f32_16x16x32_bf16 v[152:155], a[220:223], a[172:175], v[152:155]
    v_mfma_f32_16x16x32_bf16 v[156:159], a[220:223], a[180:183], v[156:159]
    ds_read_b64_tr_b16 a[112:113], v13 offset:0
    v_mfma_f32_16x16x32_bf16 v[156:159], a[216:219], a[176:179], v[156:159]
    ds_read_b64_tr_b16 a[114:115], v13 offset:1024
    v_mfma_f32_16x16x32_bf16 v[220:223], a[224:227], a[176:179], v[220:223]
    s_add_u32 m0, s52, 32768
    v_mfma_f32_16x16x32_bf16 v[220:223], a[228:231], a[180:183], v[220:223]
    buffer_load_dwordx4 v2, s[8:11], s44 offen  lds
    ds_read_b64_tr_b16 a[116:117], v13 offset:8192
    v_mfma_f32_16x16x32_bf16 v[216:219], a[228:231], a[172:175], v[216:219]
    ds_read_b64_tr_b16 a[118:119], v13 offset:9216
    v_mfma_f32_16x16x32_bf16 v[216:219], a[224:227], a[168:171], v[216:219]
    v_mfma_f32_16x16x32_bf16 v[248:251], a[232:235], a[168:171], v[248:251]
    v_mfma_f32_16x16x32_bf16 v[248:251], a[236:239], a[172:175], v[248:251]
    v_mfma_f32_16x16x32_bf16 v[252:255], a[236:239], a[180:183], v[252:255]
    v_mfma_f32_16x16x32_bf16 v[252:255], a[232:235], a[176:179], v[252:255]
    s_waitcnt lgkmcnt(14)
    v_mfma_f32_16x16x32_bf16 v[32:35], a[64:67], a[0:3], v[32:35]
    v_mfma_f32_16x16x32_bf16 v[32:35], a[68:71], a[4:7], v[32:35]
    s_add_u32 m0, s53, 32768
    ds_read_b128 a[16:19], v3 offset:4096
    v_mfma_f32_16x16x32_bf16 v[36:39], a[68:71], a[12:15], v[36:39]
    buffer_load_dwordx4 v2, s[8:11], s45 offen  lds
    v_mfma_f32_16x16x32_bf16 v[36:39], a[64:67], a[8:11], v[36:39]
    ds_read_b128 a[20:23], v4 offset:4096
    v_mfma_f32_16x16x32_bf16 v[100:103], a[72:75], a[8:11], v[100:103]
    v_mfma_f32_16x16x32_bf16 v[100:103], a[76:79], a[12:15], v[100:103]
    ds_read_b128 a[28:31], v4 offset:6144
    v_mfma_f32_16x16x32_bf16 v[96:99], a[76:79], a[4:7], v[96:99]
    v_mfma_f32_16x16x32_bf16 v[96:99], a[72:75], a[0:3], v[96:99]
    ds_read_b128 a[24:27], v3 offset:6144
    v_mfma_f32_16x16x32_bf16 v[160:163], a[80:83], a[0:3], v[160:163]
    v_mfma_f32_16x16x32_bf16 v[160:163], a[84:87], a[4:7], v[160:163]
    ds_read_b128 a[32:35], v3 offset:8192
    v_mfma_f32_16x16x32_bf16 v[164:167], a[84:87], a[12:15], v[164:167]
    s_add_u32 m0, s54, 32768
    v_mfma_f32_16x16x32_bf16 v[164:167], a[80:83], a[8:11], v[164:167]
    buffer_load_dwordx4 v2, s[8:11], s46 offen  lds
    ds_read_b128 a[36:39], v4 offset:8192
    v_mfma_f32_16x16x32_bf16 v[68:71], a[88:91], a[8:11], v[68:71]
    s_waitcnt lgkmcnt(14)
    v_mfma_f32_16x16x32_bf16 v[68:71], a[92:95], a[12:15], v[68:71]
    ds_read_b128 a[44:47], v4 offset:10240
    v_mfma_f32_16x16x32_bf16 v[64:67], a[92:95], a[4:7], v[64:67]
    v_mfma_f32_16x16x32_bf16 v[64:67], a[88:91], a[0:3], v[64:67]
    ds_read_b128 a[40:43], v3 offset:10240
    v_mfma_f32_16x16x32_bf16 v[128:131], a[96:99], a[0:3], v[128:131]
    v_mfma_f32_16x16x32_bf16 v[128:131], a[100:103], a[4:7], v[128:131]
    ds_read_b128 a[48:51], v3 offset:12288
    v_mfma_f32_16x16x32_bf16 v[132:135], a[100:103], a[12:15], v[132:135]
    s_add_u32 m0, s55, 32768
    v_mfma_f32_16x16x32_bf16 v[132:135], a[96:99], a[8:11], v[132:135]
    buffer_load_dwordx4 v2, s[8:11], s47 offen  lds
    ds_read_b128 a[52:55], v4 offset:12288
    s_waitcnt lgkmcnt(14)
    v_mfma_f32_16x16x32_bf16 v[196:199], a[104:107], a[8:11], v[196:199]
    v_add_u32 v2, 458752, v2
    v_mfma_f32_16x16x32_bf16 v[196:199], a[108:111], a[12:15], v[196:199]
    ds_read_b128 a[60:63], v4 offset:14336
    v_mfma_f32_16x16x32_bf16 v[192:195], a[108:111], a[4:7], v[192:195]
    v_mfma_f32_16x16x32_bf16 v[192:195], a[104:107], a[0:3], v[192:195]
    ds_read_b128 a[56:59], v3 offset:14336
    s_waitcnt lgkmcnt(14)
    v_mfma_f32_16x16x32_bf16 v[224:227], a[112:115], a[0:3], v[224:227]
    s_waitcnt lgkmcnt(12)
    v_mfma_f32_16x16x32_bf16 v[224:227], a[116:119], a[4:7], v[224:227]
    v_mfma_f32_16x16x32_bf16 v[228:231], a[116:119], a[12:15], v[228:231]
    s_add_u32 m0, s34, 130048
    v_mfma_f32_16x16x32_bf16 v[228:231], a[112:115], a[8:11], v[228:231]
    buffer_load_dwordx4 v1, s[4:7], s26 offen offset:1024 lds
    s_waitcnt lgkmcnt(11)
    v_mfma_f32_16x16x32_bf16 v[40:43], a[64:67], a[16:19], v[40:43]
    s_waitcnt lgkmcnt(10)
    v_mfma_f32_16x16x32_bf16 v[40:43], a[68:71], a[20:23], v[40:43]
    s_waitcnt lgkmcnt(9)
    v_mfma_f32_16x16x32_bf16 v[44:47], a[68:71], a[28:31], v[44:47]
    s_waitcnt lgkmcnt(8)
    v_mfma_f32_16x16x32_bf16 v[44:47], a[64:67], a[24:27], v[44:47]
    v_mfma_f32_16x16x32_bf16 v[108:111], a[72:75], a[24:27], v[108:111]
    v_mfma_f32_16x16x32_bf16 v[108:111], a[76:79], a[28:31], v[108:111]
    s_add_u32 m0, s35, 130048
    v_mfma_f32_16x16x32_bf16 v[104:107], a[76:79], a[20:23], v[104:107]
    buffer_load_dwordx4 v1, s[4:7], s27 offen offset:1024 lds
    v_mfma_f32_16x16x32_bf16 v[104:107], a[72:75], a[16:19], v[104:107]
    v_mfma_f32_16x16x32_bf16 v[168:171], a[80:83], a[16:19], v[168:171]
    v_mfma_f32_16x16x32_bf16 v[168:171], a[84:87], a[20:23], v[168:171]
    v_mfma_f32_16x16x32_bf16 v[172:175], a[84:87], a[28:31], v[172:175]
    v_mfma_f32_16x16x32_bf16 v[172:175], a[80:83], a[24:27], v[172:175]
    v_mfma_f32_16x16x32_bf16 v[76:79], a[88:91], a[24:27], v[76:79]
    s_add_u32 m0, s36, 130048
    v_mfma_f32_16x16x32_bf16 v[76:79], a[92:95], a[28:31], v[76:79]
    buffer_load_dwordx4 v1, s[4:7], s28 offen offset:1024 lds
    v_mfma_f32_16x16x32_bf16 v[72:75], a[92:95], a[20:23], v[72:75]
    v_mfma_f32_16x16x32_bf16 v[72:75], a[88:91], a[16:19], v[72:75]
    v_mfma_f32_16x16x32_bf16 v[136:139], a[96:99], a[16:19], v[136:139]
    v_mfma_f32_16x16x32_bf16 v[136:139], a[100:103], a[20:23], v[136:139]
    v_mfma_f32_16x16x32_bf16 v[140:143], a[100:103], a[28:31], v[140:143]
    s_add_u32 m0, s37, 130048
    v_mfma_f32_16x16x32_bf16 v[140:143], a[96:99], a[24:27], v[140:143]
    buffer_load_dwordx4 v1, s[4:7], s29 offen offset:1024 lds
    v_mfma_f32_16x16x32_bf16 v[204:207], a[104:107], a[24:27], v[204:207]
    v_mfma_f32_16x16x32_bf16 v[204:207], a[108:111], a[28:31], v[204:207]
    v_mfma_f32_16x16x32_bf16 v[200:203], a[108:111], a[20:23], v[200:203]
    v_mfma_f32_16x16x32_bf16 v[200:203], a[104:107], a[16:19], v[200:203]
    v_mfma_f32_16x16x32_bf16 v[232:235], a[112:115], a[16:19], v[232:235]
    s_add_u32 m0, s38, 130048
    v_mfma_f32_16x16x32_bf16 v[232:235], a[116:119], a[20:23], v[232:235]
    buffer_load_dwordx4 v1, s[4:7], s30 offen offset:1024 lds
    v_mfma_f32_16x16x32_bf16 v[236:239], a[116:119], a[28:31], v[236:239]
    v_mfma_f32_16x16x32_bf16 v[236:239], a[112:115], a[24:27], v[236:239]
    s_waitcnt lgkmcnt(7)
    v_mfma_f32_16x16x32_bf16 v[48:51], a[64:67], a[32:35], v[48:51]
    s_waitcnt lgkmcnt(6)
    v_mfma_f32_16x16x32_bf16 v[48:51], a[68:71], a[36:39], v[48:51]
    s_add_u32 m0, s39, 130048
    s_waitcnt lgkmcnt(5)
    v_mfma_f32_16x16x32_bf16 v[52:55], a[68:71], a[44:47], v[52:55]
    buffer_load_dwordx4 v1, s[4:7], s31 offen offset:1024 lds
    s_waitcnt lgkmcnt(4)
    v_mfma_f32_16x16x32_bf16 v[52:55], a[64:67], a[40:43], v[52:55]
    s_waitcnt vmcnt(6) lgkmcnt(0)
    s_barrier
    v_mfma_f32_16x16x32_bf16 v[116:119], a[72:75], a[40:43], v[116:119]
    s_add_u32 m0, s32, 64384
    ds_read_b128 a[120:123], v3 offset:32768
    v_mfma_f32_16x16x32_bf16 v[116:119], a[76:79], a[44:47], v[116:119]
    buffer_load_dwordx4 v1, s[4:7], s24 offen offset:1152 lds
    ds_read_b64_tr_b16 a[184:185], v7 offset:32768
    v_mfma_f32_16x16x32_bf16 v[112:115], a[76:79], a[36:39], v[112:115]
    s_add_u32 m0, s33, 64384
    v_mfma_f32_16x16x32_bf16 v[112:115], a[72:75], a[32:35], v[112:115]
    buffer_load_dwordx4 v1, s[4:7], s25 offen offset:1152 lds
    ds_read_b64_tr_b16 a[186:187], v7 offset:33792
    v_mfma_f32_16x16x32_bf16 v[176:179], a[80:83], a[32:35], v[176:179]
    s_add_u32 m0, s48, 0
    ds_read_b128 a[124:127], v4 offset:32768
    v_mfma_f32_16x16x32_bf16 v[176:179], a[84:87], a[36:39], v[176:179]
    buffer_load_dwordx4 v2, s[8:11], s40 offen nt lds
    v_mfma_f32_16x16x32_bf16 v[180:183], a[84:87], a[44:47], v[180:183]
    s_mov_b32 s56, 5242880
    ds_read_b64_tr_b16 a[188:189], v7 offset:40960
    v_mfma_f32_16x16x32_bf16 v[180:183], a[80:83], a[40:43], v[180:183]
    buffer_load_dword v31, v27, s[96:99], s56 offen
    ds_read_b64_tr_b16 a[190:191], v7 offset:41984
    v_mfma_f32_16x16x32_bf16 v[84:87], a[88:91], a[40:43], v[84:87]
    v_mfma_f32_16x16x32_bf16 v[84:87], a[92:95], a[44:47], v[84:87]
    ds_read_b128 a[132:135], v4 offset:34816
    v_mfma_f32_16x16x32_bf16 v[80:83], a[92:95], a[36:39], v[80:83]
    ds_read_b128 a[128:131], v3 offset:34816
    v_mfma_f32_16x16x32_bf16 v[80:83], a[88:91], a[32:35], v[80:83]
    v_mfma_f32_16x16x32_bf16 v[144:147], a[96:99], a[32:35], v[144:147]
    ds_read_b64_tr_b16 a[192:193], v8 offset:32768
    v_mfma_f32_16x16x32_bf16 v[144:147], a[100:103], a[36:39], v[144:147]
    ds_read_b64_tr_b16 a[194:195], v8 offset:33792
    v_mfma_f32_16x16x32_bf16 v[148:151], a[100:103], a[44:47], v[148:151]
    v_mfma_f32_16x16x32_bf16 v[148:151], a[96:99], a[40:43], v[148:151]
    s_add_u32 m0, s49, 0
    ds_read_b64_tr_b16 a[196:197], v8 offset:40960
    v_mfma_f32_16x16x32_bf16 v[212:215], a[104:107], a[40:43], v[212:215]
    buffer_load_dwordx4 v2, s[8:11], s41 offen nt lds
    ds_read_b64_tr_b16 a[198:199], v8 offset:41984
    v_mfma_f32_16x16x32_bf16 v[212:215], a[108:111], a[44:47], v[212:215]
    v_mfma_f32_16x16x32_bf16 v[208:211], a[108:111], a[36:39], v[208:211]
    ds_read_b64_tr_b16 a[200:201], v9 offset:32768
    v_mfma_f32_16x16x32_bf16 v[208:211], a[104:107], a[32:35], v[208:211]
    ds_read_b64_tr_b16 a[202:203], v9 offset:33792
    v_mfma_f32_16x16x32_bf16 v[240:243], a[112:115], a[32:35], v[240:243]
    v_mfma_f32_16x16x32_bf16 v[240:243], a[116:119], a[36:39], v[240:243]
    ds_read_b64_tr_b16 a[204:205], v9 offset:40960
    v_mfma_f32_16x16x32_bf16 v[244:247], a[116:119], a[44:47], v[244:247]
    ds_read_b64_tr_b16 a[206:207], v9 offset:41984
    v_mfma_f32_16x16x32_bf16 v[244:247], a[112:115], a[40:43], v[244:247]
    v_mfma_f32_16x16x32_bf16 v[56:59], a[64:67], a[48:51], v[56:59]
    ds_read_b64_tr_b16 a[208:209], v10 offset:32768
    v_mfma_f32_16x16x32_bf16 v[56:59], a[68:71], a[52:55], v[56:59]
    s_add_u32 m0, s50, 0
    ds_read_b64_tr_b16 a[210:211], v10 offset:33792
    v_mfma_f32_16x16x32_bf16 v[60:63], a[68:71], a[60:63], v[60:63]
    buffer_load_dwordx4 v2, s[8:11], s42 offen  lds
    v_mfma_f32_16x16x32_bf16 v[60:63], a[64:67], a[56:59], v[60:63]
    ds_read_b64_tr_b16 a[212:213], v10 offset:40960
    v_mfma_f32_16x16x32_bf16 v[124:127], a[72:75], a[56:59], v[124:127]
    ds_read_b64_tr_b16 a[214:215], v10 offset:41984
    v_mfma_f32_16x16x32_bf16 v[124:127], a[76:79], a[60:63], v[124:127]
    v_mfma_f32_16x16x32_bf16 v[120:123], a[76:79], a[52:55], v[120:123]
    ds_read_b64_tr_b16 a[216:217], v11 offset:32768
    v_mfma_f32_16x16x32_bf16 v[120:123], a[72:75], a[48:51], v[120:123]
    ds_read_b64_tr_b16 a[218:219], v11 offset:33792
    v_mfma_f32_16x16x32_bf16 v[184:187], a[80:83], a[48:51], v[184:187]
    v_mfma_f32_16x16x32_bf16 v[184:187], a[84:87], a[52:55], v[184:187]
    ds_read_b64_tr_b16 a[220:221], v11 offset:40960
    v_mfma_f32_16x16x32_bf16 v[188:191], a[84:87], a[60:63], v[188:191]
    ds_read_b64_tr_b16 a[222:223], v11 offset:41984
    v_mfma_f32_16x16x32_bf16 v[188:191], a[80:83], a[56:59], v[188:191]
    s_add_u32 m0, s51, 0
    v_mfma_f32_16x16x32_bf16 v[92:95], a[88:91], a[56:59], v[92:95]
    buffer_load_dwordx4 v2, s[8:11], s43 offen  lds
    ds_read_b64_tr_b16 a[224:225], v12 offset:32768
    v_mfma_f32_16x16x32_bf16 v[92:95], a[92:95], a[60:63], v[92:95]
    ds_read_b64_tr_b16 a[226:227], v12 offset:33792
    v_mfma_f32_16x16x32_bf16 v[88:91], a[92:95], a[52:55], v[88:91]
    v_mfma_f32_16x16x32_bf16 v[88:91], a[88:91], a[48:51], v[88:91]
    ds_read_b64_tr_b16 a[228:229], v12 offset:40960
    v_mfma_f32_16x16x32_bf16 v[152:155], a[96:99], a[48:51], v[152:155]
    ds_read_b64_tr_b16 a[230:231], v12 offset:41984
    v_mfma_f32_16x16x32_bf16 v[152:155], a[100:103], a[52:55], v[152:155]
    v_mfma_f32_16x16x32_bf16 v[156:159], a[100:103], a[60:63], v[156:159]
    ds_read_b64_tr_b16 a[232:233], v13 offset:32768
    v_mfma_f32_16x16x32_bf16 v[156:159], a[96:99], a[56:59], v[156:159]
    ds_read_b64_tr_b16 a[234:235], v13 offset:33792
    v_mfma_f32_16x16x32_bf16 v[220:223], a[104:107], a[56:59], v[220:223]
    s_add_u32 m0, s52, 0
    v_mfma_f32_16x16x32_bf16 v[220:223], a[108:111], a[60:63], v[220:223]
    buffer_load_dwordx4 v2, s[8:11], s44 offen  lds
    ds_read_b64_tr_b16 a[236:237], v13 offset:40960
    v_mfma_f32_16x16x32_bf16 v[216:219], a[108:111], a[52:55], v[216:219]
    ds_read_b64_tr_b16 a[238:239], v13 offset:41984
    v_mfma_f32_16x16x32_bf16 v[216:219], a[104:107], a[48:51], v[216:219]
    v_mfma_f32_16x16x32_bf16 v[248:251], a[112:115], a[48:51], v[248:251]
    v_mfma_f32_16x16x32_bf16 v[248:251], a[116:119], a[52:55], v[248:251]
    v_mfma_f32_16x16x32_bf16 v[252:255], a[116:119], a[60:63], v[252:255]
    v_mfma_f32_16x16x32_bf16 v[252:255], a[112:115], a[56:59], v[252:255]
    s_waitcnt lgkmcnt(14)
    v_mfma_f32_16x16x32_bf16 v[32:35], a[184:187], a[120:123], v[32:35]
    v_mfma_f32_16x16x32_bf16 v[32:35], a[188:191], a[124:127], v[32:35]
    s_add_u32 m0, s53, 0
    ds_read_b128 a[136:139], v3 offset:36864
    v_mfma_f32_16x16x32_bf16 v[36:39], a[188:191], a[132:135], v[36:39]
    buffer_load_dwordx4 v2, s[8:11], s45 offen  lds
    v_mfma_f32_16x16x32_bf16 v[36:39], a[184:187], a[128:131], v[36:39]
    ds_read_b128 a[140:143], v4 offset:36864
    v_mfma_f32_16x16x32_bf16 v[100:103], a[192:195], a[128:131], v[100:103]
    v_mfma_f32_16x16x32_bf16 v[100:103], a[196:199], a[132:135], v[100:103]
    ds_read_b128 a[148:151], v4 offset:38912
    v_mfma_f32_16x16x32_bf16 v[96:99], a[196:199], a[124:127], v[96:99]
    v_mfma_f32_16x16x32_bf16 v[96:99], a[192:195], a[120:123], v[96:99]
    ds_read_b128 a[144:147], v3 offset:38912
    v_mfma_f32_16x16x32_bf16 v[160:163], a[200:203], a[120:123], v[160:163]
    v_mfma_f32_16x16x32_bf16 v[160:163], a[204:207], a[124:127], v[160:163]
    ds_read_b128 a[152:155], v3 offset:40960
    v_mfma_f32_16x16x32_bf16 v[164:167], a[204:207], a[132:135], v[164:167]
    s_add_u32 m0, s54, 0
    v_mfma_f32_16x16x32_bf16 v[164:167], a[200:203], a[128:131], v[164:167]
    buffer_load_dwordx4 v2, s[8:11], s46 offen  lds
    ds_read_b128 a[156:159], v4 offset:40960
    v_mfma_f32_16x16x32_bf16 v[68:71], a[208:211], a[128:131], v[68:71]
    s_waitcnt lgkmcnt(14)
    v_mfma_f32_16x16x32_bf16 v[68:71], a[212:215], a[132:135], v[68:71]
    ds_read_b128 a[164:167], v4 offset:43008
    v_mfma_f32_16x16x32_bf16 v[64:67], a[212:215], a[124:127], v[64:67]
    v_mfma_f32_16x16x32_bf16 v[64:67], a[208:211], a[120:123], v[64:67]
    ds_read_b128 a[160:163], v3 offset:43008
    v_mfma_f32_16x16x32_bf16 v[128:131], a[216:219], a[120:123], v[128:131]
    v_mfma_f32_16x16x32_bf16 v[128:131], a[220:223], a[124:127], v[128:131]
    ds_read_b128 a[168:171], v3 offset:45056
    v_mfma_f32_16x16x32_bf16 v[132:135], a[220:223], a[132:135], v[132:135]
    s_add_u32 m0, s55, 0
    v_mfma_f32_16x16x32_bf16 v[132:135], a[216:219], a[128:131], v[132:135]
    buffer_load_dwordx4 v2, s[8:11], s47 offen  lds
    ds_read_b128 a[172:175], v4 offset:45056
    s_waitcnt lgkmcnt(14)
    v_mfma_f32_16x16x32_bf16 v[196:199], a[224:227], a[128:131], v[196:199]
    v_add_u32 v2, 458752, v2
    v_mfma_f32_16x16x32_bf16 v[196:199], a[228:231], a[132:135], v[196:199]
    ds_read_b128 a[180:183], v4 offset:47104
    v_mfma_f32_16x16x32_bf16 v[192:195], a[228:231], a[124:127], v[192:195]
    v_mfma_f32_16x16x32_bf16 v[192:195], a[224:227], a[120:123], v[192:195]
    ds_read_b128 a[176:179], v3 offset:47104
    s_waitcnt lgkmcnt(14)
    v_mfma_f32_16x16x32_bf16 v[224:227], a[232:235], a[120:123], v[224:227]
    s_waitcnt lgkmcnt(12)
    v_mfma_f32_16x16x32_bf16 v[224:227], a[236:239], a[124:127], v[224:227]
    v_mfma_f32_16x16x32_bf16 v[228:231], a[236:239], a[132:135], v[228:231]
    s_add_u32 m0, s34, 64384
    v_mfma_f32_16x16x32_bf16 v[228:231], a[232:235], a[128:131], v[228:231]
    buffer_load_dwordx4 v1, s[4:7], s26 offen offset:1152 lds
    s_waitcnt lgkmcnt(11)
    v_mfma_f32_16x16x32_bf16 v[40:43], a[184:187], a[136:139], v[40:43]
    s_waitcnt lgkmcnt(10)
    v_mfma_f32_16x16x32_bf16 v[40:43], a[188:191], a[140:143], v[40:43]
    s_waitcnt lgkmcnt(9)
    v_mfma_f32_16x16x32_bf16 v[44:47], a[188:191], a[148:151], v[44:47]
    s_waitcnt lgkmcnt(8)
    v_mfma_f32_16x16x32_bf16 v[44:47], a[184:187], a[144:147], v[44:47]
    v_mfma_f32_16x16x32_bf16 v[108:111], a[192:195], a[144:147], v[108:111]
    v_mfma_f32_16x16x32_bf16 v[108:111], a[196:199], a[148:151], v[108:111]
    s_add_u32 m0, s35, 64384
    v_mfma_f32_16x16x32_bf16 v[104:107], a[196:199], a[140:143], v[104:107]
    buffer_load_dwordx4 v1, s[4:7], s27 offen offset:1152 lds
    v_mfma_f32_16x16x32_bf16 v[104:107], a[192:195], a[136:139], v[104:107]
    v_mfma_f32_16x16x32_bf16 v[168:171], a[200:203], a[136:139], v[168:171]
    v_mfma_f32_16x16x32_bf16 v[168:171], a[204:207], a[140:143], v[168:171]
    v_mfma_f32_16x16x32_bf16 v[172:175], a[204:207], a[148:151], v[172:175]
    v_mfma_f32_16x16x32_bf16 v[172:175], a[200:203], a[144:147], v[172:175]
    v_mfma_f32_16x16x32_bf16 v[76:79], a[208:211], a[144:147], v[76:79]
    s_add_u32 m0, s36, 64384
    v_mfma_f32_16x16x32_bf16 v[76:79], a[212:215], a[148:151], v[76:79]
    buffer_load_dwordx4 v1, s[4:7], s28 offen offset:1152 lds
    v_mfma_f32_16x16x32_bf16 v[72:75], a[212:215], a[140:143], v[72:75]
    v_mfma_f32_16x16x32_bf16 v[72:75], a[208:211], a[136:139], v[72:75]
    v_mfma_f32_16x16x32_bf16 v[136:139], a[216:219], a[136:139], v[136:139]
    v_mfma_f32_16x16x32_bf16 v[136:139], a[220:223], a[140:143], v[136:139]
    v_mfma_f32_16x16x32_bf16 v[140:143], a[220:223], a[148:151], v[140:143]
    s_add_u32 m0, s37, 64384
    v_mfma_f32_16x16x32_bf16 v[140:143], a[216:219], a[144:147], v[140:143]
    buffer_load_dwordx4 v1, s[4:7], s29 offen offset:1152 lds
    v_mfma_f32_16x16x32_bf16 v[204:207], a[224:227], a[144:147], v[204:207]
    v_mfma_f32_16x16x32_bf16 v[204:207], a[228:231], a[148:151], v[204:207]
    v_mfma_f32_16x16x32_bf16 v[200:203], a[228:231], a[140:143], v[200:203]
    v_mfma_f32_16x16x32_bf16 v[200:203], a[224:227], a[136:139], v[200:203]
    v_mfma_f32_16x16x32_bf16 v[232:235], a[232:235], a[136:139], v[232:235]
    s_add_u32 m0, s38, 64384
    v_mfma_f32_16x16x32_bf16 v[232:235], a[236:239], a[140:143], v[232:235]
    buffer_load_dwordx4 v1, s[4:7], s30 offen offset:1152 lds
    v_mfma_f32_16x16x32_bf16 v[236:239], a[236:239], a[148:151], v[236:239]
    v_mfma_f32_16x16x32_bf16 v[236:239], a[232:235], a[144:147], v[236:239]
    s_waitcnt lgkmcnt(7)
    v_mfma_f32_16x16x32_bf16 v[48:51], a[184:187], a[152:155], v[48:51]
    s_waitcnt lgkmcnt(6)
    v_mfma_f32_16x16x32_bf16 v[48:51], a[188:191], a[156:159], v[48:51]
    s_add_u32 m0, s39, 64384
    s_waitcnt lgkmcnt(5)
    v_mfma_f32_16x16x32_bf16 v[52:55], a[188:191], a[164:167], v[52:55]
    buffer_load_dwordx4 v1, s[4:7], s31 offen offset:1152 lds
    s_waitcnt lgkmcnt(4)
    v_mfma_f32_16x16x32_bf16 v[52:55], a[184:187], a[160:163], v[52:55]
    s_waitcnt vmcnt(6) lgkmcnt(0)
    s_barrier
    v_mfma_f32_16x16x32_bf16 v[116:119], a[192:195], a[160:163], v[116:119]
    s_add_u32 m0, s32, 97024
    ds_read_b128 a[0:3], v5 offset:0
    v_mfma_f32_16x16x32_bf16 v[116:119], a[196:199], a[164:167], v[116:119]
    buffer_load_dwordx4 v1, s[4:7], s24 offen offset:1280 lds
    ds_read_b64_tr_b16 a[64:65], v7 offset:0
    v_mfma_f32_16x16x32_bf16 v[112:115], a[196:199], a[156:159], v[112:115]
    s_add_u32 m0, s33, 97024
    v_mfma_f32_16x16x32_bf16 v[112:115], a[192:195], a[152:155], v[112:115]
    buffer_load_dwordx4 v1, s[4:7], s25 offen offset:1280 lds
    ds_read_b64_tr_b16 a[66:67], v7 offset:1024
    v_mfma_f32_16x16x32_bf16 v[176:179], a[200:203], a[152:155], v[176:179]
    s_add_u32 m0, s48, 32768
    ds_read_b128 a[4:7], v6 offset:0
    v_mfma_f32_16x16x32_bf16 v[176:179], a[204:207], a[156:159], v[176:179]
    buffer_load_dwordx4 v2, s[8:11], s40 offen nt lds
    v_mfma_f32_16x16x32_bf16 v[180:183], a[204:207], a[164:167], v[180:183]
    s_mov_b32 s56, 6291456
    ds_read_b64_tr_b16 a[68:69], v7 offset:8192
    v_mfma_f32_16x16x32_bf16 v[180:183], a[200:203], a[160:163], v[180:183]
    buffer_load_dword v31, v27, s[96:99], s56 offen
    ds_read_b64_tr_b16 a[70:71], v7 offset:9216
    v_mfma_f32_16x16x32_bf16 v[84:87], a[208:211], a[160:163], v[84:87]
L_pad3:
    s_cbranch_execz L_pad7
    v_mfma_f32_16x16x32_bf16 v[84:87], a[212:215], a[164:167], v[84:87]
    ds_read_b128 a[12:15], v6 offset:2048
    v_mfma_f32_16x16x32_bf16 v[80:83], a[212:215], a[156:159], v[80:83]
    ds_read_b128 a[8:11], v5 offset:2048
    v_mfma_f32_16x16x32_bf16 v[80:83], a[208:211], a[152:155], v[80:83]
    v_mfma_f32_16x16x32_bf16 v[144:147], a[216:219], a[152:155], v[144:147]
    ds_read_b64_tr_b16 a[72:73], v8 offset:0
    v_mfma_f32_16x16x32_bf16 v[144:147], a[220:223], a[156:159], v[144:147]
    ds_read_b64_tr_b16 a[74:75], v8 offset:1024
    v_mfma_f32_16x16x32_bf16 v[148:151], a[220:223], a[164:167], v[148:151]
    v_mfma_f32_16x16x32_bf16 v[148:151], a[216:219], a[160:163], v[148:151]
    s_add_u32 m0, s49, 32768
    ds_read_b64_tr_b16 a[76:77], v8 offset:8192
    v_mfma_f32_16x16x32_bf16 v[212:215], a[224:227], a[160:163], v[212:215]
    buffer_load_dwordx4 v2, s[8:11], s41 offen nt lds
    ds_read_b64_tr_b16 a[78:79], v8 offset:9216
    v_mfma_f32_16x16x32_bf16 v[212:215], a[228:231], a[164:167], v[212:215]
    v_mfma_f32_16x16x32_bf16 v[208:211], a[228:231], a[156:159], v[208:211]
    ds_read_b64_tr_b16 a[80:81], v9 offset:0
    v_mfma_f32_16x16x32_bf16 v[208:211], a[224:227], a[152:155], v[208:211]
    ds_read_b64_tr_b16 a[82:83], v9 offset:1024
    v_mfma_f32_16x16x32_bf16 v[240:243], a[232:235], a[152:155], v[240:243]
    v_mfma_f32_16x16x32_bf16 v[240:243], a[236:239], a[156:159], v[240:243]
    ds_read_b64_tr_b16 a[84:85], v9 offset:8192
    v_mfma_f32_16x16x32_bf16 v[244:247], a[236:239], a[164:167], v[244:247]
    ds_read_b64_tr_b16 a[86:87], v9 offset:9216
    v_mfma_f32_16x16x32_bf16 v[244:247], a[232:235], a[160:163], v[244:247]
    v_mfma_f32_16x16x32_bf16 v[56:59], a[184:187], a[168:171], v[56:59]
    ds_read_b64_tr_b16 a[88:89], v10 offset:0
    v_mfma_f32_16x16x32_bf16 v[56:59], a[188:191], a[172:175], v[56:59]
    s_add_u32 m0, s50, 32768
    ds_read_b64_tr_b16 a[90:91], v10 offset:1024
    v_mfma_f32_16x16x32_bf16 v[60:63], a[188:191], a[180:183], v[60:63]
    buffer_load_dwordx4 v2, s[8:11], s42 offen  lds
    v_mfma_f32_16x16x32_bf16 v[60:63], a[184:187], a[176:179], v[60:63]
    ds_read_b64_tr_b16 a[92:93], v10 offset:8192
    v_mfma_f32_16x16x32_bf16 v[124:127], a[192:195], a[176:179], v[124:127]
    ds_read_b64_tr_b16 a[94:95], v10 offset:9216
    v_mfma_f32_16x16x32_bf16 v[124:127], a[196:199], a[180:183], v[124:127]
    v_mfma_f32_16x16x32_bf16 v[120:123], a[196:199], a[172:175], v[120:123]
    ds_read_b64_tr_b16 a[96:97], v11 offset:0
    v_mfma_f32_16x16x32_bf16 v[120:123], a[192:195], a[168:171], v[120:123]
    ds_read_b64_tr_b16 a[98:99], v11 offset:1024
    v_mfma_f32_16x16x32_bf16 v[184:187], a[200:203], a[168:171], v[184:187]
    v_mfma_f32_16x16x32_bf16 v[184:187], a[204:207], a[172:175], v[184:187]
    ds_read_b64_tr_b16 a[100:101], v11 offset:8192
    v_mfma_f32_16x16x32_bf16 v[188:191], a[204:207], a[180:183], v[188:191]
    ds_read_b64_tr_b16 a[102:103], v11 offset:9216
    v_mfma_f32_16x16x32_bf16 v[188:191], a[200:203], a[176:179], v[188:191]
    s_add_u32 m0, s51, 32768
    v_mfma_f32_16x16x32_bf16 v[92:95], a[208:211], a[176:179], v[92:95]
    buffer_load_dwordx4 v2, s[8:11], s43 offen  lds
    ds_read_b64_tr_b16 a[104:105], v12 offset:0
    v_mfma_f32_16x16x32_bf16 v[92:95], a[212:215], a[180:183], v[92:95]
    ds_read_b64_tr_b16 a[106:107], v12 offset:1024
    v_mfma_f32_16x16x32_bf16 v[88:91], a[212:215], a[172:175], v[88:91]
    v_mfma_f32_16x16x32_bf16 v[88:91], a[208:211], a[168:171], v[88:91]
    ds_read_b64_tr_b16 a[108:109], v12 offset:8192
    v_mfma_f32_16x16x32_bf16 v[152:155], a[216:219], a[168:171], v[152:155]
    ds_read_b64_tr_b16 a[110:111], v12 offset:9216
    v_mfma_f32_16x16x32_bf16 v[152:155], a[220:223], a[172:175], v[152:155]
    v_mfma_f32_16x16x32_bf16 v[156:159], a[220:223], a[180:183], v[156:159]
    ds_read_b64_tr_b16 a[112:113], v13 offset:0
    v_mfma_f32_16x16x32_bf16 v[156:159], a[216:219], a[176:179], v[156:159]
    ds_read_b64_tr_b16 a[114:115], v13 offset:1024
    v_mfma_f32_16x16x32_bf16 v[220:223], a[224:227], a[176:179], v[220:223]
    s_add_u32 m0, s52, 32768
    v_mfma_f32_16x16x32_bf16 v[220:223], a[228:231], a[180:183], v[220:223]
    buffer_load_dwordx4 v2, s[8:11], s44 offen  lds
    ds_read_b64_tr_b16 a[116:117], v13 offset:8192
    v_mfma_f32_16x16x32_bf16 v[216:219], a[228:231], a[172:175], v[216:219]
    ds_read_b64_tr_b16 a[118:119], v13 offset:9216
    v_mfma_f32_16x16x32_bf16 v[216:219], a[224:227], a[168:171], v[216:219]
    v_mfma_f32_16x16x32_bf16 v[248:251], a[232:235], a[168:171], v[248:251]
    v_mfma_f32_16x16x32_bf16 v[248:251], a[236:239], a[172:175], v[248:251]
    v_mfma_f32_16x16x32_bf16 v[252:255], a[236:239], a[180:183], v[252:255]
    v_mfma_f32_16x16x32_bf16 v[252:255], a[232:235], a[176:179], v[252:255]
    s_waitcnt lgkmcnt(14)
    v_mfma_f32_16x16x32_bf16 v[32:35], a[64:67], a[0:3], v[32:35]
    v_mfma_f32_16x16x32_bf16 v[32:35], a[68:71], a[4:7], v[32:35]
    s_add_u32 m0, s53, 32768
    ds_read_b128 a[16:19], v5 offset:4096
    v_mfma_f32_16x16x32_bf16 v[36:39], a[68:71], a[12:15], v[36:39]
    buffer_load_dwordx4 v2, s[8:11], s45 offen  lds
    v_mfma_f32_16x16x32_bf16 v[36:39], a[64:67], a[8:11], v[36:39]
    ds_read_b128 a[20:23], v6 offset:4096
    v_mfma_f32_16x16x32_bf16 v[100:103], a[72:75], a[8:11], v[100:103]
    v_mfma_f32_16x16x32_bf16 v[100:103], a[76:79], a[12:15], v[100:103]
    ds_read_b128 a[28:31], v6 offset:6144
    v_mfma_f32_16x16x32_bf16 v[96:99], a[76:79], a[4:7], v[96:99]
    v_mfma_f32_16x16x32_bf16 v[96:99], a[72:75], a[0:3], v[96:99]
    ds_read_b128 a[24:27], v5 offset:6144
    v_mfma_f32_16x16x32_bf16 v[160:163], a[80:83], a[0:3], v[160:163]
    v_mfma_f32_16x16x32_bf16 v[160:163], a[84:87], a[4:7], v[160:163]
    ds_read_b128 a[32:35], v5 offset:8192
    v_mfma_f32_16x16x32_bf16 v[164:167], a[84:87], a[12:15], v[164:167]
    s_add_u32 m0, s54, 32768
    v_mfma_f32_16x16x32_bf16 v[164:167], a[80:83], a[8:11], v[164:167]
    buffer_load_dwordx4 v2, s[8:11], s46 offen  lds
    ds_read_b128 a[36:39], v6 offset:8192
    v_mfma_f32_16x16x32_bf16 v[68:71], a[88:91], a[8:11], v[68:71]
    s_waitcnt lgkmcnt(14)
    v_mfma_f32_16x16x32_bf16 v[68:71], a[92:95], a[12:15], v[68:71]
    ds_read_b128 a[44:47], v6 offset:10240
    v_mfma_f32_16x16x32_bf16 v[64:67], a[92:95], a[4:7], v[64:67]
    v_mfma_f32_16x16x32_bf16 v[64:67], a[88:91], a[0:3], v[64:67]
    ds_read_b128 a[40:43], v5 offset:10240
    v_mfma_f32_16x16x32_bf16 v[128:131], a[96:99], a[0:3], v[128:131]
    v_mfma_f32_16x16x32_bf16 v[128:131], a[100:103], a[4:7], v[128:131]
    ds_read_b128 a[48:51], v5 offset:12288
    v_mfma_f32_16x16x32_bf16 v[132:135], a[100:103], a[12:15], v[132:135]
    s_add_u32 m0, s55, 32768
    v_mfma_f32_16x16x32_bf16 v[132:135], a[96:99], a[8:11], v[132:135]
    buffer_load_dwordx4 v2, s[8:11], s47 offen  lds
    ds_read_b128 a[52:55], v6 offset:12288
    s_waitcnt lgkmcnt(14)
    v_mfma_f32_16x16x32_bf16 v[196:199], a[104:107], a[8:11], v[196:199]
    v_add_u32 v2, 458752, v2
    v_mfma_f32_16x16x32_bf16 v[196:199], a[108:111], a[12:15], v[196:199]
    ds_read_b128 a[60:63], v6 offset:14336
    v_mfma_f32_16x16x32_bf16 v[192:195], a[108:111], a[4:7], v[192:195]
    v_mfma_f32_16x16x32_bf16 v[192:195], a[104:107], a[0:3], v[192:195]
    ds_read_b128 a[56:59], v5 offset:14336
    s_waitcnt lgkmcnt(14)
    v_mfma_f32_16x16x32_bf16 v[224:227], a[112:115], a[0:3], v[224:227]
    s_waitcnt lgkmcnt(12)
    v_mfma_f32_16x16x32_bf16 v[224:227], a[116:119], a[4:7], v[224:227]
    v_mfma_f32_16x16x32_bf16 v[228:231], a[116:119], a[12:15], v[228:231]
    s_add_u32 m0, s34, 97024
    v_mfma_f32_16x16x32_bf16 v[228:231], a[112:115], a[8:11], v[228:231]
    buffer_load_dwordx4 v1, s[4:7], s26 offen offset:1280 lds
    s_waitcnt lgkmcnt(11)
    v_mfma_f32_16x16x32_bf16 v[40:43], a[64:67], a[16:19], v[40:43]
    s_waitcnt lgkmcnt(10)
    v_mfma_f32_16x16x32_bf16 v[40:43], a[68:71], a[20:23], v[40:43]
    s_waitcnt lgkmcnt(9)
    v_mfma_f32_16x16x32_bf16 v[44:47], a[68:71], a[28:31], v[44:47]
    s_waitcnt lgkmcnt(8)
    v_mfma_f32_16x16x32_bf16 v[44:47], a[64:67], a[24:27], v[44:47]
    v_mfma_f32_16x16x32_bf16 v[108:111], a[72:75], a[24:27], v[108:111]
    v_mfma_f32_16x16x32_bf16 v[108:111], a[76:79], a[28:31], v[108:111]
    s_add_u32 m0, s35, 97024
    v_mfma_f32_16x16x32_bf16 v[104:107], a[76:79], a[20:23], v[104:107]
    buffer_load_dwordx4 v1, s[4:7], s27 offen offset:1280 lds
    v_mfma_f32_16x16x32_bf16 v[104:107], a[72:75], a[16:19], v[104:107]
    v_mfma_f32_16x16x32_bf16 v[168:171], a[80:83], a[16:19], v[168:171]
    v_mfma_f32_16x16x32_bf16 v[168:171], a[84:87], a[20:23], v[168:171]
    v_mfma_f32_16x16x32_bf16 v[172:175], a[84:87], a[28:31], v[172:175]
    v_mfma_f32_16x16x32_bf16 v[172:175], a[80:83], a[24:27], v[172:175]
    v_mfma_f32_16x16x32_bf16 v[76:79], a[88:91], a[24:27], v[76:79]
    s_add_u32 m0, s36, 97024
    v_mfma_f32_16x16x32_bf16 v[76:79], a[92:95], a[28:31], v[76:79]
    buffer_load_dwordx4 v1, s[4:7], s28 offen offset:1280 lds
    v_mfma_f32_16x16x32_bf16 v[72:75], a[92:95], a[20:23], v[72:75]
    v_mfma_f32_16x16x32_bf16 v[72:75], a[88:91], a[16:19], v[72:75]
    v_mfma_f32_16x16x32_bf16 v[136:139], a[96:99], a[16:19], v[136:139]
    v_mfma_f32_16x16x32_bf16 v[136:139], a[100:103], a[20:23], v[136:139]
    v_mfma_f32_16x16x32_bf16 v[140:143], a[100:103], a[28:31], v[140:143]
    s_add_u32 m0, s37, 97024
    v_mfma_f32_16x16x32_bf16 v[140:143], a[96:99], a[24:27], v[140:143]
    buffer_load_dwordx4 v1, s[4:7], s29 offen offset:1280 lds
    v_mfma_f32_16x16x32_bf16 v[204:207], a[104:107], a[24:27], v[204:207]
    v_mfma_f32_16x16x32_bf16 v[204:207], a[108:111], a[28:31], v[204:207]
    v_mfma_f32_16x16x32_bf16 v[200:203], a[108:111], a[20:23], v[200:203]
    v_mfma_f32_16x16x32_bf16 v[200:203], a[104:107], a[16:19], v[200:203]
    v_mfma_f32_16x16x32_bf16 v[232:235], a[112:115], a[16:19], v[232:235]
    s_add_u32 m0, s38, 97024
    v_mfma_f32_16x16x32_bf16 v[232:235], a[116:119], a[20:23], v[232:235]
    buffer_load_dwordx4 v1, s[4:7], s30 offen offset:1280 lds
    v_mfma_f32_16x16x32_bf16 v[236:239], a[116:119], a[28:31], v[236:239]
    v_mfma_f32_16x16x32_bf16 v[236:239], a[112:115], a[24:27], v[236:239]
    s_waitcnt lgkmcnt(7)
    v_mfma_f32_16x16x32_bf16 v[48:51], a[64:67], a[32:35], v[48:51]
    s_waitcnt lgkmcnt(6)
    v_mfma_f32_16x16x32_bf16 v[48:51], a[68:71], a[36:39], v[48:51]
    s_add_u32 m0, s39, 97024
    s_waitcnt lgkmcnt(5)
    v_mfma_f32_16x16x32_bf16 v[52:55], a[68:71], a[44:47], v[52:55]
    buffer_load_dwordx4 v1, s[4:7], s31 offen offset:1280 lds
    s_waitcnt lgkmcnt(4)
    v_mfma_f32_16x16x32_bf16 v[52:55], a[64:67], a[40:43], v[52:55]
    s_waitcnt vmcnt(6) lgkmcnt(0)
    s_barrier
    v_mfma_f32_16x16x32_bf16 v[116:119], a[72:75], a[40:43], v[116:119]
    s_add_u32 m0, s32, 129664
    ds_read_b128 a[120:123], v3 offset:0
    v_mfma_f32_16x16x32_bf16 v[116:119], a[76:79], a[44:47], v[116:119]
    buffer_load_dwordx4 v1, s[4:7], s24 offen offset:1408 lds
    ds_read_b64_tr_b16 a[184:185], v7 offset:32768
    v_mfma_f32_16x16x32_bf16 v[112:115], a[76:79], a[36:39], v[112:115]
    s_add_u32 m0, s33, 129664
    v_mfma_f32_16x16x32_bf16 v[112:115], a[72:75], a[32:35], v[112:115]
    buffer_load_dwordx4 v1, s[4:7], s25 offen offset:1408 lds
    ds_read_b64_tr_b16 a[186:187], v7 offset:33792
    v_mfma_f32_16x16x32_bf16 v[176:179], a[80:83], a[32:35], v[176:179]
    s_add_u32 m0, s48, 0
    ds_read_b128 a[124:127], v4 offset:0
    v_mfma_f32_16x16x32_bf16 v[176:179], a[84:87], a[36:39], v[176:179]
    buffer_load_dwordx4 v2, s[8:11], s40 offen nt lds
    v_mfma_f32_16x16x32_bf16 v[180:183], a[84:87], a[44:47], v[180:183]
    ds_read_b64_tr_b16 a[188:189], v7 offset:40960
    v_mfma_f32_16x16x32_bf16 v[180:183], a[80:83], a[40:43], v[180:183]
    ds_read_b64_tr_b16 a[190:191], v7 offset:41984
    v_mfma_f32_16x16x32_bf16 v[84:87], a[88:91], a[40:43], v[84:87]
    v_mfma_f32_16x16x32_bf16 v[84:87], a[92:95], a[44:47], v[84:87]
    ds_read_b128 a[132:135], v4 offset:2048
    v_mfma_f32_16x16x32_bf16 v[80:83], a[92:95], a[36:39], v[80:83]
    ds_read_b128 a[128:131], v3 offset:2048
    v_mfma_f32_16x16x32_bf16 v[80:83], a[88:91], a[32:35], v[80:83]
    v_mfma_f32_16x16x32_bf16 v[144:147], a[96:99], a[32:35], v[144:147]
    ds_read_b64_tr_b16 a[192:193], v8 offset:32768
    v_mfma_f32_16x16x32_bf16 v[144:147], a[100:103], a[36:39], v[144:147]
    ds_read_b64_tr_b16 a[194:195], v8 offset:33792
    v_mfma_f32_16x16x32_bf16 v[148:151], a[100:103], a[44:47], v[148:151]
    v_mfma_f32_16x16x32_bf16 v[148:151], a[96:99], a[40:43], v[148:151]
    s_add_u32 m0, s49, 0
    ds_read_b64_tr_b16 a[196:197], v8 offset:40960
    v_mfma_f32_16x16x32_bf16 v[212:215], a[104:107], a[40:43], v[212:215]
    buffer_load_dwordx4 v2, s[8:11], s41 offen nt lds
    ds_read_b64_tr_b16 a[198:199], v8 offset:41984
    v_mfma_f32_16x16x32_bf16 v[212:215], a[108:111], a[44:47], v[212:215]
    v_mfma_f32_16x16x32_bf16 v[208:211], a[108:111], a[36:39], v[208:211]
    ds_read_b64_tr_b16 a[200:201], v9 offset:32768
    v_mfma_f32_16x16x32_bf16 v[208:211], a[104:107], a[32:35], v[208:211]
    ds_read_b64_tr_b16 a[202:203], v9 offset:33792
    v_mfma_f32_16x16x32_bf16 v[240:243], a[112:115], a[32:35], v[240:243]
    v_mfma_f32_16x16x32_bf16 v[240:243], a[116:119], a[36:39], v[240:243]
    ds_read_b64_tr_b16 a[204:205], v9 offset:40960
    v_mfma_f32_16x16x32_bf16 v[244:247], a[116:119], a[44:47], v[244:247]
    ds_read_b64_tr_b16 a[206:207], v9 offset:41984
    v_mfma_f32_16x16x32_bf16 v[244:247], a[112:115], a[40:43], v[244:247]
    v_mfma_f32_16x16x32_bf16 v[56:59], a[64:67], a[48:51], v[56:59]
    ds_read_b64_tr_b16 a[208:209], v10 offset:32768
    v_mfma_f32_16x16x32_bf16 v[56:59], a[68:71], a[52:55], v[56:59]
    s_add_u32 m0, s50, 0
    ds_read_b64_tr_b16 a[210:211], v10 offset:33792
    v_mfma_f32_16x16x32_bf16 v[60:63], a[68:71], a[60:63], v[60:63]
    buffer_load_dwordx4 v2, s[8:11], s42 offen  lds
    v_mfma_f32_16x16x32_bf16 v[60:63], a[64:67], a[56:59], v[60:63]
    ds_read_b64_tr_b16 a[212:213], v10 offset:40960
    v_mfma_f32_16x16x32_bf16 v[124:127], a[72:75], a[56:59], v[124:127]
    ds_read_b64_tr_b16 a[214:215], v10 offset:41984
    v_mfma_f32_16x16x32_bf16 v[124:127], a[76:79], a[60:63], v[124:127]
    v_mfma_f32_16x16x32_bf16 v[120:123], a[76:79], a[52:55], v[120:123]
    ds_read_b64_tr_b16 a[216:217], v11 offset:32768
    v_mfma_f32_16x16x32_bf16 v[120:123], a[72:75], a[48:51], v[120:123]
    ds_read_b64_tr_b16 a[218:219], v11 offset:33792
    v_mfma_f32_16x16x32_bf16 v[184:187], a[80:83], a[48:51], v[184:187]
    v_mfma_f32_16x16x32_bf16 v[184:187], a[84:87], a[52:55], v[184:187]
    ds_read_b64_tr_b16 a[220:221], v11 offset:40960
    v_mfma_f32_16x16x32_bf16 v[188:191], a[84:87], a[60:63], v[188:191]
    ds_read_b64_tr_b16 a[222:223], v11 offset:41984
    v_mfma_f32_16x16x32_bf16 v[188:191], a[80:83], a[56:59], v[188:191]
    s_add_u32 m0, s51, 0
    v_mfma_f32_16x16x32_bf16 v[92:95], a[88:91], a[56:59], v[92:95]
    buffer_load_dwordx4 v2, s[8:11], s43 offen  lds
    ds_read_b64_tr_b16 a[224:225], v12 offset:32768
    v_mfma_f32_16x16x32_bf16 v[92:95], a[92:95], a[60:63], v[92:95]
    ds_read_b64_tr_b16 a[226:227], v12 offset:33792
    v_mfma_f32_16x16x32_bf16 v[88:91], a[92:95], a[52:55], v[88:91]
    v_mfma_f32_16x16x32_bf16 v[88:91], a[88:91], a[48:51], v[88:91]
    ds_read_b64_tr_b16 a[228:229], v12 offset:40960
    v_mfma_f32_16x16x32_bf16 v[152:155], a[96:99], a[48:51], v[152:155]
    ds_read_b64_tr_b16 a[230:231], v12 offset:41984
    v_mfma_f32_16x16x32_bf16 v[152:155], a[100:103], a[52:55], v[152:155]
    v_mfma_f32_16x16x32_bf16 v[156:159], a[100:103], a[60:63], v[156:159]
    ds_read_b64_tr_b16 a[232:233], v13 offset:32768
    v_mfma_f32_16x16x32_bf16 v[156:159], a[96:99], a[56:59], v[156:159]
    ds_read_b64_tr_b16 a[234:235], v13 offset:33792
    v_mfma_f32_16x16x32_bf16 v[220:223], a[104:107], a[56:59], v[220:223]
    s_add_u32 m0, s52, 0
    v_mfma_f32_16x16x32_bf16 v[220:223], a[108:111], a[60:63], v[220:223]
    buffer_load_dwordx4 v2, s[8:11], s44 offen  lds
    ds_read_b64_tr_b16 a[236:237], v13 offset:40960
    v_mfma_f32_16x16x32_bf16 v[216:219], a[108:111], a[52:55], v[216:219]
    ds_read_b64_tr_b16 a[238:239], v13 offset:41984
    v_mfma_f32_16x16x32_bf16 v[216:219], a[104:107], a[48:51], v[216:219]
    v_mfma_f32_16x16x32_bf16 v[248:251], a[112:115], a[48:51], v[248:251]
    v_mfma_f32_16x16x32_bf16 v[248:251], a[116:119], a[52:55], v[248:251]
    v_mfma_f32_16x16x32_bf16 v[252:255], a[116:119], a[60:63], v[252:255]
    v_mfma_f32_16x16x32_bf16 v[252:255], a[112:115], a[56:59], v[252:255]
    s_waitcnt lgkmcnt(14)
    v_mfma_f32_16x16x32_bf16 v[32:35], a[184:187], a[120:123], v[32:35]
    v_mfma_f32_16x16x32_bf16 v[32:35], a[188:191], a[124:127], v[32:35]
    s_add_u32 m0, s53, 0
    ds_read_b128 a[136:139], v3 offset:4096
    v_mfma_f32_16x16x32_bf16 v[36:39], a[188:191], a[132:135], v[36:39]
    buffer_load_dwordx4 v2, s[8:11], s45 offen  lds
    v_mfma_f32_16x16x32_bf16 v[36:39], a[184:187], a[128:131], v[36:39]
    ds_read_b128 a[140:143], v4 offset:4096
    v_mfma_f32_16x16x32_bf16 v[100:103], a[192:195], a[128:131], v[100:103]
    v_mfma_f32_16x16x32_bf16 v[100:103], a[196:199], a[132:135], v[100:103]
    ds_read_b128 a[148:151], v4 offset:6144
    v_mfma_f32_16x16x32_bf16 v[96:99], a[196:199], a[124:127], v[96:99]
    v_mfma_f32_16x16x32_bf16 v[96:99], a[192:195], a[120:123], v[96:99]
    ds_read_b128 a[144:147], v3 offset:6144
    v_mfma_f32_16x16x32_bf16 v[160:163], a[200:203], a[120:123], v[160:163]
    v_mfma_f32_16x16x32_bf16 v[160:163], a[204:207], a[124:127], v[160:163]
    ds_read_b128 a[152:155], v3 offset:8192
    v_mfma_f32_16x16x32_bf16 v[164:167], a[204:207], a[132:135], v[164:167]
    s_add_u32 m0, s54, 0
    v_mfma_f32_16x16x32_bf16 v[164:167], a[200:203], a[128:131], v[164:167]
    buffer_load_dwordx4 v2, s[8:11], s46 offen  lds
    ds_read_b128 a[156:159], v4 offset:8192
    v_mfma_f32_16x16x32_bf16 v[68:71], a[208:211], a[128:131], v[68:71]
    s_waitcnt lgkmcnt(14)
    v_mfma_f32_16x16x32_bf16 v[68:71], a[212:215], a[132:135], v[68:71]
    ds_read_b128 a[164:167], v4 offset:10240
    v_mfma_f32_16x16x32_bf16 v[64:67], a[212:215], a[124:127], v[64:67]
    v_mfma_f32_16x16x32_bf16 v[64:67], a[208:211], a[120:123], v[64:67]
    ds_read_b128 a[160:163], v3 offset:10240
    v_mfma_f32_16x16x32_bf16 v[128:131], a[216:219], a[120:123], v[128:131]
    v_mfma_f32_16x16x32_bf16 v[128:131], a[220:223], a[124:127], v[128:131]
    ds_read_b128 a[168:171], v3 offset:12288
    v_mfma_f32_16x16x32_bf16 v[132:135], a[220:223], a[132:135], v[132:135]
    s_add_u32 m0, s55, 0
    v_mfma_f32_16x16x32_bf16 v[132:135], a[216:219], a[128:131], v[132:135]
    buffer_load_dwordx4 v2, s[8:11], s47 offen  lds
    ds_read_b128 a[172:175], v4 offset:12288
    s_waitcnt lgkmcnt(14)
    v_mfma_f32_16x16x32_bf16 v[196:199], a[224:227], a[128:131], v[196:199]
    v_add_u32 v2, 458752, v2
    v_mfma_f32_16x16x32_bf16 v[196:199], a[228:231], a[132:135], v[196:199]
    ds_read_b128 a[180:183], v4 offset:14336
    v_mfma_f32_16x16x32_bf16 v[192:195], a[228:231], a[124:127], v[192:195]
    v_mfma_f32_16x16x32_bf16 v[192:195], a[224:227], a[120:123], v[192:195]
    ds_read_b128 a[176:179], v3 offset:14336
    s_waitcnt lgkmcnt(14)
    v_mfma_f32_16x16x32_bf16 v[224:227], a[232:235], a[120:123], v[224:227]
    s_waitcnt lgkmcnt(12)
    v_mfma_f32_16x16x32_bf16 v[224:227], a[236:239], a[124:127], v[224:227]
    v_mfma_f32_16x16x32_bf16 v[228:231], a[236:239], a[132:135], v[228:231]
    s_add_u32 m0, s34, 129664
    v_mfma_f32_16x16x32_bf16 v[228:231], a[232:235], a[128:131], v[228:231]
    buffer_load_dwordx4 v1, s[4:7], s26 offen offset:1408 lds
    s_waitcnt lgkmcnt(11)
    v_mfma_f32_16x16x32_bf16 v[40:43], a[184:187], a[136:139], v[40:43]
    s_waitcnt lgkmcnt(10)
    v_mfma_f32_16x16x32_bf16 v[40:43], a[188:191], a[140:143], v[40:43]
    s_waitcnt lgkmcnt(9)
    v_mfma_f32_16x16x32_bf16 v[44:47], a[188:191], a[148:151], v[44:47]
    s_waitcnt lgkmcnt(8)
    v_mfma_f32_16x16x32_bf16 v[44:47], a[184:187], a[144:147], v[44:47]
    v_mfma_f32_16x16x32_bf16 v[108:111], a[192:195], a[144:147], v[108:111]
    v_mfma_f32_16x16x32_bf16 v[108:111], a[196:199], a[148:151], v[108:111]
    s_add_u32 m0, s35, 129664
    v_mfma_f32_16x16x32_bf16 v[104:107], a[196:199], a[140:143], v[104:107]
    buffer_load_dwordx4 v1, s[4:7], s27 offen offset:1408 lds
    v_mfma_f32_16x16x32_bf16 v[104:107], a[192:195], a[136:139], v[104:107]
    v_mfma_f32_16x16x32_bf16 v[168:171], a[200:203], a[136:139], v[168:171]
    v_mfma_f32_16x16x32_bf16 v[168:171], a[204:207], a[140:143], v[168:171]
    v_mfma_f32_16x16x32_bf16 v[172:175], a[204:207], a[148:151], v[172:175]
    v_mfma_f32_16x16x32_bf16 v[172:175], a[200:203], a[144:147], v[172:175]
    v_mfma_f32_16x16x32_bf16 v[76:79], a[208:211], a[144:147], v[76:79]
    s_add_u32 m0, s36, 129664
    v_mfma_f32_16x16x32_bf16 v[76:79], a[212:215], a[148:151], v[76:79]
    buffer_load_dwordx4 v1, s[4:7], s28 offen offset:1408 lds
    v_mfma_f32_16x16x32_bf16 v[72:75], a[212:215], a[140:143], v[72:75]
    v_mfma_f32_16x16x32_bf16 v[72:75], a[208:211], a[136:139], v[72:75]
    v_mfma_f32_16x16x32_bf16 v[136:139], a[216:219], a[136:139], v[136:139]
    v_mfma_f32_16x16x32_bf16 v[136:139], a[220:223], a[140:143], v[136:139]
    v_mfma_f32_16x16x32_bf16 v[140:143], a[220:223], a[148:151], v[140:143]
    s_add_u32 m0, s37, 129664
    v_mfma_f32_16x16x32_bf16 v[140:143], a[216:219], a[144:147], v[140:143]
    buffer_load_dwordx4 v1, s[4:7], s29 offen offset:1408 lds
    v_mfma_f32_16x16x32_bf16 v[204:207], a[224:227], a[144:147], v[204:207]
    v_mfma_f32_16x16x32_bf16 v[204:207], a[228:231], a[148:151], v[204:207]
    v_mfma_f32_16x16x32_bf16 v[200:203], a[228:231], a[140:143], v[200:203]
    v_mfma_f32_16x16x32_bf16 v[200:203], a[224:227], a[136:139], v[200:203]
    v_mfma_f32_16x16x32_bf16 v[232:235], a[232:235], a[136:139], v[232:235]
    s_add_u32 m0, s38, 129664
    v_mfma_f32_16x16x32_bf16 v[232:235], a[236:239], a[140:143], v[232:235]
    buffer_load_dwordx4 v1, s[4:7], s30 offen offset:1408 lds
    v_mfma_f32_16x16x32_bf16 v[236:239], a[236:239], a[148:151], v[236:239]
    v_mfma_f32_16x16x32_bf16 v[236:239], a[232:235], a[144:147], v[236:239]
    s_waitcnt lgkmcnt(7)
    v_mfma_f32_16x16x32_bf16 v[48:51], a[184:187], a[152:155], v[48:51]
    s_waitcnt lgkmcnt(6)
    v_mfma_f32_16x16x32_bf16 v[48:51], a[188:191], a[156:159], v[48:51]
    s_add_u32 m0, s39, 129664
    s_waitcnt lgkmcnt(5)
    v_mfma_f32_16x16x32_bf16 v[52:55], a[188:191], a[164:167], v[52:55]
    buffer_load_dwordx4 v1, s[4:7], s31 offen offset:1408 lds
    s_waitcnt lgkmcnt(4)
    v_mfma_f32_16x16x32_bf16 v[52:55], a[184:187], a[160:163], v[52:55]
    s_waitcnt vmcnt(6) lgkmcnt(0)
    s_barrier
    v_mfma_f32_16x16x32_bf16 v[116:119], a[192:195], a[160:163], v[116:119]
    s_add_u32 m0, s32, 64000
    ds_read_b128 a[0:3], v3 offset:32768
    v_mfma_f32_16x16x32_bf16 v[116:119], a[196:199], a[164:167], v[116:119]
    buffer_load_dwordx4 v1, s[4:7], s24 offen offset:1536 lds
    ds_read_b64_tr_b16 a[64:65], v7 offset:0
    v_mfma_f32_16x16x32_bf16 v[112:115], a[196:199], a[156:159], v[112:115]
    s_add_u32 m0, s33, 64000
    v_mfma_f32_16x16x32_bf16 v[112:115], a[192:195], a[152:155], v[112:115]
    buffer_load_dwordx4 v1, s[4:7], s25 offen offset:1536 lds
    ds_read_b64_tr_b16 a[66:67], v7 offset:1024
    v_mfma_f32_16x16x32_bf16 v[176:179], a[200:203], a[152:155], v[176:179]
    s_add_u32 m0, s48, 32768
    ds_read_b128 a[4:7], v4 offset:32768
    v_mfma_f32_16x16x32_bf16 v[176:179], a[204:207], a[156:159], v[176:179]
    buffer_load_dwordx4 v2, s[8:11], s40 offen nt lds
    v_mfma_f32_16x16x32_bf16 v[180:183], a[204:207], a[164:167], v[180:183]
    ds_read_b64_tr_b16 a[68:69], v7 offset:8192
    v_mfma_f32_16x16x32_bf16 v[180:183], a[200:203], a[160:163], v[180:183]
    ds_read_b64_tr_b16 a[70:71], v7 offset:9216
    v_mfma_f32_16x16x32_bf16 v[84:87], a[208:211], a[160:163], v[84:87]
    v_mfma_f32_16x16x32_bf16 v[84:87], a[212:215], a[164:167], v[84:87]
    ds_read_b128 a[12:15], v4 offset:34816
    v_mfma_f32_16x16x32_bf16 v[80:83], a[212:215], a[156:159], v[80:83]
    ds_read_b128 a[8:11], v3 offset:34816
    v_mfma_f32_16x16x32_bf16 v[80:83], a[208:211], a[152:155], v[80:83]
    v_mfma_f32_16x16x32_bf16 v[144:147], a[216:219], a[152:155], v[144:147]
    ds_read_b64_tr_b16 a[72:73], v8 offset:0
    v_mfma_f32_16x16x32_bf16 v[144:147], a[220:223], a[156:159], v[144:147]
    ds_read_b64_tr_b16 a[74:75], v8 offset:1024
    v_mfma_f32_16x16x32_bf16 v[148:151], a[220:223], a[164:167], v[148:151]
    v_mfma_f32_16x16x32_bf16 v[148:151], a[216:219], a[160:163], v[148:151]
    s_add_u32 m0, s49, 32768
    ds_read_b64_tr_b16 a[76:77], v8 offset:8192
    v_mfma_f32_16x16x32_bf16 v[212:215], a[224:227], a[160:163], v[212:215]
    buffer_load_dwordx4 v2, s[8:11], s41 offen nt lds
    ds_read_b64_tr_b16 a[78:79], v8 offset:9216
    v_mfma_f32_16x16x32_bf16 v[212:215], a[228:231], a[164:167], v[212:215]
    v_mfma_f32_16x16x32_bf16 v[208:211], a[228:231], a[156:159], v[208:211]
    ds_read_b64_tr_b16 a[80:81], v9 offset:0
    v_mfma_f32_16x16x32_bf16 v[208:211], a[224:227], a[152:155], v[208:211]
    ds_read_b64_tr_b16 a[82:83], v9 offset:1024
    v_mfma_f32_16x16x32_bf16 v[240:243], a[232:235], a[152:155], v[240:243]
    v_mfma_f32_16x16x32_bf16 v[240:243], a[236:239], a[156:159], v[240:243]
    ds_read_b64_tr_b16 a[84:85], v9 offset:8192
    v_mfma_f32_16x16x32_bf16 v[244:247], a[236:239], a[164:167], v[244:247]
    ds_read_b64_tr_b16 a[86:87], v9 offset:9216
    v_mfma_f32_16x16x32_bf16 v[244:247], a[232:235], a[160:163], v[244:247]
    v_mfma_f32_16x16x32_bf16 v[56:59], a[184:187], a[168:171], v[56:59]
    ds_read_b64_tr_b16 a[88:89], v10 offset:0
    v_mfma_f32_16x16x32_bf16 v[56:59], a[188:191], a[172:175], v[56:59]
    s_add_u32 m0, s50, 32768
    ds_read_b64_tr_b16 a[90:91], v10 offset:1024
    v_mfma_f32_16x16x32_bf16 v[60:63], a[188:191], a[180:183], v[60:63]
    buffer_load_dwordx4 v2, s[8:11], s42 offen  lds
    v_mfma_f32_16x16x32_bf16 v[60:63], a[184:187], a[176:179], v[60:63]
    ds_read_b64_tr_b16 a[92:93], v10 offset:8192
    v_mfma_f32_16x16x32_bf16 v[124:127], a[192:195], a[176:179], v[124:127]
    ds_read_b64_tr_b16 a[94:95], v10 offset:9216
    v_mfma_f32_16x16x32_bf16 v[124:127], a[196:199], a[180:183], v[124:127]
    v_mfma_f32_16x16x32_bf16 v[120:123], a[196:199], a[172:175], v[120:123]
    ds_read_b64_tr_b16 a[96:97], v11 offset:0
    v_mfma_f32_16x16x32_bf16 v[120:123], a[192:195], a[168:171], v[120:123]
    ds_read_b64_tr_b16 a[98:99], v11 offset:1024
    v_mfma_f32_16x16x32_bf16 v[184:187], a[200:203], a[168:171], v[184:187]
    v_mfma_f32_16x16x32_bf16 v[184:187], a[204:207], a[172:175], v[184:187]
    ds_read_b64_tr_b16 a[100:101], v11 offset:8192
    v_mfma_f32_16x16x32_bf16 v[188:191], a[204:207], a[180:183], v[188:191]
    ds_read_b64_tr_b16 a[102:103], v11 offset:9216
    v_mfma_f32_16x16x32_bf16 v[188:191], a[200:203], a[176:179], v[188:191]
    s_add_u32 m0, s51, 32768
    v_mfma_f32_16x16x32_bf16 v[92:95], a[208:211], a[176:179], v[92:95]
    buffer_load_dwordx4 v2, s[8:11], s43 offen  lds
    ds_read_b64_tr_b16 a[104:105], v12 offset:0
    v_mfma_f32_16x16x32_bf16 v[92:95], a[212:215], a[180:183], v[92:95]
    ds_read_b64_tr_b16 a[106:107], v12 offset:1024
    v_mfma_f32_16x16x32_bf16 v[88:91], a[212:215], a[172:175], v[88:91]
    v_mfma_f32_16x16x32_bf16 v[88:91], a[208:211], a[168:171], v[88:91]
    ds_read_b64_tr_b16 a[108:109], v12 offset:8192
    v_mfma_f32_16x16x32_bf16 v[152:155], a[216:219], a[168:171], v[152:155]
    ds_read_b64_tr_b16 a[110:111], v12 offset:9216
    v_mfma_f32_16x16x32_bf16 v[152:155], a[220:223], a[172:175], v[152:155]
    v_mfma_f32_16x16x32_bf16 v[156:159], a[220:223], a[180:183], v[156:159]
    ds_read_b64_tr_b16 a[112:113], v13 offset:0
    v_mfma_f32_16x16x32_bf16 v[156:159], a[216:219], a[176:179], v[156:159]
    ds_read_b64_tr_b16 a[114:115], v13 offset:1024
    v_mfma_f32_16x16x32_bf16 v[220:223], a[224:227], a[176:179], v[220:223]
    s_add_u32 m0, s52, 32768
    v_mfma_f32_16x16x32_bf16 v[220:223], a[228:231], a[180:183], v[220:223]
    buffer_load_dwordx4 v2, s[8:11], s44 offen  lds
    ds_read_b64_tr_b16 a[116:117], v13 offset:8192
    v_mfma_f32_16x16x32_bf16 v[216:219], a[228:231], a[172:175], v[216:219]
    ds_read_b64_tr_b16 a[118:119], v13 offset:9216
    v_mfma_f32_16x16x32_bf16 v[216:219], a[224:227], a[168:171], v[216:219]
    v_mfma_f32_16x16x32_bf16 v[248:251], a[232:235], a[168:171], v[248:251]
    v_mfma_f32_16x16x32_bf16 v[248:251], a[236:239], a[172:175], v[248:251]
    v_mfma_f32_16x16x32_bf16 v[252:255], a[236:239], a[180:183], v[252:255]
    v_mfma_f32_16x16x32_bf16 v[252:255], a[232:235], a[176:179], v[252:255]
    s_waitcnt lgkmcnt(14)
    v_mfma_f32_16x16x32_bf16 v[32:35], a[64:67], a[0:3], v[32:35]
    v_mfma_f32_16x16x32_bf16 v[32:35], a[68:71], a[4:7], v[32:35]
    s_add_u32 m0, s53, 32768
    ds_read_b128 a[16:19], v3 offset:36864
    v_mfma_f32_16x16x32_bf16 v[36:39], a[68:71], a[12:15], v[36:39]
    buffer_load_dwordx4 v2, s[8:11], s45 offen  lds
    v_mfma_f32_16x16x32_bf16 v[36:39], a[64:67], a[8:11], v[36:39]
    ds_read_b128 a[20:23], v4 offset:36864
    v_mfma_f32_16x16x32_bf16 v[100:103], a[72:75], a[8:11], v[100:103]
    v_mfma_f32_16x16x32_bf16 v[100:103], a[76:79], a[12:15], v[100:103]
    ds_read_b128 a[28:31], v4 offset:38912
    v_mfma_f32_16x16x32_bf16 v[96:99], a[76:79], a[4:7], v[96:99]
    v_mfma_f32_16x16x32_bf16 v[96:99], a[72:75], a[0:3], v[96:99]
    ds_read_b128 a[24:27], v3 offset:38912
    v_mfma_f32_16x16x32_bf16 v[160:163], a[80:83], a[0:3], v[160:163]
    v_mfma_f32_16x16x32_bf16 v[160:163], a[84:87], a[4:7], v[160:163]
    ds_read_b128 a[32:35], v3 offset:40960
    v_mfma_f32_16x16x32_bf16 v[164:167], a[84:87], a[12:15], v[164:167]
    s_add_u32 m0, s54, 32768
    v_mfma_f32_16x16x32_bf16 v[164:167], a[80:83], a[8:11], v[164:167]
    buffer_load_dwordx4 v2, s[8:11], s46 offen  lds
    ds_read_b128 a[36:39], v4 offset:40960
    v_mfma_f32_16x16x32_bf16 v[68:71], a[88:91], a[8:11], v[68:71]
    s_waitcnt lgkmcnt(14)
    v_mfma_f32_16x16x32_bf16 v[68:71], a[92:95], a[12:15], v[68:71]
    ds_read_b128 a[44:47], v4 offset:43008
    v_mfma_f32_16x16x32_bf16 v[64:67], a[92:95], a[4:7], v[64:67]
    v_mfma_f32_16x16x32_bf16 v[64:67], a[88:91], a[0:3], v[64:67]
    ds_read_b128 a[40:43], v3 offset:43008
    v_mfma_f32_16x16x32_bf16 v[128:131], a[96:99], a[0:3], v[128:131]
    v_mfma_f32_16x16x32_bf16 v[128:131], a[100:103], a[4:7], v[128:131]
    ds_read_b128 a[48:51], v3 offset:45056
    v_mfma_f32_16x16x32_bf16 v[132:135], a[100:103], a[12:15], v[132:135]
    s_add_u32 m0, s55, 32768
    v_mfma_f32_16x16x32_bf16 v[132:135], a[96:99], a[8:11], v[132:135]
    buffer_load_dwordx4 v2, s[8:11], s47 offen  lds
    ds_read_b128 a[52:55], v4 offset:45056
    s_waitcnt lgkmcnt(14)
    v_mfma_f32_16x16x32_bf16 v[196:199], a[104:107], a[8:11], v[196:199]
    v_add_u32 v2, 458752, v2
    v_mfma_f32_16x16x32_bf16 v[196:199], a[108:111], a[12:15], v[196:199]
    ds_read_b128 a[60:63], v4 offset:47104
    v_mfma_f32_16x16x32_bf16 v[192:195], a[108:111], a[4:7], v[192:195]
    v_mfma_f32_16x16x32_bf16 v[192:195], a[104:107], a[0:3], v[192:195]
    ds_read_b128 a[56:59], v3 offset:47104
    s_waitcnt lgkmcnt(14)
    v_mfma_f32_16x16x32_bf16 v[224:227], a[112:115], a[0:3], v[224:227]
L_pad4:
    s_cbranch_execz L_pad8
    s_waitcnt lgkmcnt(12)
    v_mfma_f32_16x16x32_bf16 v[224:227], a[116:119], a[4:7], v[224:227]
    v_mfma_f32_16x16x32_bf16 v[228:231], a[116:119], a[12:15], v[228:231]
    s_add_u32 m0, s34, 64000
    v_mfma_f32_16x16x32_bf16 v[228:231], a[112:115], a[8:11], v[228:231]
    buffer_load_dwordx4 v1, s[4:7], s26 offen offset:1536 lds
    s_waitcnt lgkmcnt(11)
    v_mfma_f32_16x16x32_bf16 v[40:43], a[64:67], a[16:19], v[40:43]
    s_waitcnt lgkmcnt(10)
    v_mfma_f32_16x16x32_bf16 v[40:43], a[68:71], a[20:23], v[40:43]
    s_waitcnt lgkmcnt(9)
    v_mfma_f32_16x16x32_bf16 v[44:47], a[68:71], a[28:31], v[44:47]
    s_waitcnt lgkmcnt(8)
    v_mfma_f32_16x16x32_bf16 v[44:47], a[64:67], a[24:27], v[44:47]
    v_mfma_f32_16x16x32_bf16 v[108:111], a[72:75], a[24:27], v[108:111]
    v_mfma_f32_16x16x32_bf16 v[108:111], a[76:79], a[28:31], v[108:111]
    s_add_u32 m0, s35, 64000
    v_mfma_f32_16x16x32_bf16 v[104:107], a[76:79], a[20:23], v[104:107]
    buffer_load_dwordx4 v1, s[4:7], s27 offen offset:1536 lds
    v_mfma_f32_16x16x32_bf16 v[104:107], a[72:75], a[16:19], v[104:107]
    v_mfma_f32_16x16x32_bf16 v[168:171], a[80:83], a[16:19], v[168:171]
    v_mfma_f32_16x16x32_bf16 v[168:171], a[84:87], a[20:23], v[168:171]
    v_mfma_f32_16x16x32_bf16 v[172:175], a[84:87], a[28:31], v[172:175]
    v_mfma_f32_16x16x32_bf16 v[172:175], a[80:83], a[24:27], v[172:175]
    v_mfma_f32_16x16x32_bf16 v[76:79], a[88:91], a[24:27], v[76:79]
    s_add_u32 m0, s36, 64000
    v_mfma_f32_16x16x32_bf16 v[76:79], a[92:95], a[28:31], v[76:79]
    buffer_load_dwordx4 v1, s[4:7], s28 offen offset:1536 lds
    v_mfma_f32_16x16x32_bf16 v[72:75], a[92:95], a[20:23], v[72:75]
    v_mfma_f32_16x16x32_bf16 v[72:75], a[88:91], a[16:19], v[72:75]
    v_mfma_f32_16x16x32_bf16 v[136:139], a[96:99], a[16:19], v[136:139]
    v_mfma_f32_16x16x32_bf16 v[136:139], a[100:103], a[20:23], v[136:139]
    v_mfma_f32_16x16x32_bf16 v[140:143], a[100:103], a[28:31], v[140:143]
    s_add_u32 m0, s37, 64000
    v_mfma_f32_16x16x32_bf16 v[140:143], a[96:99], a[24:27], v[140:143]
    buffer_load_dwordx4 v1, s[4:7], s29 offen offset:1536 lds
    v_mfma_f32_16x16x32_bf16 v[204:207], a[104:107], a[24:27], v[204:207]
    v_mfma_f32_16x16x32_bf16 v[204:207], a[108:111], a[28:31], v[204:207]
    v_mfma_f32_16x16x32_bf16 v[200:203], a[108:111], a[20:23], v[200:203]
    v_mfma_f32_16x16x32_bf16 v[200:203], a[104:107], a[16:19], v[200:203]
    v_mfma_f32_16x16x32_bf16 v[232:235], a[112:115], a[16:19], v[232:235]
    s_add_u32 m0, s38, 64000
    v_mfma_f32_16x16x32_bf16 v[232:235], a[116:119], a[20:23], v[232:235]
    buffer_load_dwordx4 v1, s[4:7], s30 offen offset:1536 lds
    v_mfma_f32_16x16x32_bf16 v[236:239], a[116:119], a[28:31], v[236:239]
    v_mfma_f32_16x16x32_bf16 v[236:239], a[112:115], a[24:27], v[236:239]
    s_waitcnt lgkmcnt(7)
    v_mfma_f32_16x16x32_bf16 v[48:51], a[64:67], a[32:35], v[48:51]
    s_waitcnt lgkmcnt(6)
    v_mfma_f32_16x16x32_bf16 v[48:51], a[68:71], a[36:39], v[48:51]
    s_add_u32 m0, s39, 64000
    s_waitcnt lgkmcnt(5)
    v_mfma_f32_16x16x32_bf16 v[52:55], a[68:71], a[44:47], v[52:55]
    buffer_load_dwordx4 v1, s[4:7], s31 offen offset:1536 lds
    s_waitcnt lgkmcnt(4)
    v_mfma_f32_16x16x32_bf16 v[52:55], a[64:67], a[40:43], v[52:55]
    s_waitcnt vmcnt(6) lgkmcnt(0)
    s_barrier
    v_mfma_f32_16x16x32_bf16 v[116:119], a[72:75], a[40:43], v[116:119]
    s_add_u32 m0, s32, 96640
    ds_read_b128 a[120:123], v5 offset:0
    v_mfma_f32_16x16x32_bf16 v[116:119], a[76:79], a[44:47], v[116:119]
    buffer_load_dwordx4 v1, s[4:7], s24 offen offset:1664 lds
    ds_read_b64_tr_b16 a[184:185], v7 offset:32768
    v_mfma_f32_16x16x32_bf16 v[112:115], a[76:79], a[36:39], v[112:115]
    s_add_u32 m0, s33, 96640
    v_mfma_f32_16x16x32_bf16 v[112:115], a[72:75], a[32:35], v[112:115]
    buffer_load_dwordx4 v1, s[4:7], s25 offen offset:1664 lds
    ds_read_b64_tr_b16 a[186:187], v7 offset:33792
    v_mfma_f32_16x16x32_bf16 v[176:179], a[80:83], a[32:35], v[176:179]
    s_add_u32 m0, s48, 0
    ds_read_b128 a[124:127], v6 offset:0
    v_mfma_f32_16x16x32_bf16 v[176:179], a[84:87], a[36:39], v[176:179]
    buffer_load_dwordx4 v2, s[8:11], s40 offen nt lds
    v_mfma_f32_16x16x32_bf16 v[180:183], a[84:87], a[44:47], v[180:183]
    ds_read_b64_tr_b16 a[188:189], v7 offset:40960
    v_mfma_f32_16x16x32_bf16 v[180:183], a[80:83], a[40:43], v[180:183]
    ds_read_b64_tr_b16 a[190:191], v7 offset:41984
    v_mfma_f32_16x16x32_bf16 v[84:87], a[88:91], a[40:43], v[84:87]
    v_mfma_f32_16x16x32_bf16 v[84:87], a[92:95], a[44:47], v[84:87]
    buffer_load_dword v26, v29, s[60:63], 0 offen sc1
    ds_read_b128 a[132:135], v6 offset:2048
    v_mfma_f32_16x16x32_bf16 v[80:83], a[92:95], a[36:39], v[80:83]
    ds_read_b128 a[128:131], v5 offset:2048
    v_mfma_f32_16x16x32_bf16 v[80:83], a[88:91], a[32:35], v[80:83]
    v_mfma_f32_16x16x32_bf16 v[144:147], a[96:99], a[32:35], v[144:147]
    ds_read_b64_tr_b16 a[192:193], v8 offset:32768
    v_mfma_f32_16x16x32_bf16 v[144:147], a[100:103], a[36:39], v[144:147]
    ds_read_b64_tr_b16 a[194:195], v8 offset:33792
    v_mfma_f32_16x16x32_bf16 v[148:151], a[100:103], a[44:47], v[148:151]
    v_mfma_f32_16x16x32_bf16 v[148:151], a[96:99], a[40:43], v[148:151]
    s_add_u32 m0, s49, 0
    ds_read_b64_tr_b16 a[196:197], v8 offset:40960
    v_mfma_f32_16x16x32_bf16 v[212:215], a[104:107], a[40:43], v[212:215]
    buffer_load_dwordx4 v2, s[8:11], s41 offen nt lds
    ds_read_b64_tr_b16 a[198:199], v8 offset:41984
    v_mfma_f32_16x16x32_bf16 v[212:215], a[108:111], a[44:47], v[212:215]
    v_mfma_f32_16x16x32_bf16 v[208:211], a[108:111], a[36:39], v[208:211]
    ds_read_b64_tr_b16 a[200:201], v9 offset:32768
    v_mfma_f32_16x16x32_bf16 v[208:211], a[104:107], a[32:35], v[208:211]
    ds_read_b64_tr_b16 a[202:203], v9 offset:33792
    v_mfma_f32_16x16x32_bf16 v[240:243], a[112:115], a[32:35], v[240:243]
    v_mfma_f32_16x16x32_bf16 v[240:243], a[116:119], a[36:39], v[240:243]
    ds_read_b64_tr_b16 a[204:205], v9 offset:40960
    v_mfma_f32_16x16x32_bf16 v[244:247], a[116:119], a[44:47], v[244:247]
    ds_read_b64_tr_b16 a[206:207], v9 offset:41984
    v_mfma_f32_16x16x32_bf16 v[244:247], a[112:115], a[40:43], v[244:247]
    v_mfma_f32_16x16x32_bf16 v[56:59], a[64:67], a[48:51], v[56:59]
    ds_read_b64_tr_b16 a[208:209], v10 offset:32768
    v_mfma_f32_16x16x32_bf16 v[56:59], a[68:71], a[52:55], v[56:59]
    s_add_u32 m0, s50, 0
    ds_read_b64_tr_b16 a[210:211], v10 offset:33792
    v_mfma_f32_16x16x32_bf16 v[60:63], a[68:71], a[60:63], v[60:63]
    buffer_load_dwordx4 v2, s[8:11], s42 offen  lds
    v_mfma_f32_16x16x32_bf16 v[60:63], a[64:67], a[56:59], v[60:63]
    ds_read_b64_tr_b16 a[212:213], v10 offset:40960
    v_mfma_f32_16x16x32_bf16 v[124:127], a[72:75], a[56:59], v[124:127]
    ds_read_b64_tr_b16 a[214:215], v10 offset:41984
    v_mfma_f32_16x16x32_bf16 v[124:127], a[76:79], a[60:63], v[124:127]
    v_mfma_f32_16x16x32_bf16 v[120:123], a[76:79], a[52:55], v[120:123]
    ds_read_b64_tr_b16 a[216:217], v11 offset:32768
    v_mfma_f32_16x16x32_bf16 v[120:123], a[72:75], a[48:51], v[120:123]
    ds_read_b64_tr_b16 a[218:219], v11 offset:33792
    v_mfma_f32_16x16x32_bf16 v[184:187], a[80:83], a[48:51], v[184:187]
    v_mfma_f32_16x16x32_bf16 v[184:187], a[84:87], a[52:55], v[184:187]
    ds_read_b64_tr_b16 a[220:221], v11 offset:40960
    v_mfma_f32_16x16x32_bf16 v[188:191], a[84:87], a[60:63], v[188:191]
    ds_read_b64_tr_b16 a[222:223], v11 offset:41984
    v_mfma_f32_16x16x32_bf16 v[188:191], a[80:83], a[56:59], v[188:191]
    s_add_u32 m0, s51, 0
    v_mfma_f32_16x16x32_bf16 v[92:95], a[88:91], a[56:59], v[92:95]
    buffer_load_dwordx4 v2, s[8:11], s43 offen  lds
    ds_read_b64_tr_b16 a[224:225], v12 offset:32768
    v_mfma_f32_16x16x32_bf16 v[92:95], a[92:95], a[60:63], v[92:95]
    ds_read_b64_tr_b16 a[226:227], v12 offset:33792
    v_mfma_f32_16x16x32_bf16 v[88:91], a[92:95], a[52:55], v[88:91]
    v_mfma_f32_16x16x32_bf16 v[88:91], a[88:91], a[48:51], v[88:91]
    ds_read_b64_tr_b16 a[228:229], v12 offset:40960
    v_mfma_f32_16x16x32_bf16 v[152:155], a[96:99], a[48:51], v[152:155]
    ds_read_b64_tr_b16 a[230:231], v12 offset:41984
    v_mfma_f32_16x16x32_bf16 v[152:155], a[100:103], a[52:55], v[152:155]
    v_mfma_f32_16x16x32_bf16 v[156:159], a[100:103], a[60:63], v[156:159]
    ds_read_b64_tr_b16 a[232:233], v13 offset:32768
    v_mfma_f32_16x16x32_bf16 v[156:159], a[96:99], a[56:59], v[156:159]
    ds_read_b64_tr_b16 a[234:235], v13 offset:33792
    v_mfma_f32_16x16x32_bf16 v[220:223], a[104:107], a[56:59], v[220:223]
    s_add_u32 m0, s52, 0
    v_mfma_f32_16x16x32_bf16 v[220:223], a[108:111], a[60:63], v[220:223]
    buffer_load_dwordx4 v2, s[8:11], s44 offen  lds
    ds_read_b64_tr_b16 a[236:237], v13 offset:40960
    v_mfma_f32_16x16x32_bf16 v[216:219], a[108:111], a[52:55], v[216:219]
    ds_read_b64_tr_b16 a[238:239], v13 offset:41984
    v_mfma_f32_16x16x32_bf16 v[216:219], a[104:107], a[48:51], v[216:219]
    v_mfma_f32_16x16x32_bf16 v[248:251], a[112:115], a[48:51], v[248:251]
    v_mfma_f32_16x16x32_bf16 v[248:251], a[116:119], a[52:55], v[248:251]
    v_mfma_f32_16x16x32_bf16 v[252:255], a[116:119], a[60:63], v[252:255]
    v_mfma_f32_16x16x32_bf16 v[252:255], a[112:115], a[56:59], v[252:255]
    s_waitcnt lgkmcnt(14)
    v_mfma_f32_16x16x32_bf16 v[32:35], a[184:187], a[120:123], v[32:35]
    v_mfma_f32_16x16x32_bf16 v[32:35], a[188:191], a[124:127], v[32:35]
    s_add_u32 m0, s53, 0
    ds_read_b128 a[136:139], v5 offset:4096
    v_mfma_f32_16x16x32_bf16 v[36:39], a[188:191], a[132:135], v[36:39]
    buffer_load_dwordx4 v2, s[8:11], s45 offen  lds
    v_mfma_f32_16x16x32_bf16 v[36:39], a[184:187], a[128:131], v[36:39]
    ds_read_b128 a[140:143], v6 offset:4096
    v_mfma_f32_16x16x32_bf16 v[100:103], a[192:195], a[128:131], v[100:103]
    v_mfma_f32_16x16x32_bf16 v[100:103], a[196:199], a[132:135], v[100:103]
    ds_read_b128 a[148:151], v6 offset:6144
    v_mfma_f32_16x16x32_bf16 v[96:99], a[196:199], a[124:127], v[96:99]
    v_mfma_f32_16x16x32_bf16 v[96:99], a[192:195], a[120:123], v[96:99]
    ds_read_b128 a[144:147], v5 offset:6144
    v_mfma_f32_16x16x32_bf16 v[160:163], a[200:203], a[120:123], v[160:163]
    v_mfma_f32_16x16x32_bf16 v[160:163], a[204:207], a[124:127], v[160:163]
    ds_read_b128 a[152:155], v5 offset:8192
    v_mfma_f32_16x16x32_bf16 v[164:167], a[204:207], a[132:135], v[164:167]
    s_add_u32 m0, s54, 0
    v_mfma_f32_16x16x32_bf16 v[164:167], a[200:203], a[128:131], v[164:167]
    buffer_load_dwordx4 v2, s[8:11], s46 offen  lds
    ds_read_b128 a[156:159], v6 offset:8192
    v_mfma_f32_16x16x32_bf16 v[68:71], a[208:211], a[128:131], v[68:71]
    s_waitcnt lgkmcnt(14)
    v_mfma_f32_16x16x32_bf16 v[68:71], a[212:215], a[132:135], v[68:71]
    ds_read_b128 a[164:167], v6 offset:10240
    v_mfma_f32_16x16x32_bf16 v[64:67], a[212:215], a[124:127], v[64:67]
    v_mfma_f32_16x16x32_bf16 v[64:67], a[208:211], a[120:123], v[64:67]
    ds_read_b128 a[160:163], v5 offset:10240
    v_mfma_f32_16x16x32_bf16 v[128:131], a[216:219], a[120:123], v[128:131]
    v_mfma_f32_16x16x32_bf16 v[128:131], a[220:223], a[124:127], v[128:131]
    ds_read_b128 a[168:171], v5 offset:12288
    v_mfma_f32_16x16x32_bf16 v[132:135], a[220:223], a[132:135], v[132:135]
    s_add_u32 m0, s55, 0
    v_mfma_f32_16x16x32_bf16 v[132:135], a[216:219], a[128:131], v[132:135]
    buffer_load_dwordx4 v2, s[8:11], s47 offen  lds
    ds_read_b128 a[172:175], v6 offset:12288
    s_waitcnt lgkmcnt(14)
    v_mfma_f32_16x16x32_bf16 v[196:199], a[224:227], a[128:131], v[196:199]
    v_add_u32 v2, 458752, v2
    v_mfma_f32_16x16x32_bf16 v[196:199], a[228:231], a[132:135], v[196:199]
    ds_read_b128 a[180:183], v6 offset:14336
    v_mfma_f32_16x16x32_bf16 v[192:195], a[228:231], a[124:127], v[192:195]
    v_mfma_f32_16x16x32_bf16 v[192:195], a[224:227], a[120:123], v[192:195]
    ds_read_b128 a[176:179], v5 offset:14336
    s_waitcnt lgkmcnt(14)
    v_mfma_f32_16x16x32_bf16 v[224:227], a[232:235], a[120:123], v[224:227]
    s_waitcnt lgkmcnt(12)
    v_mfma_f32_16x16x32_bf16 v[224:227], a[236:239], a[124:127], v[224:227]
    v_mfma_f32_16x16x32_bf16 v[228:231], a[236:239], a[132:135], v[228:231]
    s_add_u32 m0, s34, 96640
    v_mfma_f32_16x16x32_bf16 v[228:231], a[232:235], a[128:131], v[228:231]
    buffer_load_dwordx4 v1, s[4:7], s26 offen offset:1664 lds
    s_waitcnt lgkmcnt(11)
    v_mfma_f32_16x16x32_bf16 v[40:43], a[184:187], a[136:139], v[40:43]
    s_waitcnt lgkmcnt(10)
    v_mfma_f32_16x16x32_bf16 v[40:43], a[188:191], a[140:143], v[40:43]
    s_waitcnt lgkmcnt(9)
    v_mfma_f32_16x16x32_bf16 v[44:47], a[188:191], a[148:151], v[44:47]
    s_waitcnt lgkmcnt(8)
    v_mfma_f32_16x16x32_bf16 v[44:47], a[184:187], a[144:147], v[44:47]
    v_mfma_f32_16x16x32_bf16 v[108:111], a[192:195], a[144:147], v[108:111]
    v_mfma_f32_16x16x32_bf16 v[108:111], a[196:199], a[148:151], v[108:111]
    s_add_u32 m0, s35, 96640
    v_mfma_f32_16x16x32_bf16 v[104:107], a[196:199], a[140:143], v[104:107]
    buffer_load_dwordx4 v1, s[4:7], s27 offen offset:1664 lds
    v_mfma_f32_16x16x32_bf16 v[104:107], a[192:195], a[136:139], v[104:107]
    v_mfma_f32_16x16x32_bf16 v[168:171], a[200:203], a[136:139], v[168:171]
    v_mfma_f32_16x16x32_bf16 v[168:171], a[204:207], a[140:143], v[168:171]
    v_mfma_f32_16x16x32_bf16 v[172:175], a[204:207], a[148:151], v[172:175]
    v_mfma_f32_16x16x32_bf16 v[172:175], a[200:203], a[144:147], v[172:175]
    v_mfma_f32_16x16x32_bf16 v[76:79], a[208:211], a[144:147], v[76:79]
    s_add_u32 m0, s36, 96640
    v_mfma_f32_16x16x32_bf16 v[76:79], a[212:215], a[148:151], v[76:79]
    buffer_load_dwordx4 v1, s[4:7], s28 offen offset:1664 lds
    v_mfma_f32_16x16x32_bf16 v[72:75], a[212:215], a[140:143], v[72:75]
    v_mfma_f32_16x16x32_bf16 v[72:75], a[208:211], a[136:139], v[72:75]
    v_mfma_f32_16x16x32_bf16 v[136:139], a[216:219], a[136:139], v[136:139]
    v_mfma_f32_16x16x32_bf16 v[136:139], a[220:223], a[140:143], v[136:139]
    v_mfma_f32_16x16x32_bf16 v[140:143], a[220:223], a[148:151], v[140:143]
    s_add_u32 m0, s37, 96640
    v_mfma_f32_16x16x32_bf16 v[140:143], a[216:219], a[144:147], v[140:143]
    buffer_load_dwordx4 v1, s[4:7], s29 offen offset:1664 lds
    v_mfma_f32_16x16x32_bf16 v[204:207], a[224:227], a[144:147], v[204:207]
    v_mfma_f32_16x16x32_bf16 v[204:207], a[228:231], a[148:151], v[204:207]
    v_mfma_f32_16x16x32_bf16 v[200:203], a[228:231], a[140:143], v[200:203]
    s_waitcnt vmcnt(11)
    v_cmp_gt_u32 vcc, 32, v26
    s_cbranch_vccnz L_spin0
L_spin0_ret:
    v_mfma_f32_16x16x32_bf16 v[200:203], a[224:227], a[136:139], v[200:203]
    v_mfma_f32_16x16x32_bf16 v[232:235], a[232:235], a[136:139], v[232:235]
    s_add_u32 m0, s38, 96640
    v_mfma_f32_16x16x32_bf16 v[232:235], a[236:239], a[140:143], v[232:235]
    buffer_load_dwordx4 v1, s[4:7], s30 offen offset:1664 lds
    v_mfma_f32_16x16x32_bf16 v[236:239], a[236:239], a[148:151], v[236:239]
    v_mfma_f32_16x16x32_bf16 v[236:239], a[232:235], a[144:147], v[236:239]
    s_waitcnt lgkmcnt(7)
    v_mfma_f32_16x16x32_bf16 v[48:51], a[184:187], a[152:155], v[48:51]
    s_waitcnt lgkmcnt(6)
    v_mfma_f32_16x16x32_bf16 v[48:51], a[188:191], a[156:159], v[48:51]
    s_add_u32 m0, s39, 96640
    s_waitcnt lgkmcnt(5)
    v_mfma_f32_16x16x32_bf16 v[52:55], a[188:191], a[164:167], v[52:55]
    buffer_load_dwordx4 v1, s[4:7], s31 offen offset:1664 lds
    s_waitcnt lgkmcnt(4)
    v_mfma_f32_16x16x32_bf16 v[52:55], a[184:187], a[160:163], v[52:55]
    s_waitcnt vmcnt(6) lgkmcnt(0)
    s_barrier
    v_mfma_f32_16x16x32_bf16 v[116:119], a[192:195], a[160:163], v[116:119]
    s_add_u32 m0, s32, 129280
    ds_read_b128 a[0:3], v3 offset:0
    v_mfma_f32_16x16x32_bf16 v[116:119], a[196:199], a[164:167], v[116:119]
    buffer_load_dwordx4 v1, s[4:7], s24 offen offset:1792 lds
    ds_read_b64_tr_b16 a[64:65], v7 offset:0
    v_mfma_f32_16x16x32_bf16 v[112:115], a[196:199], a[156:159], v[112:115]
    s_add_u32 m0, s33, 129280
    v_mfma_f32_16x16x32_bf16 v[112:115], a[192:195], a[152:155], v[112:115]
    buffer_load_dwordx4 v1, s[4:7], s25 offen offset:1792 lds
    ds_read_b64_tr_b16 a[66:67], v7 offset:1024
    v_mfma_f32_16x16x32_bf16 v[176:179], a[200:203], a[152:155], v[176:179]
    s_add_u32 m0, s48, 32768
    ds_read_b128 a[4:7], v4 offset:0
    v_mfma_f32_16x16x32_bf16 v[176:179], a[204:207], a[156:159], v[176:179]
    buffer_load_dwordx4 v2, s[8:11], s40 offen nt lds
    v_mfma_f32_16x16x32_bf16 v[180:183], a[204:207], a[164:167], v[180:183]
    ds_read_b64_tr_b16 a[68:69], v7 offset:8192
    v_mfma_f32_16x16x32_bf16 v[180:183], a[200:203], a[160:163], v[180:183]
    ds_read_b64_tr_b16 a[70:71], v7 offset:9216
    v_mfma_f32_16x16x32_bf16 v[84:87], a[208:211], a[160:163], v[84:87]
    v_mfma_f32_16x16x32_bf16 v[84:87], a[212:215], a[164:167], v[84:87]
    ds_read_b128 a[12:15], v4 offset:2048
    v_mfma_f32_16x16x32_bf16 v[80:83], a[212:215], a[156:159], v[80:83]
    ds_read_b128 a[8:11], v3 offset:2048
    v_mfma_f32_16x16x32_bf16 v[80:83], a[208:211], a[152:155], v[80:83]
    v_mfma_f32_16x16x32_bf16 v[144:147], a[216:219], a[152:155], v[144:147]
    ds_read_b64_tr_b16 a[72:73], v8 offset:0
    v_mfma_f32_16x16x32_bf16 v[144:147], a[220:223], a[156:159], v[144:147]
    ds_read_b64_tr_b16 a[74:75], v8 offset:1024
    v_mfma_f32_16x16x32_bf16 v[148:151], a[220:223], a[164:167], v[148:151]
    v_mfma_f32_16x16x32_bf16 v[148:151], a[216:219], a[160:163], v[148:151]
    s_add_u32 m0, s49, 32768
    ds_read_b64_tr_b16 a[76:77], v8 offset:8192
    v_mfma_f32_16x16x32_bf16 v[212:215], a[224:227], a[160:163], v[212:215]
    buffer_load_dwordx4 v2, s[8:11], s41 offen nt lds
    ds_read_b64_tr_b16 a[78:79], v8 offset:9216
    v_mfma_f32_16x16x32_bf16 v[212:215], a[228:231], a[164:167], v[212:215]
    v_mfma_f32_16x16x32_bf16 v[208:211], a[228:231], a[156:159], v[208:211]
    ds_read_b64_tr_b16 a[80:81], v9 offset:0
    v_mfma_f32_16x16x32_bf16 v[208:211], a[224:227], a[152:155], v[208:211]
    ds_read_b64_tr_b16 a[82:83], v9 offset:1024
    v_mfma_f32_16x16x32_bf16 v[240:243], a[232:235], a[152:155], v[240:243]
    v_mfma_f32_16x16x32_bf16 v[240:243], a[236:239], a[156:159], v[240:243]
    ds_read_b64_tr_b16 a[84:85], v9 offset:8192
    v_mfma_f32_16x16x32_bf16 v[244:247], a[236:239], a[164:167], v[244:247]
    ds_read_b64_tr_b16 a[86:87], v9 offset:9216
    v_mfma_f32_16x16x32_bf16 v[244:247], a[232:235], a[160:163], v[244:247]
    v_mfma_f32_16x16x32_bf16 v[56:59], a[184:187], a[168:171], v[56:59]
    ds_read_b64_tr_b16 a[88:89], v10 offset:0
    v_mfma_f32_16x16x32_bf16 v[56:59], a[188:191], a[172:175], v[56:59]
    s_add_u32 m0, s50, 32768
    ds_read_b64_tr_b16 a[90:91], v10 offset:1024
    v_mfma_f32_16x16x32_bf16 v[60:63], a[188:191], a[180:183], v[60:63]
    buffer_load_dwordx4 v2, s[8:11], s42 offen  lds
    v_mfma_f32_16x16x32_bf16 v[60:63], a[184:187], a[176:179], v[60:63]
    ds_read_b64_tr_b16 a[92:93], v10 offset:8192
    v_mfma_f32_16x16x32_bf16 v[124:127], a[192:195], a[176:179], v[124:127]
    ds_read_b64_tr_b16 a[94:95], v10 offset:9216
    v_mfma_f32_16x16x32_bf16 v[124:127], a[196:199], a[180:183], v[124:127]
    v_mfma_f32_16x16x32_bf16 v[120:123], a[196:199], a[172:175], v[120:123]
    ds_read_b64_tr_b16 a[96:97], v11 offset:0
    v_mfma_f32_16x16x32_bf16 v[120:123], a[192:195], a[168:171], v[120:123]
    ds_read_b64_tr_b16 a[98:99], v11 offset:1024
    v_mfma_f32_16x16x32_bf16 v[184:187], a[200:203], a[168:171], v[184:187]
    v_mfma_f32_16x16x32_bf16 v[184:187], a[204:207], a[172:175], v[184:187]
    ds_read_b64_tr_b16 a[100:101], v11 offset:8192
    v_mfma_f32_16x16x32_bf16 v[188:191], a[204:207], a[180:183], v[188:191]
    ds_read_b64_tr_b16 a[102:103], v11 offset:9216
    v_mfma_f32_16x16x32_bf16 v[188:191], a[200:203], a[176:179], v[188:191]
    s_add_u32 m0, s51, 32768
    v_mfma_f32_16x16x32_bf16 v[92:95], a[208:211], a[176:179], v[92:95]
    buffer_load_dwordx4 v2, s[8:11], s43 offen  lds
    ds_read_b64_tr_b16 a[104:105], v12 offset:0
    v_mfma_f32_16x16x32_bf16 v[92:95], a[212:215], a[180:183], v[92:95]
    ds_read_b64_tr_b16 a[106:107], v12 offset:1024
    v_mfma_f32_16x16x32_bf16 v[88:91], a[212:215], a[172:175], v[88:91]
    v_mfma_f32_16x16x32_bf16 v[88:91], a[208:211], a[168:171], v[88:91]
    ds_read_b64_tr_b16 a[108:109], v12 offset:8192
    v_mfma_f32_16x16x32_bf16 v[152:155], a[216:219], a[168:171], v[152:155]
    ds_read_b64_tr_b16 a[110:111], v12 offset:9216
    v_mfma_f32_16x16x32_bf16 v[152:155], a[220:223], a[172:175], v[152:155]
    v_mfma_f32_16x16x32_bf16 v[156:159], a[220:223], a[180:183], v[156:159]
    ds_read_b64_tr_b16 a[112:113], v13 offset:0
    v_mfma_f32_16x16x32_bf16 v[156:159], a[216:219], a[176:179], v[156:159]
    ds_read_b64_tr_b16 a[114:115], v13 offset:1024
    v_mfma_f32_16x16x32_bf16 v[220:223], a[224:227], a[176:179], v[220:223]
    s_add_u32 m0, s52, 32768
    v_mfma_f32_16x16x32_bf16 v[220:223], a[228:231], a[180:183], v[220:223]
    buffer_load_dwordx4 v2, s[8:11], s44 offen  lds
    ds_read_b64_tr_b16 a[116:117], v13 offset:8192
    v_mfma_f32_16x16x32_bf16 v[216:219], a[228:231], a[172:175], v[216:219]
    ds_read_b64_tr_b16 a[118:119], v13 offset:9216
    v_mfma_f32_16x16x32_bf16 v[216:219], a[224:227], a[168:171], v[216:219]
    v_mfma_f32_16x16x32_bf16 v[248:251], a[232:235], a[168:171], v[248:251]
    v_mfma_f32_16x16x32_bf16 v[248:251], a[236:239], a[172:175], v[248:251]
    v_mfma_f32_16x16x32_bf16 v[252:255], a[236:239], a[180:183], v[252:255]
    v_mfma_f32_16x16x32_bf16 v[252:255], a[232:235], a[176:179], v[252:255]
    s_waitcnt lgkmcnt(14)
    v_mfma_f32_16x16x32_bf16 v[32:35], a[64:67], a[0:3], v[32:35]
    v_mfma_f32_16x16x32_bf16 v[32:35], a[68:71], a[4:7], v[32:35]
    s_add_u32 m0, s53, 32768
    ds_read_b128 a[16:19], v3 offset:4096
    v_mfma_f32_16x16x32_bf16 v[36:39], a[68:71], a[12:15], v[36:39]
    buffer_load_dwordx4 v2, s[8:11], s45 offen  lds
    v_mfma_f32_16x16x32_bf16 v[36:39], a[64:67], a[8:11], v[36:39]
    ds_read_b128 a[20:23], v4 offset:4096
    v_mfma_f32_16x16x32_bf16 v[100:103], a[72:75], a[8:11], v[100:103]
    v_mfma_f32_16x16x32_bf16 v[100:103], a[76:79], a[12:15], v[100:103]
    ds_read_b128 a[28:31], v4 offset:6144
    v_mfma_f32_16x16x32_bf16 v[96:99], a[76:79], a[4:7], v[96:99]
    v_mfma_f32_16x16x32_bf16 v[96:99], a[72:75], a[0:3], v[96:99]
    ds_read_b128 a[24:27], v3 offset:6144
    v_mfma_f32_16x16x32_bf16 v[160:163], a[80:83], a[0:3], v[160:163]
    v_mfma_f32_16x16x32_bf16 v[160:163], a[84:87], a[4:7], v[160:163]
    ds_read_b128 a[32:35], v3 offset:8192
    v_mfma_f32_16x16x32_bf16 v[164:167], a[84:87], a[12:15], v[164:167]
    s_add_u32 m0, s54, 32768
    v_mfma_f32_16x16x32_bf16 v[164:167], a[80:83], a[8:11], v[164:167]
    buffer_load_dwordx4 v2, s[8:11], s46 offen  lds
    ds_read_b128 a[36:39], v4 offset:8192
    v_mfma_f32_16x16x32_bf16 v[68:71], a[88:91], a[8:11], v[68:71]
    s_waitcnt lgkmcnt(14)
    v_mfma_f32_16x16x32_bf16 v[68:71], a[92:95], a[12:15], v[68:71]
    ds_read_b128 a[44:47], v4 offset:10240
    v_mfma_f32_16x16x32_bf16 v[64:67], a[92:95], a[4:7], v[64:67]
    v_mfma_f32_16x16x32_bf16 v[64:67], a[88:91], a[0:3], v[64:67]
    ds_read_b128 a[40:43], v3 offset:10240
    v_mfma_f32_16x16x32_bf16 v[128:131], a[96:99], a[0:3], v[128:131]
    v_mfma_f32_16x16x32_bf16 v[128:131], a[100:103], a[4:7], v[128:131]
    ds_read_b128 a[48:51], v3 offset:12288
    v_mfma_f32_16x16x32_bf16 v[132:135], a[100:103], a[12:15], v[132:135]
    s_add_u32 m0, s55, 32768
    v_mfma_f32_16x16x32_bf16 v[132:135], a[96:99], a[8:11], v[132:135]
    buffer_load_dwordx4 v2, s[8:11], s47 offen  lds
    ds_read_b128 a[52:55], v4 offset:12288
    s_waitcnt lgkmcnt(14)
    v_mfma_f32_16x16x32_bf16 v[196:199], a[104:107], a[8:11], v[196:199]
    v_add_u32 v2, 458752, v2
    v_mfma_f32_16x16x32_bf16 v[196:199], a[108:111], a[12:15], v[196:199]
    ds_read_b128 a[60:63], v4 offset:14336
    v_mfma_f32_16x16x32_bf16 v[192:195], a[108:111], a[4:7], v[192:195]
    v_mfma_f32_16x16x32_bf16 v[192:195], a[104:107], a[0:3], v[192:195]
    ds_read_b128 a[56:59], v3 offset:14336
    s_waitcnt lgkmcnt(14)
    v_mfma_f32_16x16x32_bf16 v[224:227], a[112:115], a[0:3], v[224:227]
    s_waitcnt lgkmcnt(12)
    v_mfma_f32_16x16x32_bf16 v[224:227], a[116:119], a[4:7], v[224:227]
    v_mfma_f32_16x16x32_bf16 v[228:231], a[116:119], a[12:15], v[228:231]
    s_add_u32 m0, s34, 129280
    v_mfma_f32_16x16x32_bf16 v[228:231], a[112:115], a[8:11], v[228:231]
    buffer_load_dwordx4 v1, s[4:7], s26 offen offset:1792 lds
    s_waitcnt lgkmcnt(11)
    v_mfma_f32_16x16x32_bf16 v[40:43], a[64:67], a[16:19], v[40:43]
    s_waitcnt lgkmcnt(10)
    v_mfma_f32_16x16x32_bf16 v[40:43], a[68:71], a[20:23], v[40:43]
    s_waitcnt lgkmcnt(9)
    v_mfma_f32_16x16x32_bf16 v[44:47], a[68:71], a[28:31], v[44:47]
    s_waitcnt lgkmcnt(8)
    v_mfma_f32_16x16x32_bf16 v[44:47], a[64:67], a[24:27], v[44:47]
    v_mfma_f32_16x16x32_bf16 v[108:111], a[72:75], a[24:27], v[108:111]
    v_mfma_f32_16x16x32_bf16 v[108:111], a[76:79], a[28:31], v[108:111]
    s_add_u32 m0, s35, 129280
    v_mfma_f32_16x16x32_bf16 v[104:107], a[76:79], a[20:23], v[104:107]
    buffer_load_dwordx4 v1, s[4:7], s27 offen offset:1792 lds
    v_mfma_f32_16x16x32_bf16 v[104:107], a[72:75], a[16:19], v[104:107]
    v_mfma_f32_16x16x32_bf16 v[168:171], a[80:83], a[16:19], v[168:171]
    v_mfma_f32_16x16x32_bf16 v[168:171], a[84:87], a[20:23], v[168:171]
    v_mfma_f32_16x16x32_bf16 v[172:175], a[84:87], a[28:31], v[172:175]
    v_mfma_f32_16x16x32_bf16 v[172:175], a[80:83], a[24:27], v[172:175]
    v_mfma_f32_16x16x32_bf16 v[76:79], a[88:91], a[24:27], v[76:79]
    s_add_u32 m0, s36, 129280
    v_mfma_f32_16x16x32_bf16 v[76:79], a[92:95], a[28:31], v[76:79]
    buffer_load_dwordx4 v1, s[4:7], s28 offen offset:1792 lds
    v_mfma_f32_16x16x32_bf16 v[72:75], a[92:95], a[20:23], v[72:75]
    v_mfma_f32_16x16x32_bf16 v[72:75], a[88:91], a[16:19], v[72:75]
    v_mfma_f32_16x16x32_bf16 v[136:139], a[96:99], a[16:19], v[136:139]
    v_mfma_f32_16x16x32_bf16 v[136:139], a[100:103], a[20:23], v[136:139]
    v_mfma_f32_16x16x32_bf16 v[140:143], a[100:103], a[28:31], v[140:143]
    s_add_u32 m0, s37, 129280
    v_mfma_f32_16x16x32_bf16 v[140:143], a[96:99], a[24:27], v[140:143]
    buffer_load_dwordx4 v1, s[4:7], s29 offen offset:1792 lds
    v_mfma_f32_16x16x32_bf16 v[204:207], a[104:107], a[24:27], v[204:207]
    v_mfma_f32_16x16x32_bf16 v[204:207], a[108:111], a[28:31], v[204:207]
    v_mfma_f32_16x16x32_bf16 v[200:203], a[108:111], a[20:23], v[200:203]
    v_mfma_f32_16x16x32_bf16 v[200:203], a[104:107], a[16:19], v[200:203]
    v_mfma_f32_16x16x32_bf16 v[232:235], a[112:115], a[16:19], v[232:235]
    s_add_u32 m0, s38, 129280
    v_mfma_f32_16x16x32_bf16 v[232:235], a[116:119], a[20:23], v[232:235]
    buffer_load_dwordx4 v1, s[4:7], s30 offen offset:1792 lds
    v_mfma_f32_16x16x32_bf16 v[236:239], a[116:119], a[28:31], v[236:239]
    v_mfma_f32_16x16x32_bf16 v[236:239], a[112:115], a[24:27], v[236:239]
    s_waitcnt lgkmcnt(7)
    v_mfma_f32_16x16x32_bf16 v[48:51], a[64:67], a[32:35], v[48:51]
    s_waitcnt lgkmcnt(6)
    v_mfma_f32_16x16x32_bf16 v[48:51], a[68:71], a[36:39], v[48:51]
    s_add_u32 m0, s39, 129280
    s_waitcnt lgkmcnt(5)
    v_mfma_f32_16x16x32_bf16 v[52:55], a[68:71], a[44:47], v[52:55]
    buffer_load_dwordx4 v1, s[4:7], s31 offen offset:1792 lds
    s_waitcnt lgkmcnt(4)
    v_mfma_f32_16x16x32_bf16 v[52:55], a[64:67], a[40:43], v[52:55]
    s_waitcnt vmcnt(6) lgkmcnt(0)
    s_barrier
    v_mfma_f32_16x16x32_bf16 v[116:119], a[72:75], a[40:43], v[116:119]
    s_add_u32 m0, s32, 63616
    ds_read_b128 a[120:123], v3 offset:32768
    v_mfma_f32_16x16x32_bf16 v[116:119], a[76:79], a[44:47], v[116:119]
    buffer_load_dwordx4 v1, s[4:7], s24 offen offset:1920 lds
    ds_read_b64_tr_b16 a[184:185], v7 offset:32768
    v_mfma_f32_16x16x32_bf16 v[112:115], a[76:79], a[36:39], v[112:115]
    s_add_u32 m0, s33, 63616
    v_mfma_f32_16x16x32_bf16 v[112:115], a[72:75], a[32:35], v[112:115]
    buffer_load_dwordx4 v1, s[4:7], s25 offen offset:1920 lds
    ds_read_b64_tr_b16 a[186:187], v7 offset:33792
    v_mfma_f32_16x16x32_bf16 v[176:179], a[80:83], a[32:35], v[176:179]
    s_add_u32 m0, s48, 0
    ds_read_b128 a[124:127], v4 offset:32768
    v_mfma_f32_16x16x32_bf16 v[176:179], a[84:87], a[36:39], v[176:179]
    buffer_load_dwordx4 v2, s[8:11], s40 offen nt lds
    v_mfma_f32_16x16x32_bf16 v[180:183], a[84:87], a[44:47], v[180:183]
    ds_read_b64_tr_b16 a[188:189], v7 offset:40960
    v_mfma_f32_16x16x32_bf16 v[180:183], a[80:83], a[40:43], v[180:183]
    ds_read_b64_tr_b16 a[190:191], v7 offset:41984
    v_mfma_f32_16x16x32_bf16 v[84:87], a[88:91], a[40:43], v[84:87]
    v_mfma_f32_16x16x32_bf16 v[84:87], a[92:95], a[44:47], v[84:87]
    ds_read_b128 a[132:135], v4 offset:34816
    v_mfma_f32_16x16x32_bf16 v[80:83], a[92:95], a[36:39], v[80:83]
    ds_read_b128 a[128:131], v3 offset:34816
    v_mfma_f32_16x16x32_bf16 v[80:83], a[88:91], a[32:35], v[80:83]
    v_mfma_f32_16x16x32_bf16 v[144:147], a[96:99], a[32:35], v[144:147]
    ds_read_b64_tr_b16 a[192:193], v8 offset:32768
    v_mfma_f32_16x16x32_bf16 v[144:147], a[100:103], a[36:39], v[144:147]
    ds_read_b64_tr_b16 a[194:195], v8 offset:33792
    v_mfma_f32_16x16x32_bf16 v[148:151], a[100:103], a[44:47], v[148:151]
    v_mfma_f32_16x16x32_bf16 v[148:151], a[96:99], a[40:43], v[148:151]
    s_add_u32 m0, s49, 0
    ds_read_b64_tr_b16 a[196:197], v8 offset:40960
    v_mfma_f32_16x16x32_bf16 v[212:215], a[104:107], a[40:43], v[212:215]
    buffer_load_dwordx4 v2, s[8:11], s41 offen nt lds
    ds_read_b64_tr_b16 a[198:199], v8 offset:41984
    v_mfma_f32_16x16x32_bf16 v[212:215], a[108:111], a[44:47], v[212:215]
    v_mfma_f32_16x16x32_bf16 v[208:211], a[108:111], a[36:39], v[208:211]
    ds_read_b64_tr_b16 a[200:201], v9 offset:32768
    v_mfma_f32_16x16x32_bf16 v[208:211], a[104:107], a[32:35], v[208:211]
    ds_read_b64_tr_b16 a[202:203], v9 offset:33792
    v_mfma_f32_16x16x32_bf16 v[240:243], a[112:115], a[32:35], v[240:243]
    v_mfma_f32_16x16x32_bf16 v[240:243], a[116:119], a[36:39], v[240:243]
    ds_read_b64_tr_b16 a[204:205], v9 offset:40960
    v_mfma_f32_16x16x32_bf16 v[244:247], a[116:119], a[44:47], v[244:247]
    ds_read_b64_tr_b16 a[206:207], v9 offset:41984
    v_mfma_f32_16x16x32_bf16 v[244:247], a[112:115], a[40:43], v[244:247]
    v_mfma_f32_16x16x32_bf16 v[56:59], a[64:67], a[48:51], v[56:59]
    ds_read_b64_tr_b16 a[208:209], v10 offset:32768
    v_mfma_f32_16x16x32_bf16 v[56:59], a[68:71], a[52:55], v[56:59]
    s_add_u32 m0, s50, 0
    ds_read_b64_tr_b16 a[210:211], v10 offset:33792
    v_mfma_f32_16x16x32_bf16 v[60:63], a[68:71], a[60:63], v[60:63]
    buffer_load_dwordx4 v2, s[8:11], s42 offen  lds
    v_mfma_f32_16x16x32_bf16 v[60:63], a[64:67], a[56:59], v[60:63]
    ds_read_b64_tr_b16 a[212:213], v10 offset:40960
    v_mfma_f32_16x16x32_bf16 v[124:127], a[72:75], a[56:59], v[124:127]
    ds_read_b64_tr_b16 a[214:215], v10 offset:41984
    v_mfma_f32_16x16x32_bf16 v[124:127], a[76:79], a[60:63], v[124:127]
    v_mfma_f32_16x16x32_bf16 v[120:123], a[76:79], a[52:55], v[120:123]
    ds_read_b64_tr_b16 a[216:217], v11 offset:32768
    v_mfma_f32_16x16x32_bf16 v[120:123], a[72:75], a[48:51], v[120:123]
    ds_read_b64_tr_b16 a[218:219], v11 offset:33792
    v_mfma_f32_16x16x32_bf16 v[184:187], a[80:83], a[48:51], v[184:187]
    v_mfma_f32_16x16x32_bf16 v[184:187], a[84:87], a[52:55], v[184:187]
    ds_read_b64_tr_b16 a[220:221], v11 offset:40960
    v_mfma_f32_16x16x32_bf16 v[188:191], a[84:87], a[60:63], v[188:191]
    ds_read_b64_tr_b16 a[222:223], v11 offset:41984
L_pad5:
    s_cbranch_execz L_pad9
    v_mfma_f32_16x16x32_bf16 v[188:191], a[80:83], a[56:59], v[188:191]
    s_add_u32 m0, s51, 0
    v_mfma_f32_16x16x32_bf16 v[92:95], a[88:91], a[56:59], v[92:95]
    buffer_load_dwordx4 v2, s[8:11], s43 offen  lds
    ds_read_b64_tr_b16 a[224:225], v12 offset:32768
    v_mfma_f32_16x16x32_bf16 v[92:95], a[92:95], a[60:63], v[92:95]
    ds_read_b64_tr_b16 a[226:227], v12 offset:33792
    v_mfma_f32_16x16x32_bf16 v[88:91], a[92:95], a[52:55], v[88:91]
    v_mfma_f32_16x16x32_bf16 v[88:91], a[88:91], a[48:51], v[88:91]
    ds_read_b64_tr_b16 a[228:229], v12 offset:40960
    v_mfma_f32_16x16x32_bf16 v[152:155], a[96:99], a[48:51], v[152:155]
    ds_read_b64_tr_b16 a[230:231], v12 offset:41984
    v_mfma_f32_16x16x32_bf16 v[152:155], a[100:103], a[52:55], v[152:155]
    v_mfma_f32_16x16x32_bf16 v[156:159], a[100:103], a[60:63], v[156:159]
    ds_read_b64_tr_b16 a[232:233], v13 offset:32768
    v_mfma_f32_16x16x32_bf16 v[156:159], a[96:99], a[56:59], v[156:159]
    ds_read_b64_tr_b16 a[234:235], v13 offset:33792
    v_mfma_f32_16x16x32_bf16 v[220:223], a[104:107], a[56:59], v[220:223]
    s_add_u32 m0, s52, 0
    v_mfma_f32_16x16x32_bf16 v[220:223], a[108:111], a[60:63], v[220:223]
    buffer_load_dwordx4 v2, s[8:11], s44 offen  lds
    ds_read_b64_tr_b16 a[236:237], v13 offset:40960
    v_mfma_f32_16x16x32_bf16 v[216:219], a[108:111], a[52:55], v[216:219]
    ds_read_b64_tr_b16 a[238:239], v13 offset:41984
    v_mfma_f32_16x16x32_bf16 v[216:219], a[104:107], a[48:51], v[216:219]
    v_mfma_f32_16x16x32_bf16 v[248:251], a[112:115], a[48:51], v[248:251]
    v_mfma_f32_16x16x32_bf16 v[248:251], a[116:119], a[52:55], v[248:251]
    v_mfma_f32_16x16x32_bf16 v[252:255], a[116:119], a[60:63], v[252:255]
    v_mfma_f32_16x16x32_bf16 v[252:255], a[112:115], a[56:59], v[252:255]
    s_waitcnt lgkmcnt(14)
    v_mfma_f32_16x16x32_bf16 v[32:35], a[184:187], a[120:123], v[32:35]
    v_mfma_f32_16x16x32_bf16 v[32:35], a[188:191], a[124:127], v[32:35]
    s_add_u32 m0, s53, 0
    ds_read_b128 a[136:139], v3 offset:36864
    v_mfma_f32_16x16x32_bf16 v[36:39], a[188:191], a[132:135], v[36:39]
    buffer_load_dwordx4 v2, s[8:11], s45 offen  lds
    v_mfma_f32_16x16x32_bf16 v[36:39], a[184:187], a[128:131], v[36:39]
    ds_read_b128 a[140:143], v4 offset:36864
    v_mfma_f32_16x16x32_bf16 v[100:103], a[192:195], a[128:131], v[100:103]
    v_mfma_f32_16x16x32_bf16 v[100:103], a[196:199], a[132:135], v[100:103]
    ds_read_b128 a[148:151], v4 offset:38912
    v_mfma_f32_16x16x32_bf16 v[96:99], a[196:199], a[124:127], v[96:99]
    v_mfma_f32_16x16x32_bf16 v[96:99], a[192:195], a[120:123], v[96:99]
    ds_read_b128 a[144:147], v3 offset:38912
    v_mfma_f32_16x16x32_bf16 v[160:163], a[200:203], a[120:123], v[160:163]
    v_mfma_f32_16x16x32_bf16 v[160:163], a[204:207], a[124:127], v[160:163]
    ds_read_b128 a[152:155], v3 offset:40960
    v_mfma_f32_16x16x32_bf16 v[164:167], a[204:207], a[132:135], v[164:167]
    s_add_u32 m0, s54, 0
    v_mfma_f32_16x16x32_bf16 v[164:167], a[200:203], a[128:131], v[164:167]
    buffer_load_dwordx4 v2, s[8:11], s46 offen  lds
    ds_read_b128 a[156:159], v4 offset:40960
    v_mfma_f32_16x16x32_bf16 v[68:71], a[208:211], a[128:131], v[68:71]
    s_waitcnt lgkmcnt(14)
    v_mfma_f32_16x16x32_bf16 v[68:71], a[212:215], a[132:135], v[68:71]
    ds_read_b128 a[164:167], v4 offset:43008
    v_mfma_f32_16x16x32_bf16 v[64:67], a[212:215], a[124:127], v[64:67]
    v_mfma_f32_16x16x32_bf16 v[64:67], a[208:211], a[120:123], v[64:67]
    ds_read_b128 a[160:163], v3 offset:43008
    v_mfma_f32_16x16x32_bf16 v[128:131], a[216:219], a[120:123], v[128:131]
    v_mfma_f32_16x16x32_bf16 v[128:131], a[220:223], a[124:127], v[128:131]
    ds_read_b128 a[168:171], v3 offset:45056
    v_mfma_f32_16x16x32_bf16 v[132:135], a[220:223], a[132:135], v[132:135]
    s_add_u32 m0, s55, 0
    v_mfma_f32_16x16x32_bf16 v[132:135], a[216:219], a[128:131], v[132:135]
    buffer_load_dwordx4 v2, s[8:11], s47 offen  lds
    ds_read_b128 a[172:175], v4 offset:45056
    s_waitcnt lgkmcnt(14)
    v_mfma_f32_16x16x32_bf16 v[196:199], a[224:227], a[128:131], v[196:199]
    v_add_u32 v2, 458752, v2
    v_mfma_f32_16x16x32_bf16 v[196:199], a[228:231], a[132:135], v[196:199]
    ds_read_b128 a[180:183], v4 offset:47104
    v_mfma_f32_16x16x32_bf16 v[192:195], a[228:231], a[124:127], v[192:195]
    v_mfma_f32_16x16x32_bf16 v[192:195], a[224:227], a[120:123], v[192:195]
    ds_read_b128 a[176:179], v3 offset:47104
    s_waitcnt lgkmcnt(14)
    v_mfma_f32_16x16x32_bf16 v[224:227], a[232:235], a[120:123], v[224:227]
    s_waitcnt lgkmcnt(12)
    v_mfma_f32_16x16x32_bf16 v[224:227], a[236:239], a[124:127], v[224:227]
    v_mfma_f32_16x16x32_bf16 v[228:231], a[236:239], a[132:135], v[228:231]
    s_add_u32 m0, s34, 63616
    v_mfma_f32_16x16x32_bf16 v[228:231], a[232:235], a[128:131], v[228:231]
    buffer_load_dwordx4 v1, s[4:7], s26 offen offset:1920 lds
    s_waitcnt lgkmcnt(11)
    v_mfma_f32_16x16x32_bf16 v[40:43], a[184:187], a[136:139], v[40:43]
    s_waitcnt lgkmcnt(10)
    v_mfma_f32_16x16x32_bf16 v[40:43], a[188:191], a[140:143], v[40:43]
    s_waitcnt lgkmcnt(9)
    v_mfma_f32_16x16x32_bf16 v[44:47], a[188:191], a[148:151], v[44:47]
    s_waitcnt lgkmcnt(8)
    v_mfma_f32_16x16x32_bf16 v[44:47], a[184:187], a[144:147], v[44:47]
    v_mfma_f32_16x16x32_bf16 v[108:111], a[192:195], a[144:147], v[108:111]
    v_mfma_f32_16x16x32_bf16 v[108:111], a[196:199], a[148:151], v[108:111]
    s_add_u32 m0, s35, 63616
    v_mfma_f32_16x16x32_bf16 v[104:107], a[196:199], a[140:143], v[104:107]
    buffer_load_dwordx4 v1, s[4:7], s27 offen offset:1920 lds
    v_mfma_f32_16x16x32_bf16 v[104:107], a[192:195], a[136:139], v[104:107]
    v_mfma_f32_16x16x32_bf16 v[168:171], a[200:203], a[136:139], v[168:171]
    v_mfma_f32_16x16x32_bf16 v[168:171], a[204:207], a[140:143], v[168:171]
    v_mfma_f32_16x16x32_bf16 v[172:175], a[204:207], a[148:151], v[172:175]
    v_mfma_f32_16x16x32_bf16 v[172:175], a[200:203], a[144:147], v[172:175]
    v_mfma_f32_16x16x32_bf16 v[76:79], a[208:211], a[144:147], v[76:79]
    s_add_u32 m0, s36, 63616
    v_mfma_f32_16x16x32_bf16 v[76:79], a[212:215], a[148:151], v[76:79]
    buffer_load_dwordx4 v1, s[4:7], s28 offen offset:1920 lds
    v_mfma_f32_16x16x32_bf16 v[72:75], a[212:215], a[140:143], v[72:75]
    v_mfma_f32_16x16x32_bf16 v[72:75], a[208:211], a[136:139], v[72:75]
    v_mfma_f32_16x16x32_bf16 v[136:139], a[216:219], a[136:139], v[136:139]
    v_mfma_f32_16x16x32_bf16 v[136:139], a[220:223], a[140:143], v[136:139]
    v_mfma_f32_16x16x32_bf16 v[140:143], a[220:223], a[148:151], v[140:143]
    s_add_u32 m0, s37, 63616
    v_mfma_f32_16x16x32_bf16 v[140:143], a[216:219], a[144:147], v[140:143]
    buffer_load_dwordx4 v1, s[4:7], s29 offen offset:1920 lds
    v_mfma_f32_16x16x32_bf16 v[204:207], a[224:227], a[144:147], v[204:207]
    v_mfma_f32_16x16x32_bf16 v[204:207], a[228:231], a[148:151], v[204:207]
    v_mfma_f32_16x16x32_bf16 v[200:203], a[228:231], a[140:143], v[200:203]
    v_mfma_f32_16x16x32_bf16 v[200:203], a[224:227], a[136:139], v[200:203]
    v_mfma_f32_16x16x32_bf16 v[232:235], a[232:235], a[136:139], v[232:235]
    s_add_u32 m0, s38, 63616
    v_mfma_f32_16x16x32_bf16 v[232:235], a[236:239], a[140:143], v[232:235]
    buffer_load_dwordx4 v1, s[4:7], s30 offen offset:1920 lds
    v_mfma_f32_16x16x32_bf16 v[236:239], a[236:239], a[148:151], v[236:239]
    v_mfma_f32_16x16x32_bf16 v[236:239], a[232:235], a[144:147], v[236:239]
    s_waitcnt lgkmcnt(7)
    v_mfma_f32_16x16x32_bf16 v[48:51], a[184:187], a[152:155], v[48:51]
    s_waitcnt lgkmcnt(6)
    v_mfma_f32_16x16x32_bf16 v[48:51], a[188:191], a[156:159], v[48:51]
    s_add_u32 m0, s39, 63616
    s_waitcnt lgkmcnt(5)
    v_mfma_f32_16x16x32_bf16 v[52:55], a[188:191], a[164:167], v[52:55]
    buffer_load_dwordx4 v1, s[4:7], s31 offen offset:1920 lds
    s_waitcnt lgkmcnt(4)
    v_mfma_f32_16x16x32_bf16 v[52:55], a[184:187], a[160:163], v[52:55]
    s_waitcnt vmcnt(6) lgkmcnt(0)
    s_barrier
    v_mfma_f32_16x16x32_bf16 v[116:119], a[192:195], a[160:163], v[116:119]
    s_add_u32 m0, s48, 32768
    s_mov_b32 s24, 0
    v_mfma_f32_16x16x32_bf16 v[116:119], a[196:199], a[164:167], v[116:119]
    buffer_load_dwordx4 v2, s[8:11], s40 offen nt lds
    s_mov_b32 s25, 228352
    v_mfma_f32_16x16x32_bf16 v[112:115], a[196:199], a[156:159], v[112:115]
    s_mov_b32 s26, 456704
    s_mov_b32 s27, 685056
    v_mfma_f32_16x16x32_bf16 v[112:115], a[192:195], a[152:155], v[112:115]
    s_mov_b32 s28, 917504
    s_mov_b32 s29, 1145856
    v_mfma_f32_16x16x32_bf16 v[176:179], a[200:203], a[152:155], v[176:179]
    s_mov_b32 s30, 1374208
    s_mov_b32 s31, 1602560
    v_mfma_f32_16x16x32_bf16 v[176:179], a[204:207], a[156:159], v[176:179]
    s_add_u32 m0, s49, 32768
    s_mov_b32 s32, 1835008
    v_mfma_f32_16x16x32_bf16 v[180:183], a[204:207], a[164:167], v[180:183]
    buffer_load_dwordx4 v2, s[8:11], s41 offen nt lds
    s_mov_b32 s33, 2063360
    v_mfma_f32_16x16x32_bf16 v[180:183], a[200:203], a[160:163], v[180:183]
    s_mov_b32 s34, 2291712
    s_mov_b32 s35, 2520064
    v_mfma_f32_16x16x32_bf16 v[84:87], a[208:211], a[160:163], v[84:87]
    s_mov_b32 s36, 2752512
    s_mov_b32 s37, 2980864
    v_mfma_f32_16x16x32_bf16 v[84:87], a[212:215], a[164:167], v[84:87]
    s_mov_b32 s38, 3209216
    s_mov_b32 s39, 3437568
    v_mfma_f32_16x16x32_bf16 v[80:83], a[212:215], a[156:159], v[80:83]
    s_add_u32 m0, s50, 32768
    ds_read_b128 a[0:3], v5 offset:0
    v_mfma_f32_16x16x32_bf16 v[80:83], a[208:211], a[152:155], v[80:83]
    buffer_load_dwordx4 v2, s[8:11], s42 offen  lds
    ds_read_b64_tr_b16 a[64:65], v7 offset:0
    v_mfma_f32_16x16x32_bf16 v[144:147], a[216:219], a[152:155], v[144:147]
    ds_read_b64_tr_b16 a[66:67], v7 offset:1024
    v_mfma_f32_16x16x32_bf16 v[144:147], a[220:223], a[156:159], v[144:147]
    ds_read_b128 a[4:7], v6 offset:0
    v_mfma_f32_16x16x32_bf16 v[148:151], a[220:223], a[164:167], v[148:151]
    ds_read_b64_tr_b16 a[68:69], v7 offset:8192
    v_mfma_f32_16x16x32_bf16 v[148:151], a[216:219], a[160:163], v[148:151]
    s_add_u32 m0, s51, 32768
    ds_read_b64_tr_b16 a[70:71], v7 offset:9216
    v_mfma_f32_16x16x32_bf16 v[212:215], a[224:227], a[160:163], v[212:215]
    buffer_load_dwordx4 v2, s[8:11], s43 offen  lds
    ds_read_b64_tr_b16 a[92:93], v10 offset:8192
    v_mfma_f32_16x16x32_bf16 v[212:215], a[228:231], a[164:167], v[212:215]
    ds_read_b64_tr_b16 a[94:95], v10 offset:9216
    v_mfma_f32_16x16x32_bf16 v[208:211], a[228:231], a[156:159], v[208:211]
    ds_read_b64_tr_b16 a[88:89], v10 offset:0
    v_mfma_f32_16x16x32_bf16 v[208:211], a[224:227], a[152:155], v[208:211]
    ds_read_b64_tr_b16 a[90:91], v10 offset:1024
    v_mfma_f32_16x16x32_bf16 v[240:243], a[232:235], a[152:155], v[240:243]
    s_add_u32 m0, s52, 32768
    ds_read_b128 a[8:11], v5 offset:2048
    v_mfma_f32_16x16x32_bf16 v[240:243], a[236:239], a[156:159], v[240:243]
    buffer_load_dwordx4 v2, s[8:11], s44 offen  lds
    ds_read_b128 a[12:15], v6 offset:2048
    v_mfma_f32_16x16x32_bf16 v[244:247], a[236:239], a[164:167], v[244:247]
    ds_read_b128 a[16:19], v5 offset:4096
    v_mfma_f32_16x16x32_bf16 v[244:247], a[232:235], a[160:163], v[244:247]
    ds_read_b128 a[20:23], v6 offset:4096
    v_mfma_f32_16x16x32_bf16 v[56:59], a[184:187], a[168:171], v[56:59]
    ds_read_b128 a[24:27], v5 offset:6144
    v_mfma_f32_16x16x32_bf16 v[56:59], a[188:191], a[172:175], v[56:59]
    s_add_u32 m0, s53, 32768
    ds_read_b128 a[28:31], v6 offset:6144
    v_mfma_f32_16x16x32_bf16 v[60:63], a[188:191], a[180:183], v[60:63]
    buffer_load_dwordx4 v2, s[8:11], s45 offen  lds
    ds_read_b128 a[32:35], v5 offset:8192
    v_mfma_f32_16x16x32_bf16 v[60:63], a[184:187], a[176:179], v[60:63]
    ds_read_b128 a[36:39], v6 offset:8192
    v_mfma_f32_16x16x32_bf16 v[124:127], a[192:195], a[176:179], v[124:127]
    ds_read_b128 a[40:43], v5 offset:10240
    v_mfma_f32_16x16x32_bf16 v[124:127], a[196:199], a[180:183], v[124:127]
    ds_read_b128 a[44:47], v6 offset:10240
    v_mfma_f32_16x16x32_bf16 v[120:123], a[196:199], a[172:175], v[120:123]
    s_add_u32 m0, s54, 32768
    ds_read_b128 a[48:51], v5 offset:12288
    v_mfma_f32_16x16x32_bf16 v[120:123], a[192:195], a[168:171], v[120:123]
    buffer_load_dwordx4 v2, s[8:11], s46 offen  lds
    ds_read_b128 a[52:55], v6 offset:12288
    v_mfma_f32_16x16x32_bf16 v[184:187], a[200:203], a[168:171], v[184:187]
    ds_read_b128 a[56:59], v5 offset:14336
    v_mfma_f32_16x16x32_bf16 v[184:187], a[204:207], a[172:175], v[184:187]
    ds_read_b128 a[60:63], v6 offset:14336
    v_mfma_f32_16x16x32_bf16 v[188:191], a[204:207], a[180:183], v[188:191]
    ds_read_b64_tr_b16 a[72:73], v8 offset:0
    v_mfma_f32_16x16x32_bf16 v[188:191], a[200:203], a[176:179], v[188:191]
    s_add_u32 m0, s55, 32768
    ds_read_b64_tr_b16 a[74:75], v8 offset:1024
    v_mfma_f32_16x16x32_bf16 v[92:95], a[208:211], a[176:179], v[92:95]
    buffer_load_dwordx4 v2, s[8:11], s47 offen  lds
    ds_read_b64_tr_b16 a[76:77], v8 offset:8192
    v_mfma_f32_16x16x32_bf16 v[92:95], a[212:215], a[180:183], v[92:95]
    v_add_u32 v2, 458752, v2
    ds_read_b64_tr_b16 a[78:79], v8 offset:9216
    v_mfma_f32_16x16x32_bf16 v[88:91], a[212:215], a[172:175], v[88:91]
    ds_read_b64_tr_b16 a[100:101], v11 offset:8192
    v_mfma_f32_16x16x32_bf16 v[88:91], a[208:211], a[168:171], v[88:91]
    s_add_u32 m0, s21, 98304
    ds_read_b64_tr_b16 a[102:103], v11 offset:9216
    v_mfma_f32_16x16x32_bf16 v[152:155], a[216:219], a[168:171], v[152:155]
    buffer_load_dwordx4 v17, s[96:99], s24 offen offset:0 lds
    ds_read_b64_tr_b16 a[96:97], v11 offset:0
    v_mfma_f32_16x16x32_bf16 v[152:155], a[220:223], a[172:175], v[152:155]
    ds_read_b64_tr_b16 a[98:99], v11 offset:1024
    v_mfma_f32_16x16x32_bf16 v[156:159], a[220:223], a[180:183], v[156:159]
    ds_read_b64_tr_b16 a[80:81], v9 offset:0
    v_mfma_f32_16x16x32_bf16 v[156:159], a[216:219], a[176:179], v[156:159]
    v_mfma_f32_16x16x32_bf16 v[220:223], a[224:227], a[176:179], v[220:223]
    buffer_load_dwordx4 v17, s[96:99], s25 offen offset:1024 lds
    ds_read_b64_tr_b16 a[82:83], v9 offset:1024
    v_mfma_f32_16x16x32_bf16 v[220:223], a[228:231], a[180:183], v[220:223]
    ds_read_b64_tr_b16 a[84:85], v9 offset:8192
    v_mfma_f32_16x16x32_bf16 v[216:219], a[228:231], a[172:175], v[216:219]
    ds_read_b64_tr_b16 a[86:87], v9 offset:9216
    v_mfma_f32_16x16x32_bf16 v[216:219], a[224:227], a[168:171], v[216:219]
    v_mfma_f32_16x16x32_bf16 v[248:251], a[232:235], a[168:171], v[248:251]
    buffer_load_dwordx4 v17, s[96:99], s26 offen offset:2048 lds
    v_mfma_f32_16x16x32_bf16 v[248:251], a[236:239], a[172:175], v[248:251]
    v_mfma_f32_16x16x32_bf16 v[252:255], a[236:239], a[180:183], v[252:255]
    v_mfma_f32_16x16x32_bf16 v[252:255], a[232:235], a[176:179], v[252:255]
    s_waitcnt lgkmcnt(14)
    v_mfma_f32_16x16x32_bf16 v[32:35], a[64:67], a[0:3], v[32:35]
    buffer_load_dwordx4 v17, s[96:99], s27 offen offset:3072 lds
    ds_read_b64_tr_b16 a[108:109], v12 offset:8192
    v_mfma_f32_16x16x32_bf16 v[32:35], a[68:71], a[4:7], v[32:35]
    ds_read_b64_tr_b16 a[110:111], v12 offset:9216
    s_mov_b32 s56, 0xbfb8aa3b
    v_mfma_f32_16x16x32_bf16 v[64:67], a[92:95], a[4:7], v[64:67]
    ds_read_b64_tr_b16 a[104:105], v12 offset:0
    s_mov_b32 s57, 0xbfb8aa3b
    v_mfma_f32_16x16x32_bf16 v[64:67], a[88:91], a[0:3], v[64:67]
    s_add_u32 m0, s21, 114688
    ds_read_b64_tr_b16 a[106:107], v12 offset:1024
    v_mfma_f32_16x16x32_bf16 v[68:71], a[88:91], a[8:11], v[68:71]
    buffer_load_dwordx4 v18, s[96:99], s24 offen offset:0 lds
    ds_read_b64_tr_b16 a[112:113], v13 offset:0
    v_mfma_f32_16x16x32_bf16 v[68:71], a[92:95], a[12:15], v[68:71]
    ds_read_b64_tr_b16 a[114:115], v13 offset:1024
    s_mov_b32 s58, 1.0
    v_mfma_f32_16x16x32_bf16 v[36:39], a[68:71], a[12:15], v[36:39]
    ds_read_b64_tr_b16 a[116:117], v13 offset:8192
    s_mov_b32 s59, 1.0
    v_mfma_f32_16x16x32_bf16 v[36:39], a[64:67], a[8:11], v[36:39]
    ds_read_b64_tr_b16 a[118:119], v13 offset:9216
    s_mov_b32 s4, s100
    v_mfma_f32_16x16x32_bf16 v[40:43], a[64:67], a[16:19], v[40:43]
    buffer_load_dwordx4 v18, s[96:99], s25 offen offset:1024 lds
    s_mov_b32 s5, s101
    v_mfma_f32_16x16x32_bf16 v[40:43], a[68:71], a[20:23], v[40:43]
    v_accvgpr_read_b32 v28, a250
    v_mfma_f32_16x16x32_bf16 v[72:75], a[92:95], a[20:23], v[72:75]
    v_mfma_f32_16x16x32_bf16 v[72:75], a[88:91], a[16:19], v[72:75]
    v_mfma_f32_16x16x32_bf16 v[76:79], a[88:91], a[24:27], v[76:79]
    buffer_load_dwordx4 v18, s[96:99], s26 offen offset:2048 lds
    v_mfma_f32_16x16x32_bf16 v[76:79], a[92:95], a[28:31], v[76:79]
    v_mfma_f32_16x16x32_bf16 v[44:47], a[68:71], a[28:31], v[44:47]
    v_mfma_f32_16x16x32_bf16 v[44:47], a[64:67], a[24:27], v[44:47]
    v_mfma_f32_16x16x32_bf16 v[48:51], a[64:67], a[32:35], v[48:51]
    buffer_load_dwordx4 v18, s[96:99], s27 offen offset:3072 lds
    v_mfma_f32_16x16x32_bf16 v[48:51], a[68:71], a[36:39], v[48:51]
    v_mfma_f32_16x16x32_bf16 v[80:83], a[92:95], a[36:39], v[80:83]
    v_mfma_f32_16x16x32_bf16 v[80:83], a[88:91], a[32:35], v[80:83]
    s_waitcnt vmcnt(8) lgkmcnt(0)
    s_barrier
    v_mfma_f32_16x16x32_bf16 v[84:87], a[88:91], a[40:43], v[84:87]
    ds_read_b128 a[120:123], v3 offset:0
    v_mfma_f32_16x16x32_bf16 v[84:87], a[92:95], a[44:47], v[84:87]
    ds_read_b64_tr_b16 a[184:185], v7 offset:32768
    v_mfma_f32_16x16x32_bf16 v[52:55], a[68:71], a[44:47], v[52:55]
    ds_read_b64_tr_b16 a[186:187], v7 offset:33792
    v_mfma_f32_16x16x32_bf16 v[52:55], a[64:67], a[40:43], v[52:55]
    ds_read_b128 a[124:127], v4 offset:0
    v_mfma_f32_16x16x32_bf16 v[56:59], a[64:67], a[48:51], v[56:59]
    ds_read_b64_tr_b16 a[188:189], v7 offset:40960
    v_mfma_f32_16x16x32_bf16 v[56:59], a[68:71], a[52:55], v[56:59]
    ds_read_b64_tr_b16 a[190:191], v7 offset:41984
    v_mfma_f32_16x16x32_bf16 v[88:91], a[92:95], a[52:55], v[88:91]
    ds_read_b64_tr_b16 a[212:213], v10 offset:40960
    v_mfma_f32_16x16x32_bf16 v[88:91], a[88:91], a[48:51], v[88:91]
    s_add_u32 m0, s21, 131072
    ds_read_b64_tr_b16 a[214:215], v10 offset:41984
    v_mfma_f32_16x16x32_bf16 v[92:95], a[88:91], a[56:59], v[92:95]
    buffer_load_dwordx4 v17, s[96:99], s28 offen offset:0 lds
    ds_read_b64_tr_b16 a[208:209], v10 offset:32768
    v_mfma_f32_16x16x32_bf16 v[92:95], a[92:95], a[60:63], v[92:95]
    ds_read_b64_tr_b16 a[210:211], v10 offset:33792
    v_mfma_f32_16x16x32_bf16 v[60:63], a[68:71], a[60:63], v[60:63]
    ds_read_b128 a[128:131], v3 offset:2048
    v_mfma_f32_16x16x32_bf16 v[60:63], a[64:67], a[56:59], v[60:63]
    ds_read_b128 a[132:135], v4 offset:2048
    s_waitcnt lgkmcnt(9)
    v_mfma_f32_16x16x32_bf16 v[32:35], a[184:187], a[120:123], v[32:35]
    ds_read_b128 a[136:139], v3 offset:4096
    s_waitcnt lgkmcnt(7)
    v_mfma_f32_16x16x32_bf16 v[32:35], a[188:191], a[124:127], v[32:35]
    buffer_load_dwordx4 v17, s[96:99], s29 offen offset:1024 lds
    ds_read_b128 a[140:143], v4 offset:4096
    s_waitcnt lgkmcnt(6)
    v_mfma_f32_16x16x32_bf16 v[64:67], a[212:215], a[124:127], v[64:67]
    ds_read_b128 a[144:147], v3 offset:6144
    s_waitcnt lgkmcnt(5)
    v_mfma_f32_16x16x32_bf16 v[64:67], a[208:211], a[120:123], v[64:67]
    ds_read_b128 a[148:151], v4 offset:6144
    s_waitcnt lgkmcnt(5)
    v_mfma_f32_16x16x32_bf16 v[68:71], a[208:211], a[128:131], v[68:71]
    ds_read_b128 a[152:155], v3 offset:8192
    s_waitcnt lgkmcnt(5)
    v_mfma_f32_16x16x32_bf16 v[68:71], a[212:215], a[132:135], v[68:71]
    ds_read_b128 a[156:159], v4 offset:8192
    v_mfma_f32_16x16x32_bf16 v[36:39], a[188:191], a[132:135], v[36:39]
    buffer_load_dwordx4 v17, s[96:99], s30 offen offset:2048 lds
    ds_read_b128 a[160:163], v3 offset:10240
    v_mfma_f32_16x16x32_bf16 v[36:39], a[184:187], a[128:131], v[36:39]
    ds_read_b128 a[164:167], v4 offset:10240
    s_waitcnt lgkmcnt(7)
    v_mfma_f32_16x16x32_bf16 v[40:43], a[184:187], a[136:139], v[40:43]
    ds_read_b128 a[168:171], v3 offset:12288
    s_waitcnt lgkmcnt(7)
    v_mfma_f32_16x16x32_bf16 v[40:43], a[188:191], a[140:143], v[40:43]
    ds_read_b128 a[172:175], v4 offset:12288
    v_mfma_f32_16x16x32_bf16 v[72:75], a[212:215], a[140:143], v[72:75]
    ds_read_b128 a[176:179], v3 offset:14336
    v_mfma_f32_16x16x32_bf16 v[72:75], a[208:211], a[136:139], v[72:75]
    buffer_load_dwordx4 v17, s[96:99], s31 offen offset:3072 lds
    ds_read_b128 a[180:183], v4 offset:14336
    s_waitcnt lgkmcnt(9)
    v_mfma_f32_16x16x32_bf16 v[76:79], a[208:211], a[144:147], v[76:79]
    ds_read_b64_tr_b16 a[196:197], v8 offset:40960
    s_waitcnt lgkmcnt(9)
    v_mfma_f32_16x16x32_bf16 v[76:79], a[212:215], a[148:151], v[76:79]
    ds_read_b64_tr_b16 a[198:199], v8 offset:41984
    v_mfma_f32_16x16x32_bf16 v[44:47], a[188:191], a[148:151], v[44:47]
    ds_read_b64_tr_b16 a[192:193], v8 offset:32768
    v_mfma_f32_16x16x32_bf16 v[44:47], a[184:187], a[144:147], v[44:47]
    s_add_u32 m0, s21, 147456
    ds_read_b64_tr_b16 a[194:195], v8 offset:33792
    v_pk_mul_f32 v[64:65], v[32:33], v[64:65]
    v_pk_mul_f32 v[32:33], v[32:33], s[56:57]
    v_pk_mul_f32 v[66:67], v[34:35], v[66:67]
    v_exp_f32 v32, v32
    v_pk_mul_f32 v[34:35], v[34:35], s[56:57]
    v_exp_f32 v33, v33
    v_exp_f32 v34, v34
    v_pk_add_f32 v[32:33], v[32:33], s[58:59]
    v_exp_f32 v35, v35
    v_rcp_f32 v32, v32
    v_pk_add_f32 v[34:35], v[34:35], s[58:59]
    v_rcp_f32 v33, v33
    v_rcp_f32 v34, v34
    v_pk_mul_f32 v[64:65], v[32:33], v[64:65]
    v_rcp_f32 v35, v35
    v_cvt_pk_bf16_f32 v32, v64, v65
    v_pk_mul_f32 v[66:67], v[34:35], v[66:67]
    v_cvt_pk_bf16_f32 v33, v66, v67
    s_waitcnt lgkmcnt(11)
    v_mfma_f32_16x16x32_bf16 v[48:51], a[184:187], a[152:155], v[48:51]
    buffer_load_dwordx4 v18, s[96:99], s28 offen offset:0 lds
    ds_read_b64_tr_b16 a[216:217], v11 offset:32768
    s_waitcnt lgkmcnt(11)
    v_mfma_f32_16x16x32_bf16 v[48:51], a[188:191], a[156:159], v[48:51]
    ds_read_b64_tr_b16 a[218:219], v11 offset:33792
    v_mul_f32 v68, v36, v68
    v_mfma_f32_16x16x32_bf16 v[80:83], a[212:215], a[156:159], v[80:83]
    ds_read_b64_tr_b16 a[220:221], v11 offset:40960
    v_mul_f32 v69, v37, v69
    v_mfma_f32_16x16x32_bf16 v[80:83], a[208:211], a[152:155], v[80:83]
    ds_read_b64_tr_b16 a[222:223], v11 offset:41984
    v_mul_f32 v70, v38, v70
    s_waitcnt lgkmcnt(13)
    v_mfma_f32_16x16x32_bf16 v[84:87], a[208:211], a[160:163], v[84:87]
    ds_read_b64_tr_b16 a[204:205], v9 offset:40960
    v_mul_f32 v71, v39, v71
    s_waitcnt lgkmcnt(13)
    v_mfma_f32_16x16x32_bf16 v[84:87], a[212:215], a[164:167], v[84:87]
    buffer_load_dwordx4 v18, s[96:99], s29 offen offset:1024 lds
    ds_read_b64_tr_b16 a[206:207], v9 offset:41984
    v_mfma_f32_16x16x32_bf16 v[52:55], a[188:191], a[164:167], v[52:55]
    ds_read_b64_tr_b16 a[200:201], v9 offset:32768
    v_mul_f32 v36, s56, v36
    v_mfma_f32_16x16x32_bf16 v[52:55], a[184:187], a[160:163], v[52:55]
    ds_read_b64_tr_b16 a[202:203], v9 offset:33792
    v_mul_f32 v37, s56, v37
    s_waitcnt lgkmcnt(14)
    v_mfma_f32_16x16x32_bf16 v[56:59], a[184:187], a[168:171], v[56:59]
    ds_read_b64_tr_b16 a[224:225], v12 offset:32768
    v_mul_f32 v38, s56, v38
    v_mfma_f32_16x16x32_bf16 v[56:59], a[188:191], a[172:175], v[56:59]
    ds_read_b64_tr_b16 a[226:227], v12 offset:33792
    v_mul_f32 v39, s56, v39
    v_mfma_f32_16x16x32_bf16 v[88:91], a[212:215], a[172:175], v[88:91]
    buffer_load_dwordx4 v18, s[96:99], s30 offen offset:2048 lds
    ds_read_b64_tr_b16 a[228:229], v12 offset:40960
    v_mfma_f32_16x16x32_bf16 v[88:91], a[208:211], a[168:171], v[88:91]
    ds_read_b64_tr_b16 a[230:231], v12 offset:41984
    v_exp_f32 v36, v36
    s_waitcnt lgkmcnt(14)
    v_mfma_f32_16x16x32_bf16 v[92:95], a[208:211], a[176:179], v[92:95]
    ds_read_b64_tr_b16 a[236:237], v13 offset:40960
    v_exp_f32 v37, v37
    v_mfma_f32_16x16x32_bf16 v[92:95], a[212:215], a[180:183], v[92:95]
    ds_read_b64_tr_b16 a[238:239], v13 offset:41984
    v_exp_f32 v38, v38
    v_mfma_f32_16x16x32_bf16 v[60:63], a[188:191], a[180:183], v[60:63]
    ds_read_b64_tr_b16 a[232:233], v13 offset:32768
    v_exp_f32 v39, v39
    v_mfma_f32_16x16x32_bf16 v[60:63], a[184:187], a[176:179], v[60:63]
    buffer_load_dwordx4 v18, s[96:99], s31 offen offset:3072 lds
    ds_read_b64_tr_b16 a[234:235], v13 offset:33792
    v_mfma_f32_16x16x32_bf16 v[96:99], a[72:75], a[0:3], v[96:99]
    v_add_f32 v36, 1.0, v36
    v_add_f32 v37, 1.0, v37
    v_mfma_f32_16x16x32_bf16 v[96:99], a[76:79], a[4:7], v[96:99]
    v_add_f32 v38, 1.0, v38
    v_add_f32 v39, 1.0, v39
    v_mfma_f32_16x16x32_bf16 v[96:99], a[196:199], a[124:127], v[96:99]
    v_rcp_f32 v36, v36
    s_waitcnt lgkmcnt(14)
    v_mfma_f32_16x16x32_bf16 v[96:99], a[192:195], a[120:123], v[96:99]
    s_add_u32 m0, s21, 0
    s_waitcnt lgkmcnt(0)
    s_barrier
    v_mfma_f32_16x16x32_bf16 v[128:131], a[216:219], a[120:123], v[128:131]
    buffer_load_dwordx4 v17, s[96:99], s32 offen offset:0 lds
    v_accvgpr_read_b32 v1, a244
    v_mfma_f32_16x16x32_bf16 v[128:131], a[220:223], a[124:127], v[128:131]
    v_accvgpr_read_b32 v2, a245
    v_accvgpr_read_b32 v3, a246
    v_mfma_f32_16x16x32_bf16 v[128:131], a[100:103], a[4:7], v[128:131]
    v_accvgpr_read_b32 v4, a247
    v_accvgpr_read_b32 v13, a249
    v_mfma_f32_16x16x32_bf16 v[128:131], a[96:99], a[0:3], v[128:131]
    v_add_u32 v5, 0x10000, v1
    v_add_u32 v9, 0x20000, v1
    v_mfma_f32_16x16x32_bf16 v[132:135], a[96:99], a[8:11], v[132:135]
    v_add_u32 v6, 0x10000, v2
    v_add_u32 v10, 0x20000, v2
    v_mfma_f32_16x16x32_bf16 v[132:135], a[100:103], a[12:15], v[132:135]
    buffer_load_dwordx4 v17, s[96:99], s33 offen offset:1024 lds
    v_add_u32 v7, 0x10000, v3
    v_mfma_f32_16x16x32_bf16 v[132:135], a[220:223], a[132:135], v[132:135]
    v_add_u32 v11, 0x20000, v3
    v_add_u32 v8, 0x10000, v4
    v_mfma_f32_16x16x32_bf16 v[132:135], a[216:219], a[128:131], v[132:135]
    v_add_u32 v12, 0x20000, v4
    v_add_u32 v0, 114688, v13
    v_mfma_f32_16x16x32_bf16 v[100:103], a[192:195], a[128:131], v[100:103]
    v_rcp_f32 v37, v37
    v_mfma_f32_16x16x32_bf16 v[100:103], a[196:199], a[132:135], v[100:103]
    v_rcp_f32 v38, v38
    v_mfma_f32_16x16x32_bf16 v[100:103], a[76:79], a[12:15], v[100:103]
    buffer_load_dwordx4 v17, s[96:99], s34 offen offset:2048 lds
    v_rcp_f32 v39, v39
    v_mfma_f32_16x16x32_bf16 v[100:103], a[72:75], a[8:11], v[100:103]
    v_mul_f32 v68, v36, v68
    v_mul_f32 v69, v37, v69
    v_mfma_f32_16x16x32_bf16 v[104:107], a[72:75], a[16:19], v[104:107]
    v_mul_f32 v70, v38, v70
    v_mul_f32 v71, v39, v71
    v_mfma_f32_16x16x32_bf16 v[104:107], a[76:79], a[20:23], v[104:107]
    v_cvt_pk_bf16_f32 v34, v68, v69
    v_cvt_pk_bf16_f32 v35, v70, v71
    v_mfma_f32_16x16x32_bf16 v[104:107], a[196:199], a[140:143], v[104:107]
    s_mov_b32 s52, 0
    s_nop 0
    v_mfma_f32_16x16x32_bf16 v[104:107], a[192:195], a[136:139], v[104:107]
    buffer_load_dwordx4 v17, s[96:99], s35 offen offset:3072 lds
    v_permlane16_swap_b32 v32, v34
    v_mfma_f32_16x16x32_bf16 v[136:139], a[216:219], a[136:139], v[136:139]
    v_permlane16_swap_b32 v33, v35
    buffer_store_dwordx4 v[32:35], v14, s[12:15], s52 offen sc1
    v_mfma_f32_16x16x32_bf16 v[136:139], a[220:223], a[140:143], v[136:139]
    v_pk_mul_f32 v[72:73], v[40:41], v[72:73]
    v_pk_mul_f32 v[40:41], v[40:41], s[56:57]
    v_pk_mul_f32 v[74:75], v[42:43], v[74:75]
    v_exp_f32 v40, v40
    v_pk_mul_f32 v[42:43], v[42:43], s[56:57]
    v_exp_f32 v41, v41
    v_exp_f32 v42, v42
    v_pk_add_f32 v[40:41], v[40:41], s[58:59]
    v_exp_f32 v43, v43
    v_rcp_f32 v40, v40
    v_pk_add_f32 v[42:43], v[42:43], s[58:59]
    v_rcp_f32 v41, v41
    v_rcp_f32 v42, v42
    v_pk_mul_f32 v[72:73], v[40:41], v[72:73]
    v_rcp_f32 v43, v43
    v_cvt_pk_bf16_f32 v40, v72, v73
    v_pk_mul_f32 v[74:75], v[42:43], v[74:75]
    v_cvt_pk_bf16_f32 v41, v74, v75
    v_pk_mul_f32 v[76:77], v[44:45], v[76:77]
    v_pk_mul_f32 v[44:45], v[44:45], s[56:57]
    v_pk_mul_f32 v[78:79], v[46:47], v[78:79]
    v_exp_f32 v44, v44
    v_pk_mul_f32 v[46:47], v[46:47], s[56:57]
    v_exp_f32 v45, v45
    v_exp_f32 v46, v46
    v_pk_add_f32 v[44:45], v[44:45], s[58:59]
    v_exp_f32 v47, v47
    v_rcp_f32 v44, v44
    v_pk_add_f32 v[46:47], v[46:47], s[58:59]
    v_rcp_f32 v45, v45
    v_rcp_f32 v46, v46
    v_pk_mul_f32 v[76:77], v[44:45], v[76:77]
    v_rcp_f32 v47, v47
    v_cvt_pk_bf16_f32 v42, v76, v77
    v_pk_mul_f32 v[78:79], v[46:47], v[78:79]
    v_cvt_pk_bf16_f32 v43, v78, v79
    v_mfma_f32_16x16x32_bf16 v[136:139], a[100:103], a[20:23], v[136:139]
    s_mov_b32 s52, 229376
    s_nop 0
    v_mfma_f32_16x16x32_bf16 v[136:139], a[96:99], a[16:19], v[136:139]
    s_add_u32 m0, s21, 16384
    v_permlane16_swap_b32 v40, v42
    v_mfma_f32_16x16x32_bf16 v[140:143], a[96:99], a[24:27], v[140:143]
    buffer_load_dwordx4 v18, s[96:99], s32 offen offset:0 lds
    v_permlane16_swap_b32 v41, v43
    v_mfma_f32_16x16x32_bf16 v[140:143], a[100:103], a[28:31], v[140:143]
    buffer_store_dwordx4 v[40:43], v14, s[12:15], s52 offen sc1
    v_pk_mul_f32 v[80:81], v[48:49], v[80:81]
    v_pk_mul_f32 v[48:49], v[48:49], s[56:57]
    v_pk_mul_f32 v[82:83], v[50:51], v[82:83]
    v_exp_f32 v48, v48
    v_pk_mul_f32 v[50:51], v[50:51], s[56:57]
L_pad6:
    s_cbranch_execz L_pad10
    v_exp_f32 v49, v49
    v_exp_f32 v50, v50
    v_pk_add_f32 v[48:49], v[48:49], s[58:59]
    v_exp_f32 v51, v51
    v_rcp_f32 v48, v48
    v_pk_add_f32 v[50:51], v[50:51], s[58:59]
    v_rcp_f32 v49, v49
    v_rcp_f32 v50, v50
    v_pk_mul_f32 v[80:81], v[48:49], v[80:81]
    v_rcp_f32 v51, v51
    v_cvt_pk_bf16_f32 v48, v80, v81
    v_pk_mul_f32 v[82:83], v[50:51], v[82:83]
    v_cvt_pk_bf16_f32 v49, v82, v83
    v_pk_mul_f32 v[84:85], v[52:53], v[84:85]
    v_pk_mul_f32 v[52:53], v[52:53], s[56:57]
    v_pk_mul_f32 v[86:87], v[54:55], v[86:87]
    v_exp_f32 v52, v52
    v_pk_mul_f32 v[54:55], v[54:55], s[56:57]
    v_exp_f32 v53, v53
    v_exp_f32 v54, v54
    v_pk_add_f32 v[52:53], v[52:53], s[58:59]
    v_exp_f32 v55, v55
    v_rcp_f32 v52, v52
    v_pk_add_f32 v[54:55], v[54:55], s[58:59]
    v_rcp_f32 v53, v53
    v_rcp_f32 v54, v54
    v_pk_mul_f32 v[84:85], v[52:53], v[84:85]
    v_rcp_f32 v55, v55
    v_cvt_pk_bf16_f32 v50, v84, v85
    v_pk_mul_f32 v[86:87], v[54:55], v[86:87]
    v_cvt_pk_bf16_f32 v51, v86, v87
    v_mfma_f32_16x16x32_bf16 v[140:143], a[220:223], a[148:151], v[140:143]
    s_mov_b32 s52, 458752
    s_nop 0
    v_mfma_f32_16x16x32_bf16 v[140:143], a[216:219], a[144:147], v[140:143]
    v_permlane16_swap_b32 v48, v50
    v_permlane16_swap_b32 v49, v51
    v_mfma_f32_16x16x32_bf16 v[108:111], a[192:195], a[144:147], v[108:111]
    buffer_store_dwordx4 v[48:51], v14, s[12:15], s52 offen sc1
    v_pk_mul_f32 v[88:89], v[56:57], v[88:89]
    v_pk_mul_f32 v[56:57], v[56:57], s[56:57]
    v_pk_mul_f32 v[90:91], v[58:59], v[90:91]
    v_exp_f32 v56, v56
    v_pk_mul_f32 v[58:59], v[58:59], s[56:57]
    v_exp_f32 v57, v57
    v_exp_f32 v58, v58
    v_pk_add_f32 v[56:57], v[56:57], s[58:59]
    v_exp_f32 v59, v59
    v_rcp_f32 v56, v56
    v_pk_add_f32 v[58:59], v[58:59], s[58:59]
    v_rcp_f32 v57, v57
    v_rcp_f32 v58, v58
    v_pk_mul_f32 v[88:89], v[56:57], v[88:89]
    v_rcp_f32 v59, v59
    v_cvt_pk_bf16_f32 v56, v88, v89
    v_pk_mul_f32 v[90:91], v[58:59], v[90:91]
    v_cvt_pk_bf16_f32 v57, v90, v91
    v_pk_mul_f32 v[92:93], v[60:61], v[92:93]
    v_pk_mul_f32 v[60:61], v[60:61], s[56:57]
    v_pk_mul_f32 v[94:95], v[62:63], v[94:95]
    v_exp_f32 v60, v60
    v_pk_mul_f32 v[62:63], v[62:63], s[56:57]
    v_exp_f32 v61, v61
    v_exp_f32 v62, v62
    v_pk_add_f32 v[60:61], v[60:61], s[58:59]
    v_exp_f32 v63, v63
    v_rcp_f32 v60, v60
    v_pk_add_f32 v[62:63], v[62:63], s[58:59]
    v_rcp_f32 v61, v61
    v_rcp_f32 v62, v62
    v_pk_mul_f32 v[92:93], v[60:61], v[92:93]
    v_rcp_f32 v63, v63
    v_cvt_pk_bf16_f32 v58, v92, v93
    v_pk_mul_f32 v[94:95], v[62:63], v[94:95]
    v_cvt_pk_bf16_f32 v59, v94, v95
    v_mfma_f32_16x16x32_bf16 v[108:111], a[196:199], a[148:151], v[108:111]
    buffer_load_dwordx4 v18, s[96:99], s33 offen offset:1024 lds
    s_mov_b32 s52, 688128
    v_mfma_f32_16x16x32_bf16 v[108:111], a[76:79], a[28:31], v[108:111]
    s_nop 0
    v_permlane16_swap_b32 v56, v58
    v_mfma_f32_16x16x32_bf16 v[108:111], a[72:75], a[24:27], v[108:111]
    v_permlane16_swap_b32 v57, v59
    buffer_store_dwordx4 v[56:59], v14, s[12:15], s52 offen sc1
    v_mfma_f32_16x16x32_bf16 v[112:115], a[72:75], a[32:35], v[112:115]
    v_pk_mul_f32 v[128:129], v[96:97], v[128:129]
    v_pk_mul_f32 v[96:97], v[96:97], s[56:57]
    v_pk_mul_f32 v[130:131], v[98:99], v[130:131]
    v_exp_f32 v96, v96
    v_pk_mul_f32 v[98:99], v[98:99], s[56:57]
    v_exp_f32 v97, v97
    v_exp_f32 v98, v98
    v_pk_add_f32 v[96:97], v[96:97], s[58:59]
    v_exp_f32 v99, v99
    v_rcp_f32 v96, v96
    v_pk_add_f32 v[98:99], v[98:99], s[58:59]
    v_rcp_f32 v97, v97
    v_rcp_f32 v98, v98
    v_pk_mul_f32 v[128:129], v[96:97], v[128:129]
    v_rcp_f32 v99, v99
    v_cvt_pk_bf16_f32 v96, v128, v129
    v_pk_mul_f32 v[130:131], v[98:99], v[130:131]
    v_cvt_pk_bf16_f32 v97, v130, v131
    v_mfma_f32_16x16x32_bf16 v[112:115], a[76:79], a[36:39], v[112:115]
    v_mul_f32 v132, v100, v132
    v_mul_f32 v133, v101, v133
    v_mfma_f32_16x16x32_bf16 v[112:115], a[196:199], a[156:159], v[112:115]
    buffer_load_dwordx4 v18, s[96:99], s34 offen offset:2048 lds
    v_mul_f32 v134, v102, v134
    v_mfma_f32_16x16x32_bf16 v[112:115], a[192:195], a[152:155], v[112:115]
    v_mul_f32 v135, v103, v135
    v_mul_f32 v100, s56, v100
    v_mfma_f32_16x16x32_bf16 v[144:147], a[216:219], a[152:155], v[144:147]
    v_mul_f32 v101, s56, v101
    v_mul_f32 v102, s56, v102
    v_mfma_f32_16x16x32_bf16 v[144:147], a[220:223], a[156:159], v[144:147]
    v_mul_f32 v103, s56, v103
    v_exp_f32 v100, v100
    v_mfma_f32_16x16x32_bf16 v[144:147], a[100:103], a[36:39], v[144:147]
    v_exp_f32 v101, v101
    v_mfma_f32_16x16x32_bf16 v[144:147], a[96:99], a[32:35], v[144:147]
    buffer_load_dwordx4 v18, s[96:99], s35 offen offset:3072 lds
    v_exp_f32 v102, v102
    v_mfma_f32_16x16x32_bf16 v[148:151], a[96:99], a[40:43], v[148:151]
    v_exp_f32 v103, v103
    v_mfma_f32_16x16x32_bf16 v[148:151], a[100:103], a[44:47], v[148:151]
    v_add_f32 v100, 1.0, v100
    v_add_f32 v101, 1.0, v101
    v_mfma_f32_16x16x32_bf16 v[148:151], a[220:223], a[164:167], v[148:151]
    v_add_f32 v102, 1.0, v102
    v_add_f32 v103, 1.0, v103
    v_mfma_f32_16x16x32_bf16 v[148:151], a[216:219], a[160:163], v[148:151]
    s_add_u32 m0, s21, 32768
    v_rcp_f32 v100, v100
    v_mfma_f32_16x16x32_bf16 v[116:119], a[192:195], a[160:163], v[116:119]
    buffer_load_dwordx4 v17, s[96:99], s36 offen offset:0 lds
    v_rcp_f32 v101, v101
    v_mfma_f32_16x16x32_bf16 v[116:119], a[196:199], a[164:167], v[116:119]
    v_rcp_f32 v102, v102
    v_mfma_f32_16x16x32_bf16 v[116:119], a[76:79], a[44:47], v[116:119]
    v_rcp_f32 v103, v103
    v_mfma_f32_16x16x32_bf16 v[116:119], a[72:75], a[40:43], v[116:119]
    v_mul_f32 v132, v100, v132
    v_mul_f32 v133, v101, v133
    v_mfma_f32_16x16x32_bf16 v[120:123], a[72:75], a[48:51], v[120:123]
    v_mul_f32 v134, v102, v134
    v_mul_f32 v135, v103, v135
    v_mfma_f32_16x16x32_bf16 v[120:123], a[76:79], a[52:55], v[120:123]
    buffer_load_dwordx4 v17, s[96:99], s37 offen offset:1024 lds
    v_cvt_pk_bf16_f32 v98, v132, v133
    v_mfma_f32_16x16x32_bf16 v[120:123], a[196:199], a[172:175], v[120:123]
    v_cvt_pk_bf16_f32 v99, v134, v135
    s_mov_b32 s52, 16384
    v_mfma_f32_16x16x32_bf16 v[120:123], a[192:195], a[168:171], v[120:123]
    s_nop 0
    v_permlane16_swap_b32 v96, v98
    v_mfma_f32_16x16x32_bf16 v[152:155], a[216:219], a[168:171], v[152:155]
    v_permlane16_swap_b32 v97, v99
    buffer_store_dwordx4 v[96:99], v14, s[12:15], s52 offen sc1
    v_mfma_f32_16x16x32_bf16 v[152:155], a[220:223], a[172:175], v[152:155]
    v_pk_mul_f32 v[136:137], v[104:105], v[136:137]
    v_pk_mul_f32 v[104:105], v[104:105], s[56:57]
    v_pk_mul_f32 v[138:139], v[106:107], v[138:139]
    v_exp_f32 v104, v104
    v_pk_mul_f32 v[106:107], v[106:107], s[56:57]
    v_exp_f32 v105, v105
    v_exp_f32 v106, v106
    v_pk_add_f32 v[104:105], v[104:105], s[58:59]
    v_exp_f32 v107, v107
    v_rcp_f32 v104, v104
    v_pk_add_f32 v[106:107], v[106:107], s[58:59]
    v_rcp_f32 v105, v105
    v_rcp_f32 v106, v106
    v_pk_mul_f32 v[136:137], v[104:105], v[136:137]
    v_rcp_f32 v107, v107
    v_cvt_pk_bf16_f32 v104, v136, v137
    v_pk_mul_f32 v[138:139], v[106:107], v[138:139]
    v_cvt_pk_bf16_f32 v105, v138, v139
    v_mfma_f32_16x16x32_bf16 v[152:155], a[100:103], a[52:55], v[152:155]
    buffer_load_dwordx4 v17, s[96:99], s38 offen offset:2048 lds
    v_mul_f32 v140, v108, v140
    v_mfma_f32_16x16x32_bf16 v[152:155], a[96:99], a[48:51], v[152:155]
    v_mul_f32 v141, v109, v141
    v_mul_f32 v142, v110, v142
    v_mfma_f32_16x16x32_bf16 v[156:159], a[96:99], a[56:59], v[156:159]
    v_mul_f32 v143, v111, v143
    v_mul_f32 v108, s56, v108
    v_mfma_f32_16x16x32_bf16 v[156:159], a[100:103], a[60:63], v[156:159]
    v_mul_f32 v109, s56, v109
    v_mul_f32 v110, s56, v110
    v_mfma_f32_16x16x32_bf16 v[156:159], a[220:223], a[180:183], v[156:159]
    v_mul_f32 v111, s56, v111
    v_exp_f32 v108, v108
    v_mfma_f32_16x16x32_bf16 v[156:159], a[216:219], a[176:179], v[156:159]
    buffer_load_dwordx4 v17, s[96:99], s39 offen offset:3072 lds
    v_exp_f32 v109, v109
    v_mfma_f32_16x16x32_bf16 v[124:127], a[192:195], a[176:179], v[124:127]
    v_exp_f32 v110, v110
    v_mfma_f32_16x16x32_bf16 v[124:127], a[196:199], a[180:183], v[124:127]
    v_exp_f32 v111, v111
    v_mfma_f32_16x16x32_bf16 v[124:127], a[76:79], a[60:63], v[124:127]
    v_add_f32 v108, 1.0, v108
    v_add_f32 v109, 1.0, v109
    v_mfma_f32_16x16x32_bf16 v[124:127], a[72:75], a[56:59], v[124:127]
    s_add_u32 m0, s21, 49152
    v_add_f32 v110, 1.0, v110
    v_mfma_f32_16x16x32_bf16 v[160:163], a[80:83], a[0:3], v[160:163]
    buffer_load_dwordx4 v18, s[96:99], s36 offen offset:0 lds
    v_add_f32 v111, 1.0, v111
    v_mfma_f32_16x16x32_bf16 v[160:163], a[84:87], a[4:7], v[160:163]
    v_rcp_f32 v108, v108
    v_mfma_f32_16x16x32_bf16 v[160:163], a[204:207], a[124:127], v[160:163]
    v_rcp_f32 v109, v109
    v_mfma_f32_16x16x32_bf16 v[160:163], a[200:203], a[120:123], v[160:163]
    v_rcp_f32 v110, v110
    v_mfma_f32_16x16x32_bf16 v[192:195], a[224:227], a[120:123], v[192:195]
    v_rcp_f32 v111, v111
    v_mfma_f32_16x16x32_bf16 v[192:195], a[228:231], a[124:127], v[192:195]
    buffer_load_dwordx4 v18, s[96:99], s37 offen offset:1024 lds
    v_mul_f32 v140, v108, v140
    v_mfma_f32_16x16x32_bf16 v[192:195], a[108:111], a[4:7], v[192:195]
    v_mul_f32 v141, v109, v141
    v_mul_f32 v142, v110, v142
    v_mfma_f32_16x16x32_bf16 v[192:195], a[104:107], a[0:3], v[192:195]
    v_mul_f32 v143, v111, v143
    v_cvt_pk_bf16_f32 v106, v140, v141
    v_mfma_f32_16x16x32_bf16 v[196:199], a[104:107], a[8:11], v[196:199]
    v_cvt_pk_bf16_f32 v107, v142, v143
    s_mov_b32 s52, 245760
    v_mfma_f32_16x16x32_bf16 v[196:199], a[108:111], a[12:15], v[196:199]
    s_nop 0
    v_permlane16_swap_b32 v104, v106
    v_mfma_f32_16x16x32_bf16 v[196:199], a[228:231], a[132:135], v[196:199]
    buffer_load_dwordx4 v18, s[96:99], s38 offen offset:2048 lds
    v_permlane16_swap_b32 v105, v107
    v_mfma_f32_16x16x32_bf16 v[196:199], a[224:227], a[128:131], v[196:199]
    buffer_store_dwordx4 v[104:107], v14, s[12:15], s52 offen sc1
    v_mov_b32 v24, 1
    v_mfma_f32_16x16x32_bf16 v[164:167], a[200:203], a[128:131], v[164:167]
    s_waitcnt vmcnt(11)
    buffer_store_dword v24, v19, s[12:15], 0 offen sc1
    v_mfma_f32_16x16x32_bf16 v[164:167], a[204:207], a[132:135], v[164:167]
    v_pk_mul_f32 v[144:145], v[112:113], v[144:145]
    v_pk_mul_f32 v[112:113], v[112:113], s[56:57]
    v_pk_mul_f32 v[146:147], v[114:115], v[146:147]
    v_exp_f32 v112, v112
    v_pk_mul_f32 v[114:115], v[114:115], s[56:57]
    v_exp_f32 v113, v113
    v_exp_f32 v114, v114
    v_pk_add_f32 v[112:113], v[112:113], s[58:59]
    v_exp_f32 v115, v115
    v_rcp_f32 v112, v112
    v_pk_add_f32 v[114:115], v[114:115], s[58:59]
    v_rcp_f32 v113, v113
    v_rcp_f32 v114, v114
    v_pk_mul_f32 v[144:145], v[112:113], v[144:145]
    v_rcp_f32 v115, v115
    v_cvt_pk_bf16_f32 v112, v144, v145
    v_pk_mul_f32 v[146:147], v[114:115], v[146:147]
    v_cvt_pk_bf16_f32 v113, v146, v147
    v_pk_mul_f32 v[148:149], v[116:117], v[148:149]
    v_pk_mul_f32 v[116:117], v[116:117], s[56:57]
    v_pk_mul_f32 v[150:151], v[118:119], v[150:151]
    v_exp_f32 v116, v116
    v_pk_mul_f32 v[118:119], v[118:119], s[56:57]
    v_exp_f32 v117, v117
    v_exp_f32 v118, v118
    v_pk_add_f32 v[116:117], v[116:117], s[58:59]
    v_exp_f32 v119, v119
    v_rcp_f32 v116, v116
    v_pk_add_f32 v[118:119], v[118:119], s[58:59]
    v_rcp_f32 v117, v117
    v_rcp_f32 v118, v118
    v_pk_mul_f32 v[148:149], v[116:117], v[148:149]
    v_rcp_f32 v119, v119
    v_cvt_pk_bf16_f32 v114, v148, v149
    v_pk_mul_f32 v[150:151], v[118:119], v[150:151]
    v_cvt_pk_bf16_f32 v115, v150, v151
    v_mfma_f32_16x16x32_bf16 v[164:167], a[84:87], a[12:15], v[164:167]
    s_mov_b32 s52, 475136
    s_nop 0
    v_mfma_f32_16x16x32_bf16 v[164:167], a[80:83], a[8:11], v[164:167]
    buffer_load_dwordx4 v18, s[96:99], s39 offen offset:3072 lds
    v_permlane16_swap_b32 v112, v114
    v_mfma_f32_16x16x32_bf16 v[168:171], a[80:83], a[16:19], v[168:171]
    v_permlane16_swap_b32 v113, v115
    buffer_store_dwordx4 v[112:115], v14, s[12:15], s52 offen sc1
    v_mfma_f32_16x16x32_bf16 v[168:171], a[84:87], a[20:23], v[168:171]
    v_pk_mul_f32 v[152:153], v[120:121], v[152:153]
    v_pk_mul_f32 v[120:121], v[120:121], s[56:57]
    v_pk_mul_f32 v[154:155], v[122:123], v[154:155]
    v_exp_f32 v120, v120
    v_pk_mul_f32 v[122:123], v[122:123], s[56:57]
    v_exp_f32 v121, v121
    v_exp_f32 v122, v122
    v_pk_add_f32 v[120:121], v[120:121], s[58:59]
    v_exp_f32 v123, v123
    v_rcp_f32 v120, v120
    v_pk_add_f32 v[122:123], v[122:123], s[58:59]
    v_rcp_f32 v121, v121
    v_rcp_f32 v122, v122
    v_pk_mul_f32 v[152:153], v[120:121], v[152:153]
    v_rcp_f32 v123, v123
    v_cvt_pk_bf16_f32 v120, v152, v153
    v_pk_mul_f32 v[154:155], v[122:123], v[154:155]
    v_cvt_pk_bf16_f32 v121, v154, v155
    v_mfma_f32_16x16x32_bf16 v[168:171], a[204:207], a[140:143], v[168:171]
    v_add_u32 v17, 32768, v17
    v_mul_f32 v156, v124, v156
    v_mfma_f32_16x16x32_bf16 v[168:171], a[200:203], a[136:139], v[168:171]
    s_add_u32 m0, s21, 65536
    v_mul_f32 v157, v125, v157
    v_mfma_f32_16x16x32_bf16 v[200:203], a[224:227], a[136:139], v[200:203]
    buffer_load_dwordx4 v17, s[96:99], s24 offen offset:0 lds
    v_mul_f32 v158, v126, v158
    v_mfma_f32_16x16x32_bf16 v[200:203], a[228:231], a[140:143], v[200:203]
    v_mul_f32 v159, v127, v159
    v_mul_f32 v124, s56, v124
    v_mfma_f32_16x16x32_bf16 v[200:203], a[108:111], a[20:23], v[200:203]
    v_mul_f32 v125, s56, v125
    v_mul_f32 v126, s56, v126
    v_mfma_f32_16x16x32_bf16 v[200:203], a[104:107], a[16:19], v[200:203]
    v_mul_f32 v127, s56, v127
    v_exp_f32 v124, v124
    v_mfma_f32_16x16x32_bf16 v[204:207], a[104:107], a[24:27], v[204:207]
    v_exp_f32 v125, v125
    v_mfma_f32_16x16x32_bf16 v[204:207], a[108:111], a[28:31], v[204:207]
    buffer_load_dwordx4 v17, s[96:99], s25 offen offset:1024 lds
    v_exp_f32 v126, v126
    v_mfma_f32_16x16x32_bf16 v[204:207], a[228:231], a[148:151], v[204:207]
    v_exp_f32 v127, v127
    v_mfma_f32_16x16x32_bf16 v[204:207], a[224:227], a[144:147], v[204:207]
    v_add_f32 v124, 1.0, v124
    v_add_f32 v125, 1.0, v125
    v_mfma_f32_16x16x32_bf16 v[172:175], a[200:203], a[144:147], v[172:175]
    v_add_f32 v126, 1.0, v126
    v_add_f32 v127, 1.0, v127
    v_mfma_f32_16x16x32_bf16 v[172:175], a[204:207], a[148:151], v[172:175]
    v_rcp_f32 v124, v124
    v_mfma_f32_16x16x32_bf16 v[172:175], a[84:87], a[28:31], v[172:175]
    buffer_load_dwordx4 v17, s[96:99], s26 offen offset:2048 lds
    v_rcp_f32 v125, v125
    v_mfma_f32_16x16x32_bf16 v[172:175], a[80:83], a[24:27], v[172:175]
    v_rcp_f32 v126, v126
    v_mfma_f32_16x16x32_bf16 v[176:179], a[80:83], a[32:35], v[176:179]
    v_rcp_f32 v127, v127
    v_mfma_f32_16x16x32_bf16 v[176:179], a[84:87], a[36:39], v[176:179]
    v_mul_f32 v156, v124, v156
    v_mul_f32 v157, v125, v157
    v_mfma_f32_16x16x32_bf16 v[176:179], a[204:207], a[156:159], v[176:179]
    v_mul_f32 v158, v126, v158
    v_mul_f32 v159, v127, v159
    v_mfma_f32_16x16x32_bf16 v[176:179], a[200:203], a[152:155], v[176:179]
    buffer_load_dwordx4 v17, s[96:99], s27 offen offset:3072 lds
    v_cvt_pk_bf16_f32 v122, v156, v157
    v_mfma_f32_16x16x32_bf16 v[208:211], a[224:227], a[152:155], v[208:211]
    v_cvt_pk_bf16_f32 v123, v158, v159
    s_mov_b32 s52, 704512
    v_mfma_f32_16x16x32_bf16 v[208:211], a[228:231], a[156:159], v[208:211]
    s_nop 0
    v_permlane16_swap_b32 v120, v122
    v_mfma_f32_16x16x32_bf16 v[208:211], a[108:111], a[36:39], v[208:211]
    v_add_u32 v18, 32768, v18
    v_permlane16_swap_b32 v121, v123
    v_mfma_f32_16x16x32_bf16 v[208:211], a[104:107], a[32:35], v[208:211]
    s_add_u32 m0, s21, 81920
    buffer_store_dwordx4 v[120:123], v14, s[12:15], s52 offen sc1
    v_mfma_f32_16x16x32_bf16 v[212:215], a[104:107], a[40:43], v[212:215]
    buffer_load_dwordx4 v18, s[96:99], s24 offen offset:0 lds
    v_pk_mul_f32 v[192:193], v[160:161], v[192:193]
    v_pk_mul_f32 v[160:161], v[160:161], s[56:57]
    v_pk_mul_f32 v[194:195], v[162:163], v[194:195]
    v_exp_f32 v160, v160
    v_pk_mul_f32 v[162:163], v[162:163], s[56:57]
    v_exp_f32 v161, v161
    v_exp_f32 v162, v162
    v_pk_add_f32 v[160:161], v[160:161], s[58:59]
    v_exp_f32 v163, v163
    v_rcp_f32 v160, v160
    v_pk_add_f32 v[162:163], v[162:163], s[58:59]
    v_rcp_f32 v161, v161
    v_rcp_f32 v162, v162
    v_pk_mul_f32 v[192:193], v[160:161], v[192:193]
    v_rcp_f32 v163, v163
    v_cvt_pk_bf16_f32 v160, v192, v193
    v_pk_mul_f32 v[194:195], v[162:163], v[194:195]
    v_cvt_pk_bf16_f32 v161, v194, v195
    v_pk_mul_f32 v[196:197], v[164:165], v[196:197]
    v_pk_mul_f32 v[164:165], v[164:165], s[56:57]
    v_pk_mul_f32 v[198:199], v[166:167], v[198:199]
    v_exp_f32 v164, v164
    v_pk_mul_f32 v[166:167], v[166:167], s[56:57]
    v_exp_f32 v165, v165
    v_exp_f32 v166, v166
    v_pk_add_f32 v[164:165], v[164:165], s[58:59]
    v_exp_f32 v167, v167
    v_rcp_f32 v164, v164
    v_pk_add_f32 v[166:167], v[166:167], s[58:59]
    v_rcp_f32 v165, v165
    v_rcp_f32 v166, v166
    v_pk_mul_f32 v[196:197], v[164:165], v[196:197]
    v_rcp_f32 v167, v167
    v_cvt_pk_bf16_f32 v162, v196, v197
    v_pk_mul_f32 v[198:199], v[166:167], v[198:199]
    v_cvt_pk_bf16_f32 v163, v198, v199
    v_mfma_f32_16x16x32_bf16 v[212:215], a[108:111], a[44:47], v[212:215]
    s_mov_b32 s52, 32768
    s_nop 0
    v_mfma_f32_16x16x32_bf16 v[212:215], a[228:231], a[164:167], v[212:215]
    v_permlane16_swap_b32 v160, v162
    v_permlane16_swap_b32 v161, v163
    v_mfma_f32_16x16x32_bf16 v[212:215], a[224:227], a[160:163], v[212:215]
    buffer_store_dwordx4 v[160:163], v14, s[12:15], s52 offen sc1
    v_pk_mul_f32 v[200:201], v[168:169], v[200:201]
    v_pk_mul_f32 v[168:169], v[168:169], s[56:57]
    v_pk_mul_f32 v[202:203], v[170:171], v[202:203]
    v_exp_f32 v168, v168
    v_pk_mul_f32 v[170:171], v[170:171], s[56:57]
    v_exp_f32 v169, v169
    v_exp_f32 v170, v170
    v_pk_add_f32 v[168:169], v[168:169], s[58:59]
    v_exp_f32 v171, v171
    v_rcp_f32 v168, v168
    v_pk_add_f32 v[170:171], v[170:171], s[58:59]
    v_rcp_f32 v169, v169
    v_rcp_f32 v170, v170
    v_pk_mul_f32 v[200:201], v[168:169], v[200:201]
    v_rcp_f32 v171, v171
    v_cvt_pk_bf16_f32 v168, v200, v201
    v_pk_mul_f32 v[202:203], v[170:171], v[202:203]
    v_cvt_pk_bf16_f32 v169, v202, v203
    v_mfma_f32_16x16x32_bf16 v[180:183], a[200:203], a[160:163], v[180:183]
    v_mul_f32 v204, v172, v204
    v_mul_f32 v205, v173, v205
    v_mfma_f32_16x16x32_bf16 v[180:183], a[204:207], a[164:167], v[180:183]
    buffer_load_dwordx4 v18, s[96:99], s25 offen offset:1024 lds
    v_mul_f32 v206, v174, v206
    v_mfma_f32_16x16x32_bf16 v[180:183], a[84:87], a[44:47], v[180:183]
    v_mul_f32 v207, v175, v207
    v_mul_f32 v172, s56, v172
    v_mfma_f32_16x16x32_bf16 v[180:183], a[80:83], a[40:43], v[180:183]
    v_mul_f32 v173, s56, v173
    v_mul_f32 v174, s56, v174
    v_mfma_f32_16x16x32_bf16 v[184:187], a[80:83], a[48:51], v[184:187]
    v_mul_f32 v175, s56, v175
    v_exp_f32 v172, v172
    v_mfma_f32_16x16x32_bf16 v[184:187], a[84:87], a[52:55], v[184:187]
    v_exp_f32 v173, v173
    v_mfma_f32_16x16x32_bf16 v[184:187], a[204:207], a[172:175], v[184:187]
    buffer_load_dwordx4 v18, s[96:99], s26 offen offset:2048 lds
    v_exp_f32 v174, v174
    v_mfma_f32_16x16x32_bf16 v[184:187], a[200:203], a[168:171], v[184:187]
    v_exp_f32 v175, v175
    v_mfma_f32_16x16x32_bf16 v[216:219], a[224:227], a[168:171], v[216:219]
    v_add_f32 v172, 1.0, v172
    v_add_f32 v173, 1.0, v173
    v_mfma_f32_16x16x32_bf16 v[216:219], a[228:231], a[172:175], v[216:219]
    v_add_f32 v174, 1.0, v174
    v_add_f32 v175, 1.0, v175
    v_mfma_f32_16x16x32_bf16 v[216:219], a[108:111], a[52:55], v[216:219]
    v_rcp_f32 v172, v172
    v_mfma_f32_16x16x32_bf16 v[216:219], a[104:107], a[48:51], v[216:219]
    buffer_load_dwordx4 v18, s[96:99], s27 offen offset:3072 lds
    v_rcp_f32 v173, v173
    v_mfma_f32_16x16x32_bf16 v[220:223], a[104:107], a[56:59], v[220:223]
    v_rcp_f32 v174, v174
    v_mfma_f32_16x16x32_bf16 v[220:223], a[108:111], a[60:63], v[220:223]
    v_rcp_f32 v175, v175
    v_mfma_f32_16x16x32_bf16 v[220:223], a[228:231], a[180:183], v[220:223]
    v_mul_f32 v204, v172, v204
    v_mul_f32 v205, v173, v205
    v_mfma_f32_16x16x32_bf16 v[220:223], a[224:227], a[176:179], v[220:223]
    v_mul_f32 v206, v174, v206
    v_mul_f32 v207, v175, v207
    v_mfma_f32_16x16x32_bf16 v[188:191], a[200:203], a[176:179], v[188:191]
    v_cvt_pk_bf16_f32 v170, v204, v205
    v_cvt_pk_bf16_f32 v171, v206, v207
    v_mfma_f32_16x16x32_bf16 v[188:191], a[204:207], a[180:183], v[188:191]
    s_mov_b32 s52, 262144
    s_nop 0
    v_mfma_f32_16x16x32_bf16 v[188:191], a[84:87], a[60:63], v[188:191]
    v_permlane16_swap_b32 v168, v170
    v_permlane16_swap_b32 v169, v171
    v_mfma_f32_16x16x32_bf16 v[188:191], a[80:83], a[56:59], v[188:191]
    buffer_store_dwordx4 v[168:171], v14, s[12:15], s52 offen sc1
    buffer_load_dword v29, v28, s[12:15], 0 offen sc1
    v_pk_mul_f32 v[208:209], v[176:177], v[208:209]
    v_pk_mul_f32 v[176:177], v[176:177], s[56:57]
    v_pk_mul_f32 v[210:211], v[178:179], v[210:211]
    v_exp_f32 v176, v176
    v_pk_mul_f32 v[178:179], v[178:179], s[56:57]
    v_exp_f32 v177, v177
    v_exp_f32 v178, v178
    v_pk_add_f32 v[176:177], v[176:177], s[58:59]
    v_exp_f32 v179, v179
    v_rcp_f32 v176, v176
    v_pk_add_f32 v[178:179], v[178:179], s[58:59]
    v_rcp_f32 v177, v177
    v_rcp_f32 v178, v178
    v_pk_mul_f32 v[208:209], v[176:177], v[208:209]
    v_rcp_f32 v179, v179
    v_cvt_pk_bf16_f32 v176, v208, v209
    v_pk_mul_f32 v[210:211], v[178:179], v[210:211]
    v_cvt_pk_bf16_f32 v177, v210, v211
    v_mfma_f32_16x16x32_bf16 v[224:227], a[112:115], a[0:3], v[224:227]
    v_mul_f32 v212, v180, v212
    v_mul_f32 v213, v181, v213
    v_mfma_f32_16x16x32_bf16 v[224:227], a[116:119], a[4:7], v[224:227]
    v_mul_f32 v214, v182, v214
    v_mul_f32 v215, v183, v215
    v_mfma_f32_16x16x32_bf16 v[224:227], a[236:239], a[124:127], v[224:227]
    v_mul_f32 v180, s56, v180
    v_mul_f32 v181, s56, v181
    v_mfma_f32_16x16x32_bf16 v[224:227], a[232:235], a[120:123], v[224:227]
    v_mul_f32 v182, s56, v182
    v_mul_f32 v183, s56, v183
    v_mfma_f32_16x16x32_bf16 v[228:231], a[232:235], a[128:131], v[228:231]
    v_exp_f32 v180, v180
    v_mfma_f32_16x16x32_bf16 v[228:231], a[236:239], a[132:135], v[228:231]
    v_exp_f32 v181, v181
    v_mfma_f32_16x16x32_bf16 v[228:231], a[116:119], a[12:15], v[228:231]
    v_exp_f32 v182, v182
    v_mfma_f32_16x16x32_bf16 v[228:231], a[112:115], a[8:11], v[228:231]
    v_exp_f32 v183, v183
    v_mfma_f32_16x16x32_bf16 v[232:235], a[112:115], a[16:19], v[232:235]
    v_add_f32 v180, 1.0, v180
    v_add_f32 v181, 1.0, v181
    v_mfma_f32_16x16x32_bf16 v[232:235], a[116:119], a[20:23], v[232:235]
    v_add_f32 v182, 1.0, v182
    v_add_f32 v183, 1.0, v183
    v_mfma_f32_16x16x32_bf16 v[232:235], a[236:239], a[140:143], v[232:235]
    v_rcp_f32 v180, v180
    v_mfma_f32_16x16x32_bf16 v[232:235], a[232:235], a[136:139], v[232:235]
    v_rcp_f32 v181, v181
    v_mfma_f32_16x16x32_bf16 v[236:239], a[232:235], a[144:147], v[236:239]
    v_rcp_f32 v182, v182
    v_mfma_f32_16x16x32_bf16 v[236:239], a[236:239], a[148:151], v[236:239]
    v_rcp_f32 v183, v183
    v_mfma_f32_16x16x32_bf16 v[236:239], a[116:119], a[28:31], v[236:239]
    v_mul_f32 v212, v180, v212
    v_mul_f32 v213, v181, v213
    v_mfma_f32_16x16x32_bf16 v[236:239], a[112:115], a[24:27], v[236:239]
    v_mul_f32 v214, v182, v214
    v_mul_f32 v215, v183, v215
    v_mfma_f32_16x16x32_bf16 v[240:243], a[112:115], a[32:35], v[240:243]
    v_cvt_pk_bf16_f32 v178, v212, v213
    v_cvt_pk_bf16_f32 v179, v214, v215
    v_mfma_f32_16x16x32_bf16 v[240:243], a[116:119], a[36:39], v[240:243]
    s_mov_b32 s52, 491520
    s_nop 0
    v_mfma_f32_16x16x32_bf16 v[240:243], a[236:239], a[156:159], v[240:243]
    v_permlane16_swap_b32 v176, v178
    v_permlane16_swap_b32 v177, v179
    v_mfma_f32_16x16x32_bf16 v[240:243], a[232:235], a[152:155], v[240:243]
    buffer_store_dwordx4 v[176:179], v14, s[12:15], s52 offen sc1
    v_pk_mul_f32 v[216:217], v[184:185], v[216:217]
    v_pk_mul_f32 v[184:185], v[184:185], s[56:57]
    v_pk_mul_f32 v[218:219], v[186:187], v[218:219]
    v_exp_f32 v184, v184
    v_pk_mul_f32 v[186:187], v[186:187], s[56:57]
    v_exp_f32 v185, v185
    v_exp_f32 v186, v186
    v_pk_add_f32 v[184:185], v[184:185], s[58:59]
    v_exp_f32 v187, v187
    v_rcp_f32 v184, v184
    v_pk_add_f32 v[186:187], v[186:187], s[58:59]
    v_rcp_f32 v185, v185
    v_rcp_f32 v186, v186
    v_pk_mul_f32 v[216:217], v[184:185], v[216:217]
    v_rcp_f32 v187, v187
    v_cvt_pk_bf16_f32 v184, v216, v217
    v_pk_mul_f32 v[218:219], v[186:187], v[218:219]
    v_cvt_pk_bf16_f32 v185, v218, v219
    v_mfma_f32_16x16x32_bf16 v[244:247], a[232:235], a[160:163], v[244:247]
    v_mul_f32 v220, v188, v220
    v_mul_f32 v221, v189, v221
    v_mfma_f32_16x16x32_bf16 v[244:247], a[236:239], a[164:167], v[244:247]
    v_mul_f32 v222, v190, v222
    v_mul_f32 v223, v191, v223
    v_mfma_f32_16x16x32_bf16 v[244:247], a[116:119], a[44:47], v[244:247]
    v_mul_f32 v188, s56, v188
    v_mul_f32 v189, s56, v189
    v_mfma_f32_16x16x32_bf16 v[244:247], a[112:115], a[40:43], v[244:247]
    v_mul_f32 v190, s56, v190
    v_mul_f32 v191, s56, v191
    v_mfma_f32_16x16x32_bf16 v[248:251], a[112:115], a[48:51], v[248:251]
    v_exp_f32 v188, v188
    v_mfma_f32_16x16x32_bf16 v[248:251], a[116:119], a[52:55], v[248:251]
    v_exp_f32 v189, v189
    v_mfma_f32_16x16x32_bf16 v[248:251], a[236:239], a[172:175], v[248:251]
    v_exp_f32 v190, v190
    v_mfma_f32_16x16x32_bf16 v[248:251], a[232:235], a[168:171], v[248:251]
    v_exp_f32 v191, v191
    v_mfma_f32_16x16x32_bf16 v[252:255], a[232:235], a[176:179], v[252:255]
    v_add_f32 v188, 1.0, v188
    v_add_f32 v189, 1.0, v189
    v_mfma_f32_16x16x32_bf16 v[252:255], a[236:239], a[180:183], v[252:255]
    v_add_f32 v190, 1.0, v190
    v_add_f32 v191, 1.0, v191
    v_mfma_f32_16x16x32_bf16 v[252:255], a[116:119], a[60:63], v[252:255]
    v_rcp_f32 v188, v188
    v_mfma_f32_16x16x32_bf16 v[252:255], a[112:115], a[56:59], v[252:255]
    s_nop 6
    v_rcp_f32 v189, v189
    v_rcp_f32 v190, v190
    v_rcp_f32 v191, v191
    v_mul_f32 v220, v188, v220
    v_mul_f32 v221, v189, v221
    v_mul_f32 v222, v190, v222
    v_mul_f32 v223, v191, v223
    v_cvt_pk_bf16_f32 v186, v220, v221
    v_cvt_pk_bf16_f32 v187, v222, v223
    s_mov_b32 s52, 720896
    s_nop 0
    v_permlane16_swap_b32 v184, v186
    v_permlane16_swap_b32 v185, v187
    buffer_store_dwordx4 v[184:187], v14, s[12:15], s52 offen sc1
    v_permlane32_swap_b32 v224, v228
    v_permlane32_swap_b32 v225, v229
    v_permlane32_swap_b32 v226, v230
    v_permlane32_swap_b32 v227, v231
    v_pk_mul_f32 v[228:229], v[224:225], v[228:229]
    v_pk_mul_f32 v[224:225], v[224:225], s[56:57]
    v_pk_mul_f32 v[230:231], v[226:227], v[230:231]
    v_exp_f32 v224, v224
    v_pk_mul_f32 v[226:227], v[226:227], s[56:57]
    v_exp_f32 v225, v225
    v_exp_f32 v226, v226
    v_pk_add_f32 v[224:225], v[224:225], s[58:59]
    v_exp_f32 v227, v227
    v_rcp_f32 v224, v224
    v_pk_add_f32 v[226:227], v[226:227], s[58:59]
    v_rcp_f32 v225, v225
    v_rcp_f32 v226, v226
    v_pk_mul_f32 v[228:229], v[224:225], v[228:229]
    v_rcp_f32 v227, v227
    v_cvt_pk_bf16_f32 v224, v228, v229
    v_pk_mul_f32 v[230:231], v[226:227], v[230:231]
    v_cvt_pk_bf16_f32 v225, v230, v231
    v_permlane32_swap_b32 v232, v236
    v_permlane32_swap_b32 v233, v237
    v_permlane32_swap_b32 v234, v238
    v_permlane32_swap_b32 v235, v239
    v_pk_mul_f32 v[236:237], v[232:233], v[236:237]
    v_pk_mul_f32 v[232:233], v[232:233], s[56:57]
    v_pk_mul_f32 v[238:239], v[234:235], v[238:239]
    v_exp_f32 v232, v232
    v_pk_mul_f32 v[234:235], v[234:235], s[56:57]
    v_exp_f32 v233, v233
    v_exp_f32 v234, v234
    v_pk_add_f32 v[232:233], v[232:233], s[58:59]
    v_exp_f32 v235, v235
    v_rcp_f32 v232, v232
    v_pk_add_f32 v[234:235], v[234:235], s[58:59]
    v_rcp_f32 v233, v233
    v_rcp_f32 v234, v234
    v_pk_mul_f32 v[236:237], v[232:233], v[236:237]
    v_rcp_f32 v235, v235
    v_cvt_pk_bf16_f32 v226, v236, v237
    v_pk_mul_f32 v[238:239], v[234:235], v[238:239]
    v_cvt_pk_bf16_f32 v227, v238, v239
    s_mov_b32 s52, 0
    s_nop 0
    v_permlane16_swap_b32 v224, v226
    v_permlane16_swap_b32 v225, v227
    buffer_store_dwordx4 v[224:227], v15, s[12:15], s52 offen sc1
    s_waitcnt vmcnt(3)
    v_cmp_gt_u32 vcc, 1, v29
    s_cbranch_vccz L_spin1_ret
    s_mov_b32 s3, 0x40000
L_spin1_loop:
    buffer_load_dword v29, v28, s[12:15], 0 offen sc1
L_pad7:
    s_cbranch_execz L_pad11
    s_sub_u32 s3, s3, 1
    s_cmp_eq_u32 s3, 0
    s_waitcnt vmcnt(0)
    s_cbranch_scc1 L_spin1_ret
    v_cmp_gt_u32 vcc, 1, v29
    s_cbranch_vccnz L_spin1_loop
L_spin1_ret:
    s_mov_b32 s40, 0
    buffer_load_dwordx4 v[32:35], v13, s[12:15], s40 offen offset:0 sc1
    buffer_load_dwordx4 v[36:39], v0, s[12:15], s40 offen offset:0 sc1
    buffer_load_dwordx4 v[40:43], v13, s[12:15], s40 offen offset:1024 sc1
    buffer_load_dwordx4 v[44:47], v0, s[12:15], s40 offen offset:1024 sc1
    buffer_load_dwordx4 v[48:51], v13, s[12:15], s40 offen offset:2048 sc1
    buffer_load_dwordx4 v[52:55], v0, s[12:15], s40 offen offset:2048 sc1
    buffer_load_dwordx4 v[56:59], v13, s[12:15], s40 offen offset:3072 sc1
    buffer_load_dwordx4 v[60:63], v0, s[12:15], s40 offen offset:3072 sc1
    s_barrier
    ds_read_b64_tr_b16 a[0:1], v5 offset:32768
    ds_read_b64_tr_b16 a[2:3], v5 offset:33280
    ds_read_b64_tr_b16 a[4:5], v5 offset:33792
    ds_read_b64_tr_b16 a[6:7], v5 offset:34304
    ds_read_b64_tr_b16 a[8:9], v5 offset:34816
    ds_read_b64_tr_b16 a[10:11], v5 offset:35328
    ds_read_b64_tr_b16 a[12:13], v5 offset:35840
    ds_read_b64_tr_b16 a[14:15], v5 offset:36352
    ds_read_b64_tr_b16 a[16:17], v6 offset:32768
    ds_read_b64_tr_b16 a[18:19], v6 offset:33280
    ds_read_b64_tr_b16 a[20:21], v6 offset:33792
    ds_read_b64_tr_b16 a[22:23], v6 offset:34304
    ds_read_b64_tr_b16 a[24:25], v6 offset:34816
    ds_read_b64_tr_b16 a[26:27], v6 offset:35328
    ds_read_b64_tr_b16 a[28:29], v6 offset:35840
    ds_read_b64_tr_b16 a[30:31], v6 offset:36352
    v_permlane32_swap_b32 v240, v244
    v_permlane32_swap_b32 v241, v245
    v_permlane32_swap_b32 v242, v246
    v_permlane32_swap_b32 v243, v247
    v_pk_mul_f32 v[244:245], v[240:241], v[244:245]
    v_pk_mul_f32 v[240:241], v[240:241], s[56:57]
    v_pk_mul_f32 v[246:247], v[242:243], v[246:247]
    v_exp_f32 v240, v240
    v_pk_mul_f32 v[242:243], v[242:243], s[56:57]
    v_exp_f32 v241, v241
    v_exp_f32 v242, v242
    v_pk_add_f32 v[240:241], v[240:241], s[58:59]
    v_exp_f32 v243, v243
    v_rcp_f32 v240, v240
    v_pk_add_f32 v[242:243], v[242:243], s[58:59]
    v_rcp_f32 v241, v241
    v_rcp_f32 v242, v242
    v_pk_mul_f32 v[244:245], v[240:241], v[244:245]
    v_rcp_f32 v243, v243
    v_cvt_pk_bf16_f32 v240, v244, v245
    v_pk_mul_f32 v[246:247], v[242:243], v[246:247]
    v_cvt_pk_bf16_f32 v241, v246, v247
    v_permlane32_swap_b32 v248, v252
    v_permlane32_swap_b32 v249, v253
    v_permlane32_swap_b32 v250, v254
    v_permlane32_swap_b32 v251, v255
    v_pk_mul_f32 v[252:253], v[248:249], v[252:253]
    v_pk_mul_f32 v[248:249], v[248:249], s[56:57]
    v_pk_mul_f32 v[254:255], v[250:251], v[254:255]
    v_exp_f32 v248, v248
    v_pk_mul_f32 v[250:251], v[250:251], s[56:57]
    v_exp_f32 v249, v249
    v_exp_f32 v250, v250
    v_pk_add_f32 v[248:249], v[248:249], s[58:59]
    v_exp_f32 v251, v251
    v_rcp_f32 v248, v248
    v_pk_add_f32 v[250:251], v[250:251], s[58:59]
    v_rcp_f32 v249, v249
    v_rcp_f32 v250, v250
    v_pk_mul_f32 v[252:253], v[248:249], v[252:253]
    v_rcp_f32 v251, v251
    v_cvt_pk_bf16_f32 v242, v252, v253
    v_pk_mul_f32 v[254:255], v[250:251], v[254:255]
    v_cvt_pk_bf16_f32 v243, v254, v255
    s_mov_b32 s52, 458752
    s_nop 0
    v_permlane16_swap_b32 v240, v242
    v_permlane16_swap_b32 v241, v243
    buffer_store_dwordx4 v[240:243], v15, s[12:15], s52 offen sc1
    s_waitcnt vmcnt(7) lgkmcnt(8)
    v_mfma_f32_16x16x32_bf16 v[96:99], a[0:3], v[32:35], 0
    ds_read_b64_tr_b16 a[32:33], v7 offset:32768
    s_mov_b32 s41, 4096
    s_waitcnt vmcnt(5)
    v_mfma_f32_16x16x32_bf16 v[96:99], a[4:7], v[40:43], v[96:99]
    ds_read_b64_tr_b16 a[34:35], v7 offset:33280
    buffer_load_dwordx4 v[64:67], v13, s[12:15], s41 offen offset:0 sc1
    s_waitcnt vmcnt(4)
    v_mfma_f32_16x16x32_bf16 v[96:99], a[8:11], v[48:51], v[96:99]
    ds_read_b64_tr_b16 a[36:37], v7 offset:33792
    s_waitcnt vmcnt(2)
    v_mfma_f32_16x16x32_bf16 v[96:99], a[12:15], v[56:59], v[96:99]
    ds_read_b64_tr_b16 a[38:39], v7 offset:34304
    v_mfma_f32_16x16x32_bf16 v[112:115], a[12:15], v[60:63], 0
    ds_read_b64_tr_b16 a[40:41], v7 offset:34816
    v_mfma_f32_16x16x32_bf16 v[112:115], a[8:11], v[52:55], v[112:115]
    ds_read_b64_tr_b16 a[42:43], v7 offset:35328
    v_mfma_f32_16x16x32_bf16 v[112:115], a[4:7], v[44:47], v[112:115]
    ds_read_b64_tr_b16 a[44:45], v7 offset:35840
    v_mfma_f32_16x16x32_bf16 v[112:115], a[0:3], v[36:39], v[112:115]
    ds_read_b64_tr_b16 a[46:47], v7 offset:36352
    s_waitcnt lgkmcnt(8)
    v_mfma_f32_16x16x32_bf16 v[100:103], a[16:19], v[32:35], 0
    ds_read_b64_tr_b16 a[0:1], v8 offset:32768
    buffer_load_dwordx4 v[68:71], v0, s[12:15], s41 offen offset:0 sc1
    v_mfma_f32_16x16x32_bf16 v[100:103], a[20:23], v[40:43], v[100:103]
    ds_read_b64_tr_b16 a[2:3], v8 offset:33280
    v_mfma_f32_16x16x32_bf16 v[100:103], a[24:27], v[48:51], v[100:103]
    ds_read_b64_tr_b16 a[4:5], v8 offset:33792
    v_mfma_f32_16x16x32_bf16 v[100:103], a[28:31], v[56:59], v[100:103]
    ds_read_b64_tr_b16 a[6:7], v8 offset:34304
    buffer_load_dwordx4 v[72:75], v13, s[12:15], s41 offen offset:1024 sc1
    v_mfma_f32_16x16x32_bf16 v[116:119], a[28:31], v[60:63], 0
    ds_read_b64_tr_b16 a[8:9], v8 offset:34816
    v_mfma_f32_16x16x32_bf16 v[116:119], a[24:27], v[52:55], v[116:119]
    ds_read_b64_tr_b16 a[10:11], v8 offset:35328
    v_mfma_f32_16x16x32_bf16 v[116:119], a[20:23], v[44:47], v[116:119]
    ds_read_b64_tr_b16 a[12:13], v8 offset:35840
    ds_read_b64_tr_b16 a[14:15], v8 offset:36352
    v_mfma_f32_16x16x32_bf16 v[116:119], a[16:19], v[36:39], v[116:119]
    s_waitcnt lgkmcnt(8)
    s_barrier
    v_mfma_f32_16x16x32_bf16 v[104:107], a[32:35], v[32:35], 0
    ds_read_b64_tr_b16 a[16:17], v5 offset:49152
    buffer_load_dwordx4 v[76:79], v0, s[12:15], s41 offen offset:1024 sc1
    v_mfma_f32_16x16x32_bf16 v[104:107], a[36:39], v[40:43], v[104:107]
    ds_read_b64_tr_b16 a[18:19], v5 offset:49664
    v_mfma_f32_16x16x32_bf16 v[104:107], a[40:43], v[48:51], v[104:107]
    ds_read_b64_tr_b16 a[20:21], v5 offset:50176
    v_mfma_f32_16x16x32_bf16 v[104:107], a[44:47], v[56:59], v[104:107]
    ds_read_b64_tr_b16 a[22:23], v5 offset:50688
    buffer_load_dwordx4 v[80:83], v13, s[12:15], s41 offen offset:2048 sc1
    v_mfma_f32_16x16x32_bf16 v[120:123], a[44:47], v[60:63], 0
    ds_read_b64_tr_b16 a[24:25], v5 offset:51200
    v_mfma_f32_16x16x32_bf16 v[120:123], a[40:43], v[52:55], v[120:123]
    ds_read_b64_tr_b16 a[26:27], v5 offset:51712
    v_mfma_f32_16x16x32_bf16 v[120:123], a[36:39], v[44:47], v[120:123]
    ds_read_b64_tr_b16 a[28:29], v5 offset:52224
    buffer_load_dwordx4 v[84:87], v0, s[12:15], s41 offen offset:2048 sc1
    v_mfma_f32_16x16x32_bf16 v[120:123], a[32:35], v[36:39], v[120:123]
    ds_read_b64_tr_b16 a[30:31], v5 offset:52736
    s_waitcnt lgkmcnt(8)
    v_mfma_f32_16x16x32_bf16 v[108:111], a[0:3], v[32:35], 0
    ds_read_b64_tr_b16 a[32:33], v6 offset:49152
    buffer_load_dwordx4 v[88:91], v13, s[12:15], s41 offen offset:3072 sc1
    v_mfma_f32_16x16x32_bf16 v[108:111], a[4:7], v[40:43], v[108:111]
    ds_read_b64_tr_b16 a[34:35], v6 offset:49664
    v_mfma_f32_16x16x32_bf16 v[108:111], a[8:11], v[48:51], v[108:111]
    ds_read_b64_tr_b16 a[36:37], v6 offset:50176
    v_mfma_f32_16x16x32_bf16 v[108:111], a[12:15], v[56:59], v[108:111]
    ds_read_b64_tr_b16 a[38:39], v6 offset:50688
    buffer_load_dwordx4 v[92:95], v0, s[12:15], s41 offen offset:3072 sc1
    v_mfma_f32_16x16x32_bf16 v[124:127], a[12:15], v[60:63], 0
    ds_read_b64_tr_b16 a[40:41], v6 offset:51200
    v_mfma_f32_16x16x32_bf16 v[124:127], a[8:11], v[52:55], v[124:127]
    ds_read_b64_tr_b16 a[42:43], v6 offset:51712
    v_mfma_f32_16x16x32_bf16 v[124:127], a[4:7], v[44:47], v[124:127]
    ds_read_b64_tr_b16 a[44:45], v6 offset:52224
    v_mfma_f32_16x16x32_bf16 v[124:127], a[0:3], v[36:39], v[124:127]
    ds_read_b64_tr_b16 a[46:47], v6 offset:52736
    s_waitcnt lgkmcnt(8)
    v_mfma_f32_16x16x32_bf16 v[128:131], a[16:19], v[32:35], 0
    ds_read_b64_tr_b16 a[0:1], v7 offset:49152
    v_mov_b32 v24, 4
    v_mfma_f32_16x16x32_bf16 v[128:131], a[20:23], v[40:43], v[128:131]
    ds_read_b64_tr_b16 a[2:3], v7 offset:49664
    s_waitcnt vmcnt(8)
    buffer_store_dword v24, v19, s[12:15], 0 offen sc1
    v_mfma_f32_16x16x32_bf16 v[128:131], a[24:27], v[48:51], v[128:131]
    ds_read_b64_tr_b16 a[4:5], v7 offset:50176
    v_mfma_f32_16x16x32_bf16 v[128:131], a[28:31], v[56:59], v[128:131]
    ds_read_b64_tr_b16 a[6:7], v7 offset:50688
    v_mfma_f32_16x16x32_bf16 v[144:147], a[28:31], v[60:63], 0
    ds_read_b64_tr_b16 a[8:9], v7 offset:51200
    s_mov_b32 s42, 8192
    v_mfma_f32_16x16x32_bf16 v[144:147], a[24:27], v[52:55], v[144:147]
    ds_read_b64_tr_b16 a[10:11], v7 offset:51712
    buffer_load_dwordx4 a[48:51], v13, s[12:15], s42 offen offset:0 sc1
    v_mfma_f32_16x16x32_bf16 v[144:147], a[20:23], v[44:47], v[144:147]
    ds_read_b64_tr_b16 a[12:13], v7 offset:52224
    buffer_load_dwordx4 a[52:55], v0, s[12:15], s42 offen offset:0 sc1
    v_mfma_f32_16x16x32_bf16 v[144:147], a[16:19], v[36:39], v[144:147]
    ds_read_b64_tr_b16 a[14:15], v7 offset:52736
    s_waitcnt lgkmcnt(8)
    v_mfma_f32_16x16x32_bf16 v[132:135], a[32:35], v[32:35], 0
    ds_read_b64_tr_b16 a[16:17], v8 offset:49152
    buffer_load_dwordx4 a[56:59], v13, s[12:15], s42 offen offset:1024 sc1
    v_mfma_f32_16x16x32_bf16 v[132:135], a[36:39], v[40:43], v[132:135]
    ds_read_b64_tr_b16 a[18:19], v8 offset:49664
    v_mfma_f32_16x16x32_bf16 v[132:135], a[40:43], v[48:51], v[132:135]
    ds_read_b64_tr_b16 a[20:21], v8 offset:50176
    v_mfma_f32_16x16x32_bf16 v[132:135], a[44:47], v[56:59], v[132:135]
    ds_read_b64_tr_b16 a[22:23], v8 offset:50688
    buffer_load_dwordx4 a[60:63], v0, s[12:15], s42 offen offset:1024 sc1
    v_mfma_f32_16x16x32_bf16 v[148:151], a[44:47], v[60:63], 0
    ds_read_b64_tr_b16 a[24:25], v8 offset:51200
    v_mfma_f32_16x16x32_bf16 v[148:151], a[40:43], v[52:55], v[148:151]
    ds_read_b64_tr_b16 a[26:27], v8 offset:51712
    v_mfma_f32_16x16x32_bf16 v[148:151], a[36:39], v[44:47], v[148:151]
    ds_read_b64_tr_b16 a[28:29], v8 offset:52224
    ds_read_b64_tr_b16 a[30:31], v8 offset:52736
    v_mfma_f32_16x16x32_bf16 v[148:151], a[32:35], v[36:39], v[148:151]
    s_waitcnt lgkmcnt(8)
    s_barrier
    v_mfma_f32_16x16x32_bf16 v[136:139], a[0:3], v[32:35], 0
    ds_read_b64_tr_b16 a[32:33], v9 offset:0
    buffer_load_dwordx4 a[64:67], v13, s[12:15], s42 offen offset:2048 sc1
    v_mfma_f32_16x16x32_bf16 v[136:139], a[4:7], v[40:43], v[136:139]
    ds_read_b64_tr_b16 a[34:35], v9 offset:512
    v_mfma_f32_16x16x32_bf16 v[136:139], a[8:11], v[48:51], v[136:139]
    ds_read_b64_tr_b16 a[36:37], v9 offset:1024
    v_mfma_f32_16x16x32_bf16 v[136:139], a[12:15], v[56:59], v[136:139]
    ds_read_b64_tr_b16 a[38:39], v9 offset:1536
    v_mfma_f32_16x16x32_bf16 v[152:155], a[12:15], v[60:63], 0
    ds_read_b64_tr_b16 a[40:41], v9 offset:2048
    v_mfma_f32_16x16x32_bf16 v[152:155], a[8:11], v[52:55], v[152:155]
    ds_read_b64_tr_b16 a[42:43], v9 offset:2560
    v_mfma_f32_16x16x32_bf16 v[152:155], a[4:7], v[44:47], v[152:155]
    ds_read_b64_tr_b16 a[44:45], v9 offset:3072
    v_mfma_f32_16x16x32_bf16 v[152:155], a[0:3], v[36:39], v[152:155]
    ds_read_b64_tr_b16 a[46:47], v9 offset:3584
    s_waitcnt lgkmcnt(8)
    v_mfma_f32_16x16x32_bf16 v[140:143], a[16:19], v[32:35], 0
    ds_read_b64_tr_b16 a[0:1], v10 offset:0
    buffer_load_dwordx4 a[68:71], v0, s[12:15], s42 offen offset:2048 sc1
    v_mfma_f32_16x16x32_bf16 v[140:143], a[20:23], v[40:43], v[140:143]
    ds_read_b64_tr_b16 a[2:3], v10 offset:512
    v_mfma_f32_16x16x32_bf16 v[140:143], a[24:27], v[48:51], v[140:143]
    ds_read_b64_tr_b16 a[4:5], v10 offset:1024
    v_mfma_f32_16x16x32_bf16 v[140:143], a[28:31], v[56:59], v[140:143]
    ds_read_b64_tr_b16 a[6:7], v10 offset:1536
    buffer_load_dwordx4 a[72:75], v13, s[12:15], s42 offen offset:3072 sc1
    v_mfma_f32_16x16x32_bf16 v[156:159], a[28:31], v[60:63], 0
    ds_read_b64_tr_b16 a[8:9], v10 offset:2048
    v_mfma_f32_16x16x32_bf16 v[156:159], a[24:27], v[52:55], v[156:159]
    ds_read_b64_tr_b16 a[10:11], v10 offset:2560
    v_mfma_f32_16x16x32_bf16 v[156:159], a[20:23], v[44:47], v[156:159]
    ds_read_b64_tr_b16 a[12:13], v10 offset:3072
    v_mfma_f32_16x16x32_bf16 v[156:159], a[16:19], v[36:39], v[156:159]
    ds_read_b64_tr_b16 a[14:15], v10 offset:3584
    s_waitcnt vmcnt(8) lgkmcnt(8)
    v_mfma_f32_16x16x32_bf16 v[96:99], a[32:35], v[64:67], v[96:99]
    ds_read_b64_tr_b16 a[16:17], v11 offset:0
    buffer_load_dwordx4 a[76:79], v0, s[12:15], s42 offen offset:3072 sc1
    v_mfma_f32_16x16x32_bf16 v[96:99], a[36:39], v[72:75], v[96:99]
    ds_read_b64_tr_b16 a[18:19], v11 offset:512
    v_mfma_f32_16x16x32_bf16 v[96:99], a[40:43], v[80:83], v[96:99]
    ds_read_b64_tr_b16 a[20:21], v11 offset:1024
    v_mfma_f32_16x16x32_bf16 v[96:99], a[44:47], v[88:91], v[96:99]
    ds_read_b64_tr_b16 a[22:23], v11 offset:1536
    s_mov_b32 s43, 12288
    v_mfma_f32_16x16x32_bf16 v[112:115], a[44:47], v[92:95], v[112:115]
    ds_read_b64_tr_b16 a[24:25], v11 offset:2048
    buffer_load_dwordx4 a[80:83], v13, s[12:15], s43 offen offset:0 sc1
    v_mfma_f32_16x16x32_bf16 v[112:115], a[40:43], v[84:87], v[112:115]
    ds_read_b64_tr_b16 a[26:27], v11 offset:2560
    v_mfma_f32_16x16x32_bf16 v[112:115], a[36:39], v[76:79], v[112:115]
    ds_read_b64_tr_b16 a[28:29], v11 offset:3072
    v_mfma_f32_16x16x32_bf16 v[112:115], a[32:35], v[68:71], v[112:115]
    ds_read_b64_tr_b16 a[30:31], v11 offset:3584
    s_waitcnt lgkmcnt(8)
    v_mfma_f32_16x16x32_bf16 v[100:103], a[0:3], v[64:67], v[100:103]
    ds_read_b64_tr_b16 a[32:33], v12 offset:0
    buffer_load_dwordx4 a[84:87], v0, s[12:15], s43 offen offset:0 sc1
    v_mfma_f32_16x16x32_bf16 v[100:103], a[4:7], v[72:75], v[100:103]
    ds_read_b64_tr_b16 a[34:35], v12 offset:512
    v_mfma_f32_16x16x32_bf16 v[100:103], a[8:11], v[80:83], v[100:103]
    ds_read_b64_tr_b16 a[36:37], v12 offset:1024
    v_mfma_f32_16x16x32_bf16 v[100:103], a[12:15], v[88:91], v[100:103]
    ds_read_b64_tr_b16 a[38:39], v12 offset:1536
    buffer_load_dwordx4 a[88:91], v13, s[12:15], s43 offen offset:1024 sc1
    v_mfma_f32_16x16x32_bf16 v[116:119], a[12:15], v[92:95], v[116:119]
    ds_read_b64_tr_b16 a[40:41], v12 offset:2048
    v_mfma_f32_16x16x32_bf16 v[116:119], a[8:11], v[84:87], v[116:119]
    ds_read_b64_tr_b16 a[42:43], v12 offset:2560
    v_mfma_f32_16x16x32_bf16 v[116:119], a[4:7], v[76:79], v[116:119]
    ds_read_b64_tr_b16 a[44:45], v12 offset:3072
    ds_read_b64_tr_b16 a[46:47], v12 offset:3584
    v_mfma_f32_16x16x32_bf16 v[116:119], a[0:3], v[68:71], v[116:119]
    s_waitcnt lgkmcnt(8)
    s_barrier
    v_mfma_f32_16x16x32_bf16 v[104:107], a[16:19], v[64:67], v[104:107]
    ds_read_b64_tr_b16 a[0:1], v9 offset:16384
    buffer_load_dwordx4 a[92:95], v0, s[12:15], s43 offen offset:1024 sc1
    v_mfma_f32_16x16x32_bf16 v[104:107], a[20:23], v[72:75], v[104:107]
    ds_read_b64_tr_b16 a[2:3], v9 offset:16896
    v_mfma_f32_16x16x32_bf16 v[104:107], a[24:27], v[80:83], v[104:107]
    ds_read_b64_tr_b16 a[4:5], v9 offset:17408
    v_mfma_f32_16x16x32_bf16 v[104:107], a[28:31], v[88:91], v[104:107]
    ds_read_b64_tr_b16 a[6:7], v9 offset:17920
    buffer_load_dwordx4 a[96:99], v13, s[12:15], s43 offen offset:2048 sc1
    v_mfma_f32_16x16x32_bf16 v[120:123], a[28:31], v[92:95], v[120:123]
    ds_read_b64_tr_b16 a[8:9], v9 offset:18432
    v_mfma_f32_16x16x32_bf16 v[120:123], a[24:27], v[84:87], v[120:123]
    ds_read_b64_tr_b16 a[10:11], v9 offset:18944
    v_mfma_f32_16x16x32_bf16 v[120:123], a[20:23], v[76:79], v[120:123]
    ds_read_b64_tr_b16 a[12:13], v9 offset:19456
    v_mfma_f32_16x16x32_bf16 v[120:123], a[16:19], v[68:71], v[120:123]
    ds_read_b64_tr_b16 a[14:15], v9 offset:19968
    s_waitcnt lgkmcnt(8)
    v_mfma_f32_16x16x32_bf16 v[108:111], a[32:35], v[64:67], v[108:111]
    ds_read_b64_tr_b16 a[16:17], v10 offset:16384
    buffer_load_dwordx4 a[100:103], v0, s[12:15], s43 offen offset:2048 sc1
    v_mfma_f32_16x16x32_bf16 v[108:111], a[36:39], v[72:75], v[108:111]
    ds_read_b64_tr_b16 a[18:19], v10 offset:16896
    v_mfma_f32_16x16x32_bf16 v[108:111], a[40:43], v[80:83], v[108:111]
    ds_read_b64_tr_b16 a[20:21], v10 offset:17408
    v_mfma_f32_16x16x32_bf16 v[108:111], a[44:47], v[88:91], v[108:111]
    ds_read_b64_tr_b16 a[22:23], v10 offset:17920
    buffer_load_dwordx4 a[104:107], v13, s[12:15], s43 offen offset:3072 sc1
    v_mfma_f32_16x16x32_bf16 v[124:127], a[44:47], v[92:95], v[124:127]
    ds_read_b64_tr_b16 a[24:25], v10 offset:18432
    v_mfma_f32_16x16x32_bf16 v[124:127], a[40:43], v[84:87], v[124:127]
    ds_read_b64_tr_b16 a[26:27], v10 offset:18944
    v_mfma_f32_16x16x32_bf16 v[124:127], a[36:39], v[76:79], v[124:127]
    ds_read_b64_tr_b16 a[28:29], v10 offset:19456
    v_mfma_f32_16x16x32_bf16 v[124:127], a[32:35], v[68:71], v[124:127]
    ds_read_b64_tr_b16 a[30:31], v10 offset:19968
    s_waitcnt lgkmcnt(8)
    v_mfma_f32_16x16x32_bf16 v[128:131], a[0:3], v[64:67], v[128:131]
    ds_read_b64_tr_b16 a[32:33], v11 offset:16384
    buffer_load_dword v29, v28, s[12:15], 0 offen sc1
    v_mfma_f32_16x16x32_bf16 v[128:131], a[4:7], v[72:75], v[128:131]
    ds_read_b64_tr_b16 a[34:35], v11 offset:16896
    v_mfma_f32_16x16x32_bf16 v[128:131], a[8:11], v[80:83], v[128:131]
    ds_read_b64_tr_b16 a[36:37], v11 offset:17408
    v_mfma_f32_16x16x32_bf16 v[128:131], a[12:15], v[88:91], v[128:131]
    ds_read_b64_tr_b16 a[38:39], v11 offset:17920
    buffer_load_dwordx4 a[108:111], v0, s[12:15], s43 offen offset:3072 sc1
    v_mfma_f32_16x16x32_bf16 v[144:147], a[12:15], v[92:95], v[144:147]
    ds_read_b64_tr_b16 a[40:41], v11 offset:18432
    v_mfma_f32_16x16x32_bf16 v[144:147], a[8:11], v[84:87], v[144:147]
    ds_read_b64_tr_b16 a[42:43], v11 offset:18944
    v_mfma_f32_16x16x32_bf16 v[144:147], a[4:7], v[76:79], v[144:147]
    ds_read_b64_tr_b16 a[44:45], v11 offset:19456
    s_add_u32 m0, s21, 98304
    s_nop 0
    buffer_load_dwordx4 v17, s[96:99], s28 offen offset:0 lds
    v_mfma_f32_16x16x32_bf16 v[144:147], a[0:3], v[68:71], v[144:147]
    ds_read_b64_tr_b16 a[46:47], v11 offset:19968
    s_waitcnt lgkmcnt(8)
    v_mfma_f32_16x16x32_bf16 v[132:135], a[16:19], v[64:67], v[132:135]
    ds_read_b64_tr_b16 a[0:1], v12 offset:16384
    buffer_load_dwordx4 v17, s[96:99], s29 offen offset:1024 lds
    v_mfma_f32_16x16x32_bf16 v[132:135], a[20:23], v[72:75], v[132:135]
    ds_read_b64_tr_b16 a[2:3], v12 offset:16896
    v_mfma_f32_16x16x32_bf16 v[132:135], a[24:27], v[80:83], v[132:135]
    ds_read_b64_tr_b16 a[4:5], v12 offset:17408
    v_mfma_f32_16x16x32_bf16 v[132:135], a[28:31], v[88:91], v[132:135]
    ds_read_b64_tr_b16 a[6:7], v12 offset:17920
    v_mfma_f32_16x16x32_bf16 v[148:151], a[28:31], v[92:95], v[148:151]
    ds_read_b64_tr_b16 a[8:9], v12 offset:18432
    v_mfma_f32_16x16x32_bf16 v[148:151], a[24:27], v[84:87], v[148:151]
    ds_read_b64_tr_b16 a[10:11], v12 offset:18944
    v_mfma_f32_16x16x32_bf16 v[148:151], a[20:23], v[76:79], v[148:151]
    ds_read_b64_tr_b16 a[12:13], v12 offset:19456
    ds_read_b64_tr_b16 a[14:15], v12 offset:19968
    v_mfma_f32_16x16x32_bf16 v[148:151], a[16:19], v[68:71], v[148:151]
    s_waitcnt lgkmcnt(8)
    s_barrier
    v_mfma_f32_16x16x32_bf16 v[136:139], a[32:35], v[64:67], v[136:139]
    ds_read_b64_tr_b16 a[16:17], v1 offset:0
    buffer_load_dwordx4 v17, s[96:99], s30 offen offset:2048 lds
    v_mfma_f32_16x16x32_bf16 v[136:139], a[36:39], v[72:75], v[136:139]
    ds_read_b64_tr_b16 a[18:19], v1 offset:512
    v_mfma_f32_16x16x32_bf16 v[136:139], a[40:43], v[80:83], v[136:139]
    ds_read_b64_tr_b16 a[20:21], v1 offset:1024
    v_mfma_f32_16x16x32_bf16 v[136:139], a[44:47], v[88:91], v[136:139]
    ds_read_b64_tr_b16 a[22:23], v1 offset:1536
    buffer_load_dwordx4 v17, s[96:99], s31 offen offset:3072 lds
    v_mfma_f32_16x16x32_bf16 v[152:155], a[44:47], v[92:95], v[152:155]
    ds_read_b64_tr_b16 a[24:25], v1 offset:2048
    v_mfma_f32_16x16x32_bf16 v[152:155], a[40:43], v[84:87], v[152:155]
    ds_read_b64_tr_b16 a[26:27], v1 offset:2560
    v_mfma_f32_16x16x32_bf16 v[152:155], a[36:39], v[76:79], v[152:155]
    ds_read_b64_tr_b16 a[28:29], v1 offset:3072
    v_mfma_f32_16x16x32_bf16 v[152:155], a[32:35], v[68:71], v[152:155]
    ds_read_b64_tr_b16 a[30:31], v1 offset:3584
    s_waitcnt lgkmcnt(8)
    v_mfma_f32_16x16x32_bf16 v[140:143], a[0:3], v[64:67], v[140:143]
    ds_read_b64_tr_b16 a[32:33], v2 offset:0
    s_add_u32 m0, s21, 114688
    v_mfma_f32_16x16x32_bf16 v[140:143], a[4:7], v[72:75], v[140:143]
    ds_read_b64_tr_b16 a[34:35], v2 offset:512
    buffer_load_dwordx4 v18, s[96:99], s28 offen offset:0 lds
    v_mfma_f32_16x16x32_bf16 v[140:143], a[8:11], v[80:83], v[140:143]
    ds_read_b64_tr_b16 a[36:37], v2 offset:1024
    v_mfma_f32_16x16x32_bf16 v[140:143], a[12:15], v[88:91], v[140:143]
    ds_read_b64_tr_b16 a[38:39], v2 offset:1536
    v_mfma_f32_16x16x32_bf16 v[156:159], a[12:15], v[92:95], v[156:159]
    ds_read_b64_tr_b16 a[40:41], v2 offset:2048
    buffer_load_dwordx4 v18, s[96:99], s29 offen offset:1024 lds
    v_mfma_f32_16x16x32_bf16 v[156:159], a[8:11], v[84:87], v[156:159]
    ds_read_b64_tr_b16 a[42:43], v2 offset:2560
    v_mfma_f32_16x16x32_bf16 v[156:159], a[4:7], v[76:79], v[156:159]
    ds_read_b64_tr_b16 a[44:45], v2 offset:3072
    v_mfma_f32_16x16x32_bf16 v[156:159], a[0:3], v[68:71], v[156:159]
    ds_read_b64_tr_b16 a[46:47], v2 offset:3584
    s_waitcnt vmcnt(15) lgkmcnt(8)
    v_mfma_f32_16x16x32_bf16 v[96:99], a[16:19], a[48:51], v[96:99]
    ds_read_b64_tr_b16 a[0:1], v3 offset:0
    buffer_load_dwordx4 v18, s[96:99], s30 offen offset:2048 lds
    v_mfma_f32_16x16x32_bf16 v[96:99], a[20:23], a[56:59], v[96:99]
    ds_read_b64_tr_b16 a[2:3], v3 offset:512
    v_mfma_f32_16x16x32_bf16 v[96:99], a[24:27], a[64:67], v[96:99]
    ds_read_b64_tr_b16 a[4:5], v3 offset:1024
    v_mfma_f32_16x16x32_bf16 v[96:99], a[28:31], a[72:75], v[96:99]
    ds_read_b64_tr_b16 a[6:7], v3 offset:1536
    buffer_load_dwordx4 v18, s[96:99], s31 offen offset:3072 lds
    v_mfma_f32_16x16x32_bf16 v[112:115], a[28:31], a[76:79], v[112:115]
    ds_read_b64_tr_b16 a[8:9], v3 offset:2048
    v_mfma_f32_16x16x32_bf16 v[112:115], a[24:27], a[68:71], v[112:115]
    ds_read_b64_tr_b16 a[10:11], v3 offset:2560
    v_mfma_f32_16x16x32_bf16 v[112:115], a[20:23], a[60:63], v[112:115]
    ds_read_b64_tr_b16 a[12:13], v3 offset:3072
    v_mfma_f32_16x16x32_bf16 v[112:115], a[16:19], a[52:55], v[112:115]
    ds_read_b64_tr_b16 a[14:15], v3 offset:3584
    s_waitcnt lgkmcnt(8)
    v_mfma_f32_16x16x32_bf16 v[100:103], a[32:35], a[48:51], v[100:103]
    ds_read_b64_tr_b16 a[16:17], v4 offset:0
    s_add_u32 m0, s21, 131072
    v_mfma_f32_16x16x32_bf16 v[100:103], a[36:39], a[56:59], v[100:103]
    ds_read_b64_tr_b16 a[18:19], v4 offset:512
    buffer_load_dwordx4 v17, s[96:99], s32 offen offset:0 lds
    v_mfma_f32_16x16x32_bf16 v[100:103], a[40:43], a[64:67], v[100:103]
    ds_read_b64_tr_b16 a[20:21], v4 offset:1024
    v_mfma_f32_16x16x32_bf16 v[100:103], a[44:47], a[72:75], v[100:103]
    ds_read_b64_tr_b16 a[22:23], v4 offset:1536
    v_mfma_f32_16x16x32_bf16 v[116:119], a[44:47], a[76:79], v[116:119]
    ds_read_b64_tr_b16 a[24:25], v4 offset:2048
    buffer_load_dwordx4 v17, s[96:99], s33 offen offset:1024 lds
    v_mfma_f32_16x16x32_bf16 v[116:119], a[40:43], a[68:71], v[116:119]
    ds_read_b64_tr_b16 a[26:27], v4 offset:2560
    v_mfma_f32_16x16x32_bf16 v[116:119], a[36:39], a[60:63], v[116:119]
    ds_read_b64_tr_b16 a[28:29], v4 offset:3072
    ds_read_b64_tr_b16 a[30:31], v4 offset:3584
    v_mfma_f32_16x16x32_bf16 v[116:119], a[32:35], a[52:55], v[116:119]
    s_waitcnt lgkmcnt(8)
    s_barrier
    v_mfma_f32_16x16x32_bf16 v[104:107], a[0:3], a[48:51], v[104:107]
    ds_read_b64_tr_b16 a[32:33], v1 offset:16384
    buffer_load_dwordx4 v17, s[96:99], s34 offen offset:2048 lds
    v_mfma_f32_16x16x32_bf16 v[104:107], a[4:7], a[56:59], v[104:107]
    ds_read_b64_tr_b16 a[34:35], v1 offset:16896
    v_mfma_f32_16x16x32_bf16 v[104:107], a[8:11], a[64:67], v[104:107]
    ds_read_b64_tr_b16 a[36:37], v1 offset:17408
    v_mfma_f32_16x16x32_bf16 v[104:107], a[12:15], a[72:75], v[104:107]
    ds_read_b64_tr_b16 a[38:39], v1 offset:17920
    buffer_load_dwordx4 v17, s[96:99], s35 offen offset:3072 lds
    v_mfma_f32_16x16x32_bf16 v[120:123], a[12:15], a[76:79], v[120:123]
    ds_read_b64_tr_b16 a[40:41], v1 offset:18432
    v_mfma_f32_16x16x32_bf16 v[120:123], a[8:11], a[68:71], v[120:123]
    ds_read_b64_tr_b16 a[42:43], v1 offset:18944
    v_mfma_f32_16x16x32_bf16 v[120:123], a[4:7], a[60:63], v[120:123]
    ds_read_b64_tr_b16 a[44:45], v1 offset:19456
    v_mfma_f32_16x16x32_bf16 v[120:123], a[0:3], a[52:55], v[120:123]
    ds_read_b64_tr_b16 a[46:47], v1 offset:19968
    s_waitcnt lgkmcnt(8)
    v_mfma_f32_16x16x32_bf16 v[108:111], a[16:19], a[48:51], v[108:111]
    ds_read_b64_tr_b16 a[0:1], v2 offset:16384
    s_add_u32 m0, s21, 147456
    v_mfma_f32_16x16x32_bf16 v[108:111], a[20:23], a[56:59], v[108:111]
    ds_read_b64_tr_b16 a[2:3], v2 offset:16896
    buffer_load_dwordx4 v18, s[96:99], s32 offen offset:0 lds
    v_mfma_f32_16x16x32_bf16 v[108:111], a[24:27], a[64:67], v[108:111]
    ds_read_b64_tr_b16 a[4:5], v2 offset:17408
    v_mfma_f32_16x16x32_bf16 v[108:111], a[28:31], a[72:75], v[108:111]
    ds_read_b64_tr_b16 a[6:7], v2 offset:17920
    v_mfma_f32_16x16x32_bf16 v[124:127], a[28:31], a[76:79], v[124:127]
    ds_read_b64_tr_b16 a[8:9], v2 offset:18432
    buffer_load_dwordx4 v18, s[96:99], s33 offen offset:1024 lds
    v_mfma_f32_16x16x32_bf16 v[124:127], a[24:27], a[68:71], v[124:127]
    ds_read_b64_tr_b16 a[10:11], v2 offset:18944
    v_mfma_f32_16x16x32_bf16 v[124:127], a[20:23], a[60:63], v[124:127]
    ds_read_b64_tr_b16 a[12:13], v2 offset:19456
    v_mfma_f32_16x16x32_bf16 v[124:127], a[16:19], a[52:55], v[124:127]
    ds_read_b64_tr_b16 a[14:15], v2 offset:19968
    s_waitcnt vmcnt(15)
    v_cmp_gt_u32 vcc, 4, v29
    s_cbranch_vccz L_spin2_ret
    s_mov_b32 s3, 0x40000
L_spin2_loop:
    buffer_load_dword v29, v28, s[12:15], 0 offen sc1
    s_sub_u32 s3, s3, 1
    s_cmp_eq_u32 s3, 0
    s_waitcnt vmcnt(0)
    s_cbranch_scc1 L_spin2_ret
    v_cmp_gt_u32 vcc, 4, v29
    s_cbranch_vccnz L_spin2_loop
L_spin2_ret:
    s_waitcnt lgkmcnt(8)
    v_mfma_f32_16x16x32_bf16 v[128:131], a[32:35], a[48:51], v[128:131]
    ds_read_b64_tr_b16 a[16:17], v3 offset:16384
    s_mov_b32 s40, 16384
    v_mfma_f32_16x16x32_bf16 v[128:131], a[36:39], a[56:59], v[128:131]
    ds_read_b64_tr_b16 a[18:19], v3 offset:16896
    buffer_load_dwordx4 a[112:115], v13, s[12:15], s40 offen offset:0 sc1
    v_mfma_f32_16x16x32_bf16 v[128:131], a[40:43], a[64:67], v[128:131]
    ds_read_b64_tr_b16 a[20:21], v3 offset:17408
    v_mfma_f32_16x16x32_bf16 v[128:131], a[44:47], a[72:75], v[128:131]
    ds_read_b64_tr_b16 a[22:23], v3 offset:17920
    v_mfma_f32_16x16x32_bf16 v[144:147], a[44:47], a[76:79], v[144:147]
    ds_read_b64_tr_b16 a[24:25], v3 offset:18432
    v_mfma_f32_16x16x32_bf16 v[144:147], a[40:43], a[68:71], v[144:147]
    ds_read_b64_tr_b16 a[26:27], v3 offset:18944
    v_accvgpr_read_b32 v22, a240
    v_mfma_f32_16x16x32_bf16 v[144:147], a[36:39], a[60:63], v[144:147]
    ds_read_b64_tr_b16 a[28:29], v3 offset:19456
    v_mfma_f32_16x16x32_bf16 v[144:147], a[32:35], a[52:55], v[144:147]
    ds_read_b64_tr_b16 a[30:31], v3 offset:19968
    s_waitcnt lgkmcnt(8)
    v_mfma_f32_16x16x32_bf16 v[132:135], a[0:3], a[48:51], v[132:135]
    ds_read_b64_tr_b16 a[32:33], v4 offset:16384
    buffer_load_dwordx4 a[116:119], v0, s[12:15], s40 offen offset:0 sc1
    v_mfma_f32_16x16x32_bf16 v[132:135], a[4:7], a[56:59], v[132:135]
    ds_read_b64_tr_b16 a[34:35], v4 offset:16896
    v_mfma_f32_16x16x32_bf16 v[132:135], a[8:11], a[64:67], v[132:135]
    ds_read_b64_tr_b16 a[36:37], v4 offset:17408
    v_mfma_f32_16x16x32_bf16 v[132:135], a[12:15], a[72:75], v[132:135]
    ds_read_b64_tr_b16 a[38:39], v4 offset:17920
    buffer_load_dwordx4 a[120:123], v13, s[12:15], s40 offen offset:1024 sc1
    v_mfma_f32_16x16x32_bf16 v[148:151], a[12:15], a[76:79], v[148:151]
    ds_read_b64_tr_b16 a[40:41], v4 offset:18432
    v_mfma_f32_16x16x32_bf16 v[148:151], a[8:11], a[68:71], v[148:151]
    ds_read_b64_tr_b16 a[42:43], v4 offset:18944
    v_accvgpr_read_b32 v23, a241
    v_mfma_f32_16x16x32_bf16 v[148:151], a[4:7], a[60:63], v[148:151]
    ds_read_b64_tr_b16 a[44:45], v4 offset:19456
    ds_read_b64_tr_b16 a[46:47], v4 offset:19968
    v_mfma_f32_16x16x32_bf16 v[148:151], a[0:3], a[52:55], v[148:151]
    s_waitcnt lgkmcnt(8)
    s_barrier
    v_mfma_f32_16x16x32_bf16 v[136:139], a[16:19], a[48:51], v[136:139]
    ds_read_b64_tr_b16 a[0:1], v1 offset:32768
    buffer_load_dwordx4 a[124:127], v0, s[12:15], s40 offen offset:1024 sc1
    v_mfma_f32_16x16x32_bf16 v[136:139], a[20:23], a[56:59], v[136:139]
    ds_read_b64_tr_b16 a[2:3], v1 offset:33280
    v_mfma_f32_16x16x32_bf16 v[136:139], a[24:27], a[64:67], v[136:139]
    ds_read_b64_tr_b16 a[4:5], v1 offset:33792
    v_mfma_f32_16x16x32_bf16 v[136:139], a[28:31], a[72:75], v[136:139]
    ds_read_b64_tr_b16 a[6:7], v1 offset:34304
    buffer_load_dwordx4 a[128:131], v13, s[12:15], s40 offen offset:2048 sc1
    v_mfma_f32_16x16x32_bf16 v[152:155], a[28:31], a[76:79], v[152:155]
    ds_read_b64_tr_b16 a[8:9], v1 offset:34816
    v_mfma_f32_16x16x32_bf16 v[152:155], a[24:27], a[68:71], v[152:155]
    ds_read_b64_tr_b16 a[10:11], v1 offset:35328
    v_accvgpr_read_b32 v20, a242
    v_mfma_f32_16x16x32_bf16 v[152:155], a[20:23], a[60:63], v[152:155]
    ds_read_b64_tr_b16 a[12:13], v1 offset:35840
    v_mfma_f32_16x16x32_bf16 v[152:155], a[16:19], a[52:55], v[152:155]
    ds_read_b64_tr_b16 a[14:15], v1 offset:36352
L_pad8:
    s_cbranch_execz L_pad_ret
    s_waitcnt lgkmcnt(8)
    v_mfma_f32_16x16x32_bf16 v[140:143], a[32:35], a[48:51], v[140:143]
    ds_read_b64_tr_b16 a[16:17], v2 offset:32768
    buffer_load_dwordx4 a[132:135], v0, s[12:15], s40 offen offset:2048 sc1
    v_mfma_f32_16x16x32_bf16 v[140:143], a[36:39], a[56:59], v[140:143]
    ds_read_b64_tr_b16 a[18:19], v2 offset:33280
    v_mfma_f32_16x16x32_bf16 v[140:143], a[40:43], a[64:67], v[140:143]
    ds_read_b64_tr_b16 a[20:21], v2 offset:33792
    v_mfma_f32_16x16x32_bf16 v[140:143], a[44:47], a[72:75], v[140:143]
    ds_read_b64_tr_b16 a[22:23], v2 offset:34304
    buffer_load_dwordx4 a[136:139], v13, s[12:15], s40 offen offset:3072 sc1
    v_mfma_f32_16x16x32_bf16 v[156:159], a[44:47], a[76:79], v[156:159]
    ds_read_b64_tr_b16 a[24:25], v2 offset:34816
    v_mfma_f32_16x16x32_bf16 v[156:159], a[40:43], a[68:71], v[156:159]
    ds_read_b64_tr_b16 a[26:27], v2 offset:35328
    v_accvgpr_read_b32 v21, a243
    v_mfma_f32_16x16x32_bf16 v[156:159], a[36:39], a[60:63], v[156:159]
    ds_read_b64_tr_b16 a[28:29], v2 offset:35840
    v_mfma_f32_16x16x32_bf16 v[156:159], a[32:35], a[52:55], v[156:159]
    ds_read_b64_tr_b16 a[30:31], v2 offset:36352
    s_waitcnt vmcnt(21) lgkmcnt(8)
    v_mfma_f32_16x16x32_bf16 v[96:99], a[0:3], a[80:83], v[96:99]
    ds_read_b64_tr_b16 a[32:33], v3 offset:32768
    buffer_load_dwordx4 a[140:143], v0, s[12:15], s40 offen offset:3072 sc1
    v_mfma_f32_16x16x32_bf16 v[96:99], a[4:7], a[88:91], v[96:99]
    ds_read_b64_tr_b16 a[34:35], v3 offset:33280
    v_mfma_f32_16x16x32_bf16 v[96:99], a[8:11], a[96:99], v[96:99]
    ds_read_b64_tr_b16 a[36:37], v3 offset:33792
    v_mfma_f32_16x16x32_bf16 v[96:99], a[12:15], a[104:107], v[96:99]
    ds_read_b64_tr_b16 a[38:39], v3 offset:34304
    s_mov_b32 s41, 20480
    v_mfma_f32_16x16x32_bf16 v[112:115], a[12:15], a[108:111], v[112:115]
    ds_read_b64_tr_b16 a[40:41], v3 offset:34816
    buffer_load_dwordx4 a[144:147], v13, s[12:15], s41 offen offset:0 sc1
    v_mfma_f32_16x16x32_bf16 v[112:115], a[8:11], a[100:103], v[112:115]
    ds_read_b64_tr_b16 a[42:43], v3 offset:35328
    v_accvgpr_read_b32 v27, a252
    v_mfma_f32_16x16x32_bf16 v[112:115], a[4:7], a[92:95], v[112:115]
    ds_read_b64_tr_b16 a[44:45], v3 offset:35840
    v_mfma_f32_16x16x32_bf16 v[112:115], a[0:3], a[84:87], v[112:115]
    ds_read_b64_tr_b16 a[46:47], v3 offset:36352
    s_waitcnt lgkmcnt(8)
    v_mfma_f32_16x16x32_bf16 v[100:103], a[16:19], a[80:83], v[100:103]
    ds_read_b64_tr_b16 a[0:1], v4 offset:32768
    buffer_load_dwordx4 a[148:151], v0, s[12:15], s41 offen offset:0 sc1
    v_mfma_f32_16x16x32_bf16 v[100:103], a[20:23], a[88:91], v[100:103]
    ds_read_b64_tr_b16 a[2:3], v4 offset:33280
    v_mfma_f32_16x16x32_bf16 v[100:103], a[24:27], a[96:99], v[100:103]
    ds_read_b64_tr_b16 a[4:5], v4 offset:33792
    v_mfma_f32_16x16x32_bf16 v[100:103], a[28:31], a[104:107], v[100:103]
    ds_read_b64_tr_b16 a[6:7], v4 offset:34304
    buffer_load_dwordx4 a[152:155], v13, s[12:15], s41 offen offset:1024 sc1
    v_mfma_f32_16x16x32_bf16 v[116:119], a[28:31], a[108:111], v[116:119]
    ds_read_b64_tr_b16 a[8:9], v4 offset:34816
    v_mfma_f32_16x16x32_bf16 v[116:119], a[24:27], a[100:103], v[116:119]
    ds_read_b64_tr_b16 a[10:11], v4 offset:35328
    v_mov_b32 v26, 1
    v_mfma_f32_16x16x32_bf16 v[116:119], a[20:23], a[92:95], v[116:119]
    ds_read_b64_tr_b16 a[12:13], v4 offset:35840
    ds_read_b64_tr_b16 a[14:15], v4 offset:36352
    v_mfma_f32_16x16x32_bf16 v[116:119], a[16:19], a[84:87], v[116:119]
    s_waitcnt lgkmcnt(8)
    s_barrier
    v_mfma_f32_16x16x32_bf16 v[104:107], a[32:35], a[80:83], v[104:107]
    ds_read_b64_tr_b16 a[16:17], v1 offset:49152
    buffer_load_dwordx4 a[156:159], v0, s[12:15], s41 offen offset:1024 sc1
    v_mfma_f32_16x16x32_bf16 v[104:107], a[36:39], a[88:91], v[104:107]
    ds_read_b64_tr_b16 a[18:19], v1 offset:49664
    v_mfma_f32_16x16x32_bf16 v[104:107], a[40:43], a[96:99], v[104:107]
    ds_read_b64_tr_b16 a[20:21], v1 offset:50176
    v_mfma_f32_16x16x32_bf16 v[104:107], a[44:47], a[104:107], v[104:107]
    ds_read_b64_tr_b16 a[22:23], v1 offset:50688
    v_mfma_f32_16x16x32_bf16 v[120:123], a[44:47], a[108:111], v[120:123]
    ds_read_b64_tr_b16 a[24:25], v1 offset:51200
    v_mfma_f32_16x16x32_bf16 v[120:123], a[40:43], a[100:103], v[120:123]
    ds_read_b64_tr_b16 a[26:27], v1 offset:51712
    v_accvgpr_read_b32 v25, a248
    v_mfma_f32_16x16x32_bf16 v[120:123], a[36:39], a[92:95], v[120:123]
    ds_read_b64_tr_b16 a[28:29], v1 offset:52224
    v_mfma_f32_16x16x32_bf16 v[120:123], a[32:35], a[84:87], v[120:123]
    ds_read_b64_tr_b16 a[30:31], v1 offset:52736
    s_waitcnt lgkmcnt(8)
    v_mfma_f32_16x16x32_bf16 v[108:111], a[0:3], a[80:83], v[108:111]
    ds_read_b64_tr_b16 a[32:33], v2 offset:49152
    buffer_load_dwordx4 a[160:163], v13, s[12:15], s41 offen offset:2048 sc1
    v_mfma_f32_16x16x32_bf16 v[108:111], a[4:7], a[88:91], v[108:111]
    ds_read_b64_tr_b16 a[34:35], v2 offset:49664
    v_mfma_f32_16x16x32_bf16 v[108:111], a[8:11], a[96:99], v[108:111]
    ds_read_b64_tr_b16 a[36:37], v2 offset:50176
    v_mfma_f32_16x16x32_bf16 v[108:111], a[12:15], a[104:107], v[108:111]
    ds_read_b64_tr_b16 a[38:39], v2 offset:50688
    buffer_load_dwordx4 a[164:167], v0, s[12:15], s41 offen offset:2048 sc1
    v_mfma_f32_16x16x32_bf16 v[124:127], a[12:15], a[108:111], v[124:127]
    ds_read_b64_tr_b16 a[40:41], v2 offset:51200
    v_mfma_f32_16x16x32_bf16 v[124:127], a[8:11], a[100:103], v[124:127]
    ds_read_b64_tr_b16 a[42:43], v2 offset:51712
    v_mfma_f32_16x16x32_bf16 v[124:127], a[4:7], a[92:95], v[124:127]
    ds_read_b64_tr_b16 a[44:45], v2 offset:52224
    v_mfma_f32_16x16x32_bf16 v[124:127], a[0:3], a[84:87], v[124:127]
    ds_read_b64_tr_b16 a[46:47], v2 offset:52736
    s_waitcnt lgkmcnt(8)
    v_mfma_f32_16x16x32_bf16 v[128:131], a[16:19], a[80:83], v[128:131]
    ds_read_b64_tr_b16 a[0:1], v3 offset:49152
    buffer_load_dwordx4 a[168:171], v13, s[12:15], s41 offen offset:3072 sc1
    v_mfma_f32_16x16x32_bf16 v[128:131], a[20:23], a[88:91], v[128:131]
    ds_read_b64_tr_b16 a[2:3], v3 offset:49664
    v_mfma_f32_16x16x32_bf16 v[128:131], a[24:27], a[96:99], v[128:131]
    ds_read_b64_tr_b16 a[4:5], v3 offset:50176
    v_mfma_f32_16x16x32_bf16 v[128:131], a[28:31], a[104:107], v[128:131]
    ds_read_b64_tr_b16 a[6:7], v3 offset:50688
    buffer_load_dwordx4 a[172:175], v0, s[12:15], s41 offen offset:3072 sc1
    v_mfma_f32_16x16x32_bf16 v[144:147], a[28:31], a[108:111], v[144:147]
    ds_read_b64_tr_b16 a[8:9], v3 offset:51200
    v_mfma_f32_16x16x32_bf16 v[144:147], a[24:27], a[100:103], v[144:147]
    ds_read_b64_tr_b16 a[10:11], v3 offset:51712
    v_mfma_f32_16x16x32_bf16 v[144:147], a[20:23], a[92:95], v[144:147]
    ds_read_b64_tr_b16 a[12:13], v3 offset:52224
    v_mfma_f32_16x16x32_bf16 v[144:147], a[16:19], a[84:87], v[144:147]
    ds_read_b64_tr_b16 a[14:15], v3 offset:52736
    s_waitcnt lgkmcnt(8)
    v_mfma_f32_16x16x32_bf16 v[132:135], a[32:35], a[80:83], v[132:135]
    ds_read_b64_tr_b16 a[16:17], v4 offset:49152
    s_mov_b32 s42, 24576
    v_mfma_f32_16x16x32_bf16 v[132:135], a[36:39], a[88:91], v[132:135]
    ds_read_b64_tr_b16 a[18:19], v4 offset:49664
    buffer_load_dwordx4 a[176:179], v13, s[12:15], s42 offen offset:0 sc1
    v_mfma_f32_16x16x32_bf16 v[132:135], a[40:43], a[96:99], v[132:135]
    ds_read_b64_tr_b16 a[20:21], v4 offset:50176
    v_mfma_f32_16x16x32_bf16 v[132:135], a[44:47], a[104:107], v[132:135]
    ds_read_b64_tr_b16 a[22:23], v4 offset:50688
    v_mfma_f32_16x16x32_bf16 v[148:151], a[44:47], a[108:111], v[148:151]
    ds_read_b64_tr_b16 a[24:25], v4 offset:51200
    buffer_load_dwordx4 a[180:183], v0, s[12:15], s42 offen offset:0 sc1
    v_mfma_f32_16x16x32_bf16 v[148:151], a[40:43], a[100:103], v[148:151]
    ds_read_b64_tr_b16 a[26:27], v4 offset:51712
    v_mfma_f32_16x16x32_bf16 v[148:151], a[36:39], a[92:95], v[148:151]
    ds_read_b64_tr_b16 a[28:29], v4 offset:52224
    ds_read_b64_tr_b16 a[30:31], v4 offset:52736
    v_mfma_f32_16x16x32_bf16 v[148:151], a[32:35], a[84:87], v[148:151]
    s_waitcnt lgkmcnt(8)
    s_barrier
    v_mfma_f32_16x16x32_bf16 v[136:139], a[0:3], a[80:83], v[136:139]
    ds_read_b64_tr_b16 a[32:33], v5 offset:0
    buffer_load_dwordx4 a[184:187], v13, s[12:15], s42 offen offset:1024 sc1
    v_mfma_f32_16x16x32_bf16 v[136:139], a[4:7], a[88:91], v[136:139]
    ds_read_b64_tr_b16 a[34:35], v5 offset:512
    v_mfma_f32_16x16x32_bf16 v[136:139], a[8:11], a[96:99], v[136:139]
    ds_read_b64_tr_b16 a[36:37], v5 offset:1024
    v_mfma_f32_16x16x32_bf16 v[136:139], a[12:15], a[104:107], v[136:139]
    ds_read_b64_tr_b16 a[38:39], v5 offset:1536
    buffer_load_dwordx4 a[188:191], v0, s[12:15], s42 offen offset:1024 sc1
    v_mfma_f32_16x16x32_bf16 v[152:155], a[12:15], a[108:111], v[152:155]
    ds_read_b64_tr_b16 a[40:41], v5 offset:2048
    v_mfma_f32_16x16x32_bf16 v[152:155], a[8:11], a[100:103], v[152:155]
    ds_read_b64_tr_b16 a[42:43], v5 offset:2560
    v_mfma_f32_16x16x32_bf16 v[152:155], a[4:7], a[92:95], v[152:155]
    ds_read_b64_tr_b16 a[44:45], v5 offset:3072
    v_mfma_f32_16x16x32_bf16 v[152:155], a[0:3], a[84:87], v[152:155]
    ds_read_b64_tr_b16 a[46:47], v5 offset:3584
    s_waitcnt lgkmcnt(8)
    v_mfma_f32_16x16x32_bf16 v[140:143], a[16:19], a[80:83], v[140:143]
    ds_read_b64_tr_b16 a[0:1], v6 offset:0
    buffer_load_dwordx4 a[192:195], v13, s[12:15], s42 offen offset:2048 sc1
    v_mfma_f32_16x16x32_bf16 v[140:143], a[20:23], a[88:91], v[140:143]
    ds_read_b64_tr_b16 a[2:3], v6 offset:512
    v_mfma_f32_16x16x32_bf16 v[140:143], a[24:27], a[96:99], v[140:143]
    ds_read_b64_tr_b16 a[4:5], v6 offset:1024
    v_mfma_f32_16x16x32_bf16 v[140:143], a[28:31], a[104:107], v[140:143]
    ds_read_b64_tr_b16 a[6:7], v6 offset:1536
    buffer_load_dwordx4 a[196:199], v0, s[12:15], s42 offen offset:2048 sc1
    v_mfma_f32_16x16x32_bf16 v[156:159], a[28:31], a[108:111], v[156:159]
    ds_read_b64_tr_b16 a[8:9], v6 offset:2048
    v_mfma_f32_16x16x32_bf16 v[156:159], a[24:27], a[100:103], v[156:159]
    ds_read_b64_tr_b16 a[10:11], v6 offset:2560
    v_mfma_f32_16x16x32_bf16 v[156:159], a[20:23], a[92:95], v[156:159]
    ds_read_b64_tr_b16 a[12:13], v6 offset:3072
    v_mfma_f32_16x16x32_bf16 v[156:159], a[16:19], a[84:87], v[156:159]
    ds_read_b64_tr_b16 a[14:15], v6 offset:3584
    s_waitcnt vmcnt(14) lgkmcnt(8)
    v_mfma_f32_16x16x32_bf16 v[96:99], a[32:35], a[112:115], v[96:99]
    ds_read_b64_tr_b16 a[16:17], v7 offset:0
    buffer_load_dwordx4 a[200:203], v13, s[12:15], s42 offen offset:3072 sc1
    v_mfma_f32_16x16x32_bf16 v[96:99], a[36:39], a[120:123], v[96:99]
    ds_read_b64_tr_b16 a[18:19], v7 offset:512
    v_mfma_f32_16x16x32_bf16 v[96:99], a[40:43], a[128:131], v[96:99]
    ds_read_b64_tr_b16 a[20:21], v7 offset:1024
    v_mfma_f32_16x16x32_bf16 v[96:99], a[44:47], a[136:139], v[96:99]
    ds_read_b64_tr_b16 a[22:23], v7 offset:1536
    buffer_load_dwordx4 a[204:207], v0, s[12:15], s42 offen offset:3072 sc1
    v_mfma_f32_16x16x32_bf16 v[112:115], a[44:47], a[140:143], v[112:115]
    ds_read_b64_tr_b16 a[24:25], v7 offset:2048
    v_mfma_f32_16x16x32_bf16 v[112:115], a[40:43], a[132:135], v[112:115]
    ds_read_b64_tr_b16 a[26:27], v7 offset:2560
    v_mfma_f32_16x16x32_bf16 v[112:115], a[36:39], a[124:127], v[112:115]
    ds_read_b64_tr_b16 a[28:29], v7 offset:3072
    v_mfma_f32_16x16x32_bf16 v[112:115], a[32:35], a[116:119], v[112:115]
    ds_read_b64_tr_b16 a[30:31], v7 offset:3584
    s_waitcnt lgkmcnt(8)
    v_mfma_f32_16x16x32_bf16 v[100:103], a[0:3], a[112:115], v[100:103]
    ds_read_b64_tr_b16 a[32:33], v8 offset:0
    buffer_load_dwordx4 v18, s[96:99], s34 offen offset:2048 lds
    v_mfma_f32_16x16x32_bf16 v[100:103], a[4:7], a[120:123], v[100:103]
    ds_read_b64_tr_b16 a[34:35], v8 offset:512
    v_mfma_f32_16x16x32_bf16 v[100:103], a[8:11], a[128:131], v[100:103]
    ds_read_b64_tr_b16 a[36:37], v8 offset:1024
    v_mfma_f32_16x16x32_bf16 v[100:103], a[12:15], a[136:139], v[100:103]
    ds_read_b64_tr_b16 a[38:39], v8 offset:1536
    v_mfma_f32_16x16x32_bf16 v[116:119], a[12:15], a[140:143], v[116:119]
    ds_read_b64_tr_b16 a[40:41], v8 offset:2048
    v_mfma_f32_16x16x32_bf16 v[116:119], a[8:11], a[132:135], v[116:119]
    ds_read_b64_tr_b16 a[42:43], v8 offset:2560
    v_mfma_f32_16x16x32_bf16 v[116:119], a[4:7], a[124:127], v[116:119]
    ds_read_b64_tr_b16 a[44:45], v8 offset:3072
    ds_read_b64_tr_b16 a[46:47], v8 offset:3584
    v_mfma_f32_16x16x32_bf16 v[116:119], a[0:3], a[116:119], v[116:119]
    s_waitcnt lgkmcnt(8)
    s_barrier
    v_mfma_f32_16x16x32_bf16 v[104:107], a[16:19], a[112:115], v[104:107]
    ds_read_b64_tr_b16 a[0:1], v5 offset:16384
    buffer_load_dwordx4 v18, s[96:99], s35 offen offset:3072 lds
    v_mfma_f32_16x16x32_bf16 v[104:107], a[20:23], a[120:123], v[104:107]
    ds_read_b64_tr_b16 a[2:3], v5 offset:16896
    v_mfma_f32_16x16x32_bf16 v[104:107], a[24:27], a[128:131], v[104:107]
    ds_read_b64_tr_b16 a[4:5], v5 offset:17408
    v_mfma_f32_16x16x32_bf16 v[104:107], a[28:31], a[136:139], v[104:107]
    ds_read_b64_tr_b16 a[6:7], v5 offset:17920
    s_add_u32 m0, s21, 0
    v_mfma_f32_16x16x32_bf16 v[120:123], a[28:31], a[140:143], v[120:123]
    ds_read_b64_tr_b16 a[8:9], v5 offset:18432
    buffer_load_dwordx4 v17, s[96:99], s36 offen offset:0 lds
    v_mfma_f32_16x16x32_bf16 v[120:123], a[24:27], a[132:135], v[120:123]
    ds_read_b64_tr_b16 a[10:11], v5 offset:18944
    v_mfma_f32_16x16x32_bf16 v[120:123], a[20:23], a[124:127], v[120:123]
    ds_read_b64_tr_b16 a[12:13], v5 offset:19456
    v_mfma_f32_16x16x32_bf16 v[120:123], a[16:19], a[116:119], v[120:123]
    ds_read_b64_tr_b16 a[14:15], v5 offset:19968
    s_waitcnt lgkmcnt(8)
    v_mfma_f32_16x16x32_bf16 v[108:111], a[32:35], a[112:115], v[108:111]
    ds_read_b64_tr_b16 a[16:17], v6 offset:16384
    buffer_load_dwordx4 v17, s[96:99], s37 offen offset:1024 lds
    v_mfma_f32_16x16x32_bf16 v[108:111], a[36:39], a[120:123], v[108:111]
    ds_read_b64_tr_b16 a[18:19], v6 offset:16896
    v_mfma_f32_16x16x32_bf16 v[108:111], a[40:43], a[128:131], v[108:111]
    ds_read_b64_tr_b16 a[20:21], v6 offset:17408
    v_mfma_f32_16x16x32_bf16 v[108:111], a[44:47], a[136:139], v[108:111]
    ds_read_b64_tr_b16 a[22:23], v6 offset:17920
    buffer_load_dwordx4 v17, s[96:99], s38 offen offset:2048 lds
    v_mfma_f32_16x16x32_bf16 v[124:127], a[44:47], a[140:143], v[124:127]
    ds_read_b64_tr_b16 a[24:25], v6 offset:18432
    v_mfma_f32_16x16x32_bf16 v[124:127], a[40:43], a[132:135], v[124:127]
    ds_read_b64_tr_b16 a[26:27], v6 offset:18944
    v_mfma_f32_16x16x32_bf16 v[124:127], a[36:39], a[124:127], v[124:127]
    ds_read_b64_tr_b16 a[28:29], v6 offset:19456
    v_mfma_f32_16x16x32_bf16 v[124:127], a[32:35], a[116:119], v[124:127]
    ds_read_b64_tr_b16 a[30:31], v6 offset:19968
    s_waitcnt lgkmcnt(8)
    v_mfma_f32_16x16x32_bf16 v[128:131], a[0:3], a[112:115], v[128:131]
    ds_read_b64_tr_b16 a[32:33], v7 offset:16384
    buffer_load_dwordx4 v17, s[96:99], s39 offen offset:3072 lds
    v_mfma_f32_16x16x32_bf16 v[128:131], a[4:7], a[120:123], v[128:131]
    ds_read_b64_tr_b16 a[34:35], v7 offset:16896
    v_mfma_f32_16x16x32_bf16 v[128:131], a[8:11], a[128:131], v[128:131]
    ds_read_b64_tr_b16 a[36:37], v7 offset:17408
    v_mfma_f32_16x16x32_bf16 v[128:131], a[12:15], a[136:139], v[128:131]
    ds_read_b64_tr_b16 a[38:39], v7 offset:17920
    s_mov_b32 s43, 28672
    v_mfma_f32_16x16x32_bf16 v[144:147], a[12:15], a[140:143], v[144:147]
    ds_read_b64_tr_b16 a[40:41], v7 offset:18432
    buffer_load_dwordx4 a[208:211], v13, s[12:15], s43 offen offset:0 sc1
    v_mfma_f32_16x16x32_bf16 v[144:147], a[8:11], a[132:135], v[144:147]
    ds_read_b64_tr_b16 a[42:43], v7 offset:18944
    v_mfma_f32_16x16x32_bf16 v[144:147], a[4:7], a[124:127], v[144:147]
    ds_read_b64_tr_b16 a[44:45], v7 offset:19456
    v_mfma_f32_16x16x32_bf16 v[144:147], a[0:3], a[116:119], v[144:147]
    ds_read_b64_tr_b16 a[46:47], v7 offset:19968
    s_waitcnt lgkmcnt(8)
    v_mfma_f32_16x16x32_bf16 v[132:135], a[16:19], a[112:115], v[132:135]
    ds_read_b64_tr_b16 a[0:1], v8 offset:16384
    buffer_load_dwordx4 a[212:215], v0, s[12:15], s43 offen offset:0 sc1
    v_mfma_f32_16x16x32_bf16 v[132:135], a[20:23], a[120:123], v[132:135]
    ds_read_b64_tr_b16 a[2:3], v8 offset:16896
    v_mfma_f32_16x16x32_bf16 v[132:135], a[24:27], a[128:131], v[132:135]
    ds_read_b64_tr_b16 a[4:5], v8 offset:17408
    v_mfma_f32_16x16x32_bf16 v[132:135], a[28:31], a[136:139], v[132:135]
    ds_read_b64_tr_b16 a[6:7], v8 offset:17920
    buffer_load_dwordx4 a[216:219], v13, s[12:15], s43 offen offset:1024 sc1
    v_mfma_f32_16x16x32_bf16 v[148:151], a[28:31], a[140:143], v[148:151]
    ds_read_b64_tr_b16 a[8:9], v8 offset:18432
    v_mfma_f32_16x16x32_bf16 v[148:151], a[24:27], a[132:135], v[148:151]
    ds_read_b64_tr_b16 a[10:11], v8 offset:18944
    v_mfma_f32_16x16x32_bf16 v[148:151], a[20:23], a[124:127], v[148:151]
    ds_read_b64_tr_b16 a[12:13], v8 offset:19456
    ds_read_b64_tr_b16 a[14:15], v8 offset:19968
    v_mfma_f32_16x16x32_bf16 v[148:151], a[16:19], a[116:119], v[148:151]
    s_waitcnt lgkmcnt(8)
    s_barrier
    v_mfma_f32_16x16x32_bf16 v[136:139], a[32:35], a[112:115], v[136:139]
    ds_read_b64_tr_b16 a[16:17], v5 offset:32768
    buffer_load_dwordx4 a[220:223], v0, s[12:15], s43 offen offset:1024 sc1
    v_mfma_f32_16x16x32_bf16 v[136:139], a[36:39], a[120:123], v[136:139]
    ds_read_b64_tr_b16 a[18:19], v5 offset:33280
    v_mfma_f32_16x16x32_bf16 v[136:139], a[40:43], a[128:131], v[136:139]
    ds_read_b64_tr_b16 a[20:21], v5 offset:33792
    v_mfma_f32_16x16x32_bf16 v[136:139], a[44:47], a[136:139], v[136:139]
    ds_read_b64_tr_b16 a[22:23], v5 offset:34304
    buffer_load_dwordx4 a[224:227], v13, s[12:15], s43 offen offset:2048 sc1
    v_mfma_f32_16x16x32_bf16 v[152:155], a[44:47], a[140:143], v[152:155]
    ds_read_b64_tr_b16 a[24:25], v5 offset:34816
    v_mfma_f32_16x16x32_bf16 v[152:155], a[40:43], a[132:135], v[152:155]
    ds_read_b64_tr_b16 a[26:27], v5 offset:35328
    v_mfma_f32_16x16x32_bf16 v[152:155], a[36:39], a[124:127], v[152:155]
    ds_read_b64_tr_b16 a[28:29], v5 offset:35840
    v_mfma_f32_16x16x32_bf16 v[152:155], a[32:35], a[116:119], v[152:155]
    ds_read_b64_tr_b16 a[30:31], v5 offset:36352
    s_waitcnt lgkmcnt(8)
    v_mfma_f32_16x16x32_bf16 v[140:143], a[0:3], a[112:115], v[140:143]
    ds_read_b64_tr_b16 a[32:33], v6 offset:32768
    buffer_load_dwordx4 a[228:231], v0, s[12:15], s43 offen offset:2048 sc1
    v_mfma_f32_16x16x32_bf16 v[140:143], a[4:7], a[120:123], v[140:143]
    ds_read_b64_tr_b16 a[34:35], v6 offset:33280
    v_mfma_f32_16x16x32_bf16 v[140:143], a[8:11], a[128:131], v[140:143]
    ds_read_b64_tr_b16 a[36:37], v6 offset:33792
    v_mfma_f32_16x16x32_bf16 v[140:143], a[12:15], a[136:139], v[140:143]
    ds_read_b64_tr_b16 a[38:39], v6 offset:34304
    buffer_load_dwordx4 a[232:235], v13, s[12:15], s43 offen offset:3072 sc1
    v_mfma_f32_16x16x32_bf16 v[156:159], a[12:15], a[140:143], v[156:159]
    ds_read_b64_tr_b16 a[40:41], v6 offset:34816
    v_mfma_f32_16x16x32_bf16 v[156:159], a[8:11], a[132:135], v[156:159]
    ds_read_b64_tr_b16 a[42:43], v6 offset:35328
    v_mfma_f32_16x16x32_bf16 v[156:159], a[4:7], a[124:127], v[156:159]
    ds_read_b64_tr_b16 a[44:45], v6 offset:35840
    v_mfma_f32_16x16x32_bf16 v[156:159], a[0:3], a[116:119], v[156:159]
    ds_read_b64_tr_b16 a[46:47], v6 offset:36352
    s_waitcnt vmcnt(21) lgkmcnt(8)
    v_mfma_f32_16x16x32_bf16 v[96:99], a[16:19], a[144:147], v[96:99]
    ds_read_b64_tr_b16 a[0:1], v7 offset:32768
    buffer_load_dwordx4 a[236:239], v0, s[12:15], s43 offen offset:3072 sc1
    v_mfma_f32_16x16x32_bf16 v[96:99], a[20:23], a[152:155], v[96:99]
    ds_read_b64_tr_b16 a[2:3], v7 offset:33280
    v_mfma_f32_16x16x32_bf16 v[96:99], a[24:27], a[160:163], v[96:99]
    ds_read_b64_tr_b16 a[4:5], v7 offset:33792
    v_mfma_f32_16x16x32_bf16 v[96:99], a[28:31], a[168:171], v[96:99]
    ds_read_b64_tr_b16 a[6:7], v7 offset:34304
    v_mfma_f32_16x16x32_bf16 v[112:115], a[28:31], a[172:175], v[112:115]
    ds_read_b64_tr_b16 a[8:9], v7 offset:34816
    v_mfma_f32_16x16x32_bf16 v[112:115], a[24:27], a[164:167], v[112:115]
    ds_read_b64_tr_b16 a[10:11], v7 offset:35328
    v_mfma_f32_16x16x32_bf16 v[112:115], a[20:23], a[156:159], v[112:115]
    ds_read_b64_tr_b16 a[12:13], v7 offset:35840
    v_mfma_f32_16x16x32_bf16 v[112:115], a[16:19], a[148:151], v[112:115]
    ds_read_b64_tr_b16 a[14:15], v7 offset:36352
    s_waitcnt lgkmcnt(8)
    v_mfma_f32_16x16x32_bf16 v[100:103], a[32:35], a[144:147], v[100:103]
    ds_read_b64_tr_b16 a[16:17], v8 offset:32768
    s_add_u32 m0, s21, 16384
    v_mfma_f32_16x16x32_bf16 v[100:103], a[36:39], a[152:155], v[100:103]
    ds_read_b64_tr_b16 a[18:19], v8 offset:33280
    buffer_load_dwordx4 v18, s[96:99], s36 offen offset:0 lds
    v_mfma_f32_16x16x32_bf16 v[100:103], a[40:43], a[160:163], v[100:103]
    ds_read_b64_tr_b16 a[20:21], v8 offset:33792
    v_mfma_f32_16x16x32_bf16 v[100:103], a[44:47], a[168:171], v[100:103]
    ds_read_b64_tr_b16 a[22:23], v8 offset:34304
    v_mfma_f32_16x16x32_bf16 v[116:119], a[44:47], a[172:175], v[116:119]
    ds_read_b64_tr_b16 a[24:25], v8 offset:34816
    buffer_load_dwordx4 v18, s[96:99], s37 offen offset:1024 lds
    v_mfma_f32_16x16x32_bf16 v[116:119], a[40:43], a[164:167], v[116:119]
    ds_read_b64_tr_b16 a[26:27], v8 offset:35328
    v_mfma_f32_16x16x32_bf16 v[116:119], a[36:39], a[156:159], v[116:119]
    ds_read_b64_tr_b16 a[28:29], v8 offset:35840
    ds_read_b64_tr_b16 a[30:31], v8 offset:36352
    v_mfma_f32_16x16x32_bf16 v[116:119], a[32:35], a[148:151], v[116:119]
    s_waitcnt lgkmcnt(8)
    s_barrier
    v_mfma_f32_16x16x32_bf16 v[104:107], a[0:3], a[144:147], v[104:107]
    ds_read_b64_tr_b16 a[32:33], v5 offset:49152
    buffer_load_dwordx4 v18, s[96:99], s38 offen offset:2048 lds
    v_mfma_f32_16x16x32_bf16 v[104:107], a[4:7], a[152:155], v[104:107]
    ds_read_b64_tr_b16 a[34:35], v5 offset:49664
    v_mfma_f32_16x16x32_bf16 v[104:107], a[8:11], a[160:163], v[104:107]
    ds_read_b64_tr_b16 a[36:37], v5 offset:50176
    v_mfma_f32_16x16x32_bf16 v[104:107], a[12:15], a[168:171], v[104:107]
    ds_read_b64_tr_b16 a[38:39], v5 offset:50688
    buffer_load_dwordx4 v18, s[96:99], s39 offen offset:3072 lds
    v_mfma_f32_16x16x32_bf16 v[120:123], a[12:15], a[172:175], v[120:123]
    ds_read_b64_tr_b16 a[40:41], v5 offset:51200
    v_mfma_f32_16x16x32_bf16 v[120:123], a[8:11], a[164:167], v[120:123]
    ds_read_b64_tr_b16 a[42:43], v5 offset:51712
    v_mfma_f32_16x16x32_bf16 v[120:123], a[4:7], a[156:159], v[120:123]
    ds_read_b64_tr_b16 a[44:45], v5 offset:52224
    v_mfma_f32_16x16x32_bf16 v[120:123], a[0:3], a[148:151], v[120:123]
    ds_read_b64_tr_b16 a[46:47], v5 offset:52736
    s_waitcnt lgkmcnt(8)
    v_mfma_f32_16x16x32_bf16 v[108:111], a[16:19], a[144:147], v[108:111]
    ds_read_b64_tr_b16 a[0:1], v6 offset:49152
    v_add_u32 v17, 32768, v17
    v_mfma_f32_16x16x32_bf16 v[108:111], a[20:23], a[152:155], v[108:111]
    ds_read_b64_tr_b16 a[2:3], v6 offset:49664
    s_add_u32 m0, s21, 32768
    v_mfma_f32_16x16x32_bf16 v[108:111], a[24:27], a[160:163], v[108:111]
    ds_read_b64_tr_b16 a[4:5], v6 offset:50176
    buffer_load_dwordx4 v17, s[96:99], s24 offen offset:0 lds
    v_mfma_f32_16x16x32_bf16 v[108:111], a[28:31], a[168:171], v[108:111]
    ds_read_b64_tr_b16 a[6:7], v6 offset:50688
    v_mfma_f32_16x16x32_bf16 v[124:127], a[28:31], a[172:175], v[124:127]
    ds_read_b64_tr_b16 a[8:9], v6 offset:51200
    v_mfma_f32_16x16x32_bf16 v[124:127], a[24:27], a[164:167], v[124:127]
    ds_read_b64_tr_b16 a[10:11], v6 offset:51712
    buffer_load_dwordx4 v17, s[96:99], s25 offen offset:1024 lds
    v_mfma_f32_16x16x32_bf16 v[124:127], a[20:23], a[156:159], v[124:127]
    ds_read_b64_tr_b16 a[12:13], v6 offset:52224
    v_mfma_f32_16x16x32_bf16 v[124:127], a[16:19], a[148:151], v[124:127]
    ds_read_b64_tr_b16 a[14:15], v6 offset:52736
    s_waitcnt lgkmcnt(8)
    v_mfma_f32_16x16x32_bf16 v[128:131], a[32:35], a[144:147], v[128:131]
    ds_read_b64_tr_b16 a[16:17], v7 offset:49152
    buffer_load_dwordx4 v17, s[96:99], s26 offen offset:2048 lds
    v_mfma_f32_16x16x32_bf16 v[128:131], a[36:39], a[152:155], v[128:131]
    ds_read_b64_tr_b16 a[18:19], v7 offset:49664
    v_mfma_f32_16x16x32_bf16 v[128:131], a[40:43], a[160:163], v[128:131]
    ds_read_b64_tr_b16 a[20:21], v7 offset:50176
    v_mfma_f32_16x16x32_bf16 v[128:131], a[44:47], a[168:171], v[128:131]
    ds_read_b64_tr_b16 a[22:23], v7 offset:50688
    buffer_load_dwordx4 v17, s[96:99], s27 offen offset:3072 lds
    v_mfma_f32_16x16x32_bf16 v[144:147], a[44:47], a[172:175], v[144:147]
    ds_read_b64_tr_b16 a[24:25], v7 offset:51200
    v_mfma_f32_16x16x32_bf16 v[144:147], a[40:43], a[164:167], v[144:147]
    ds_read_b64_tr_b16 a[26:27], v7 offset:51712
    v_mfma_f32_16x16x32_bf16 v[144:147], a[36:39], a[156:159], v[144:147]
    ds_read_b64_tr_b16 a[28:29], v7 offset:52224
    v_mfma_f32_16x16x32_bf16 v[144:147], a[32:35], a[148:151], v[144:147]
    ds_read_b64_tr_b16 a[30:31], v7 offset:52736
    s_waitcnt lgkmcnt(8)
    v_mfma_f32_16x16x32_bf16 v[132:135], a[0:3], a[144:147], v[132:135]
    ds_read_b64_tr_b16 a[32:33], v8 offset:49152
    s_mov_b32 s40, 32768
    v_mfma_f32_16x16x32_bf16 v[132:135], a[4:7], a[152:155], v[132:135]
    ds_read_b64_tr_b16 a[34:35], v8 offset:49664
    buffer_load_dwordx4 v[160:163], v13, s[12:15], s40 offen offset:0 sc1
    v_mfma_f32_16x16x32_bf16 v[132:135], a[8:11], a[160:163], v[132:135]
    ds_read_b64_tr_b16 a[36:37], v8 offset:50176
    v_mfma_f32_16x16x32_bf16 v[132:135], a[12:15], a[168:171], v[132:135]
    ds_read_b64_tr_b16 a[38:39], v8 offset:50688
    v_mfma_f32_16x16x32_bf16 v[148:151], a[12:15], a[172:175], v[148:151]
    ds_read_b64_tr_b16 a[40:41], v8 offset:51200
    buffer_load_dwordx4 v[164:167], v0, s[12:15], s40 offen offset:0 sc1
    v_mfma_f32_16x16x32_bf16 v[148:151], a[8:11], a[164:167], v[148:151]
    ds_read_b64_tr_b16 a[42:43], v8 offset:51712
    v_mfma_f32_16x16x32_bf16 v[148:151], a[4:7], a[156:159], v[148:151]
    ds_read_b64_tr_b16 a[44:45], v8 offset:52224
    ds_read_b64_tr_b16 a[46:47], v8 offset:52736
    v_mfma_f32_16x16x32_bf16 v[148:151], a[0:3], a[148:151], v[148:151]
    s_waitcnt lgkmcnt(8)
    s_barrier
    v_mfma_f32_16x16x32_bf16 v[136:139], a[16:19], a[144:147], v[136:139]
    ds_read_b64_tr_b16 a[0:1], v9 offset:0
    buffer_load_dwordx4 v[168:171], v13, s[12:15], s40 offen offset:1024 sc1
    v_mfma_f32_16x16x32_bf16 v[136:139], a[20:23], a[152:155], v[136:139]
    ds_read_b64_tr_b16 a[2:3], v9 offset:512
    v_mfma_f32_16x16x32_bf16 v[136:139], a[24:27], a[160:163], v[136:139]
    ds_read_b64_tr_b16 a[4:5], v9 offset:1024
    v_mfma_f32_16x16x32_bf16 v[136:139], a[28:31], a[168:171], v[136:139]
    ds_read_b64_tr_b16 a[6:7], v9 offset:1536
    v_mfma_f32_16x16x32_bf16 v[152:155], a[28:31], a[172:175], v[152:155]
    ds_read_b64_tr_b16 a[8:9], v9 offset:2048
    v_mfma_f32_16x16x32_bf16 v[152:155], a[24:27], a[164:167], v[152:155]
    ds_read_b64_tr_b16 a[10:11], v9 offset:2560
    v_mfma_f32_16x16x32_bf16 v[152:155], a[20:23], a[156:159], v[152:155]
    ds_read_b64_tr_b16 a[12:13], v9 offset:3072
    v_mfma_f32_16x16x32_bf16 v[152:155], a[16:19], a[148:151], v[152:155]
    ds_read_b64_tr_b16 a[14:15], v9 offset:3584
    s_waitcnt lgkmcnt(8)
    v_mfma_f32_16x16x32_bf16 v[140:143], a[32:35], a[144:147], v[140:143]
    ds_read_b64_tr_b16 a[16:17], v10 offset:0
    buffer_load_dwordx4 v[172:175], v0, s[12:15], s40 offen offset:1024 sc1
    v_mfma_f32_16x16x32_bf16 v[140:143], a[36:39], a[152:155], v[140:143]
    ds_read_b64_tr_b16 a[18:19], v10 offset:512
    v_mfma_f32_16x16x32_bf16 v[140:143], a[40:43], a[160:163], v[140:143]
    ds_read_b64_tr_b16 a[20:21], v10 offset:1024
    v_mfma_f32_16x16x32_bf16 v[140:143], a[44:47], a[168:171], v[140:143]
    ds_read_b64_tr_b16 a[22:23], v10 offset:1536
    buffer_load_dwordx4 v[176:179], v13, s[12:15], s40 offen offset:2048 sc1
    v_mfma_f32_16x16x32_bf16 v[156:159], a[44:47], a[172:175], v[156:159]
    ds_read_b64_tr_b16 a[24:25], v10 offset:2048
    v_mfma_f32_16x16x32_bf16 v[156:159], a[40:43], a[164:167], v[156:159]
    ds_read_b64_tr_b16 a[26:27], v10 offset:2560
    v_mfma_f32_16x16x32_bf16 v[156:159], a[36:39], a[156:159], v[156:159]
    ds_read_b64_tr_b16 a[28:29], v10 offset:3072
    v_mfma_f32_16x16x32_bf16 v[156:159], a[32:35], a[148:151], v[156:159]
    ds_read_b64_tr_b16 a[30:31], v10 offset:3584
    s_waitcnt vmcnt(27) lgkmcnt(8)
    v_mfma_f32_16x16x32_bf16 v[96:99], a[0:3], a[176:179], v[96:99]
    ds_read_b64_tr_b16 a[32:33], v11 offset:0
    buffer_load_dwordx4 v[180:183], v0, s[12:15], s40 offen offset:2048 sc1
    v_mfma_f32_16x16x32_bf16 v[96:99], a[4:7], a[184:187], v[96:99]
    ds_read_b64_tr_b16 a[34:35], v11 offset:512
    v_mfma_f32_16x16x32_bf16 v[96:99], a[8:11], a[192:195], v[96:99]
    ds_read_b64_tr_b16 a[36:37], v11 offset:1024
    v_mfma_f32_16x16x32_bf16 v[96:99], a[12:15], a[200:203], v[96:99]
    ds_read_b64_tr_b16 a[38:39], v11 offset:1536
    buffer_load_dwordx4 v[184:187], v13, s[12:15], s40 offen offset:3072 sc1
    v_mfma_f32_16x16x32_bf16 v[112:115], a[12:15], a[204:207], v[112:115]
    ds_read_b64_tr_b16 a[40:41], v11 offset:2048
    v_mfma_f32_16x16x32_bf16 v[112:115], a[8:11], a[196:199], v[112:115]
    ds_read_b64_tr_b16 a[42:43], v11 offset:2560
    v_mfma_f32_16x16x32_bf16 v[112:115], a[4:7], a[188:191], v[112:115]
    ds_read_b64_tr_b16 a[44:45], v11 offset:3072
    v_mfma_f32_16x16x32_bf16 v[112:115], a[0:3], a[180:183], v[112:115]
    ds_read_b64_tr_b16 a[46:47], v11 offset:3584
    s_waitcnt lgkmcnt(8)
    v_mfma_f32_16x16x32_bf16 v[100:103], a[16:19], a[176:179], v[100:103]
    ds_read_b64_tr_b16 a[0:1], v12 offset:0
    buffer_load_dwordx4 v[188:191], v0, s[12:15], s40 offen offset:3072 sc1
    v_mfma_f32_16x16x32_bf16 v[100:103], a[20:23], a[184:187], v[100:103]
    ds_read_b64_tr_b16 a[2:3], v12 offset:512
    v_mfma_f32_16x16x32_bf16 v[100:103], a[24:27], a[192:195], v[100:103]
    ds_read_b64_tr_b16 a[4:5], v12 offset:1024
    v_mfma_f32_16x16x32_bf16 v[100:103], a[28:31], a[200:203], v[100:103]
    ds_read_b64_tr_b16 a[6:7], v12 offset:1536
    s_add_u32 m0, s21, 49152
    v_mfma_f32_16x16x32_bf16 v[116:119], a[28:31], a[204:207], v[116:119]
    ds_read_b64_tr_b16 a[8:9], v12 offset:2048
    buffer_load_dwordx4 v17, s[96:99], s28 offen offset:0 lds
    v_mfma_f32_16x16x32_bf16 v[116:119], a[24:27], a[196:199], v[116:119]
    ds_read_b64_tr_b16 a[10:11], v12 offset:2560
    v_mfma_f32_16x16x32_bf16 v[116:119], a[20:23], a[188:191], v[116:119]
    ds_read_b64_tr_b16 a[12:13], v12 offset:3072
    ds_read_b64_tr_b16 a[14:15], v12 offset:3584
    v_mfma_f32_16x16x32_bf16 v[116:119], a[16:19], a[180:183], v[116:119]
    s_waitcnt vmcnt(29) lgkmcnt(8)
    s_barrier
L_pad9:
    s_cbranch_execz L_pad_ret
    v_mfma_f32_16x16x32_bf16 v[104:107], a[32:35], a[176:179], v[104:107]
    ds_read_b64_tr_b16 a[16:17], v9 offset:16384
    buffer_load_dwordx4 v17, s[96:99], s29 offen offset:1024 lds
    v_mfma_f32_16x16x32_bf16 v[104:107], a[36:39], a[184:187], v[104:107]
    ds_read_b64_tr_b16 a[18:19], v9 offset:16896
    v_mfma_f32_16x16x32_bf16 v[104:107], a[40:43], a[192:195], v[104:107]
    ds_read_b64_tr_b16 a[20:21], v9 offset:17408
    v_mfma_f32_16x16x32_bf16 v[104:107], a[44:47], a[200:203], v[104:107]
    ds_read_b64_tr_b16 a[22:23], v9 offset:17920
    buffer_load_dwordx4 v17, s[96:99], s30 offen offset:2048 lds
    v_mfma_f32_16x16x32_bf16 v[120:123], a[44:47], a[204:207], v[120:123]
    ds_read_b64_tr_b16 a[24:25], v9 offset:18432
    v_mfma_f32_16x16x32_bf16 v[120:123], a[40:43], a[196:199], v[120:123]
    ds_read_b64_tr_b16 a[26:27], v9 offset:18944
    v_mfma_f32_16x16x32_bf16 v[120:123], a[36:39], a[188:191], v[120:123]
    ds_read_b64_tr_b16 a[28:29], v9 offset:19456
    v_mfma_f32_16x16x32_bf16 v[120:123], a[32:35], a[180:183], v[120:123]
    ds_read_b64_tr_b16 a[30:31], v9 offset:19968
    s_waitcnt lgkmcnt(8)
    v_mfma_f32_16x16x32_bf16 v[108:111], a[0:3], a[176:179], v[108:111]
    ds_read_b64_tr_b16 a[32:33], v10 offset:16384
    buffer_load_dwordx4 v17, s[96:99], s31 offen offset:3072 lds
    v_mfma_f32_16x16x32_bf16 v[108:111], a[4:7], a[184:187], v[108:111]
    ds_read_b64_tr_b16 a[34:35], v10 offset:16896
    v_mfma_f32_16x16x32_bf16 v[108:111], a[8:11], a[192:195], v[108:111]
    ds_read_b64_tr_b16 a[36:37], v10 offset:17408
    v_mfma_f32_16x16x32_bf16 v[108:111], a[12:15], a[200:203], v[108:111]
    ds_read_b64_tr_b16 a[38:39], v10 offset:17920
    s_mov_b32 s41, 36864
    v_mfma_f32_16x16x32_bf16 v[124:127], a[12:15], a[204:207], v[124:127]
    ds_read_b64_tr_b16 a[40:41], v10 offset:18432
    buffer_load_dwordx4 v[192:195], v13, s[12:15], s41 offen offset:0 sc1
    v_mfma_f32_16x16x32_bf16 v[124:127], a[8:11], a[196:199], v[124:127]
    ds_read_b64_tr_b16 a[42:43], v10 offset:18944
    v_mfma_f32_16x16x32_bf16 v[124:127], a[4:7], a[188:191], v[124:127]
    ds_read_b64_tr_b16 a[44:45], v10 offset:19456
    v_mfma_f32_16x16x32_bf16 v[124:127], a[0:3], a[180:183], v[124:127]
    ds_read_b64_tr_b16 a[46:47], v10 offset:19968
    s_waitcnt lgkmcnt(8)
    v_mfma_f32_16x16x32_bf16 v[128:131], a[16:19], a[176:179], v[128:131]
    ds_read_b64_tr_b16 a[0:1], v11 offset:16384
    buffer_load_dwordx4 v[196:199], v0, s[12:15], s41 offen offset:0 sc1
    v_mfma_f32_16x16x32_bf16 v[128:131], a[20:23], a[184:187], v[128:131]
    ds_read_b64_tr_b16 a[2:3], v11 offset:16896
    v_mfma_f32_16x16x32_bf16 v[128:131], a[24:27], a[192:195], v[128:131]
    ds_read_b64_tr_b16 a[4:5], v11 offset:17408
    v_mfma_f32_16x16x32_bf16 v[128:131], a[28:31], a[200:203], v[128:131]
    ds_read_b64_tr_b16 a[6:7], v11 offset:17920
    buffer_load_dwordx4 v[200:203], v13, s[12:15], s41 offen offset:1024 sc1
    v_mfma_f32_16x16x32_bf16 v[144:147], a[28:31], a[204:207], v[144:147]
    ds_read_b64_tr_b16 a[8:9], v11 offset:18432
    v_mfma_f32_16x16x32_bf16 v[144:147], a[24:27], a[196:199], v[144:147]
    ds_read_b64_tr_b16 a[10:11], v11 offset:18944
    v_mfma_f32_16x16x32_bf16 v[144:147], a[20:23], a[188:191], v[144:147]
    ds_read_b64_tr_b16 a[12:13], v11 offset:19456
    v_mfma_f32_16x16x32_bf16 v[144:147], a[16:19], a[180:183], v[144:147]
    ds_read_b64_tr_b16 a[14:15], v11 offset:19968
    s_waitcnt lgkmcnt(8)
    v_mfma_f32_16x16x32_bf16 v[132:135], a[32:35], a[176:179], v[132:135]
    ds_read_b64_tr_b16 a[16:17], v12 offset:16384
    buffer_load_dwordx4 v[204:207], v0, s[12:15], s41 offen offset:1024 sc1
    v_mfma_f32_16x16x32_bf16 v[132:135], a[36:39], a[184:187], v[132:135]
    ds_read_b64_tr_b16 a[18:19], v12 offset:16896
    v_mfma_f32_16x16x32_bf16 v[132:135], a[40:43], a[192:195], v[132:135]
    ds_read_b64_tr_b16 a[20:21], v12 offset:17408
    v_mfma_f32_16x16x32_bf16 v[132:135], a[44:47], a[200:203], v[132:135]
    ds_read_b64_tr_b16 a[22:23], v12 offset:17920
    v_mfma_f32_16x16x32_bf16 v[148:151], a[44:47], a[204:207], v[148:151]
    ds_read_b64_tr_b16 a[24:25], v12 offset:18432
    v_mfma_f32_16x16x32_bf16 v[148:151], a[40:43], a[196:199], v[148:151]
    ds_read_b64_tr_b16 a[26:27], v12 offset:18944
    v_mfma_f32_16x16x32_bf16 v[148:151], a[36:39], a[188:191], v[148:151]
    ds_read_b64_tr_b16 a[28:29], v12 offset:19456
    ds_read_b64_tr_b16 a[30:31], v12 offset:19968
    v_mfma_f32_16x16x32_bf16 v[148:151], a[32:35], a[180:183], v[148:151]
    s_waitcnt vmcnt(32) lgkmcnt(8)
    s_barrier
    v_mfma_f32_16x16x32_bf16 v[136:139], a[0:3], a[176:179], v[136:139]
    ds_read_b64_tr_b16 a[32:33], v1 offset:0
    buffer_load_dwordx4 v[208:211], v13, s[12:15], s41 offen offset:2048 sc1
    v_mfma_f32_16x16x32_bf16 v[136:139], a[4:7], a[184:187], v[136:139]
    ds_read_b64_tr_b16 a[34:35], v1 offset:512
    v_mfma_f32_16x16x32_bf16 v[136:139], a[8:11], a[192:195], v[136:139]
    ds_read_b64_tr_b16 a[36:37], v1 offset:1024
    v_mfma_f32_16x16x32_bf16 v[136:139], a[12:15], a[200:203], v[136:139]
    ds_read_b64_tr_b16 a[38:39], v1 offset:1536
    buffer_load_dwordx4 v[212:215], v0, s[12:15], s41 offen offset:2048 sc1
    v_mfma_f32_16x16x32_bf16 v[152:155], a[12:15], a[204:207], v[152:155]
    ds_read_b64_tr_b16 a[40:41], v1 offset:2048
    v_mfma_f32_16x16x32_bf16 v[152:155], a[8:11], a[196:199], v[152:155]
    ds_read_b64_tr_b16 a[42:43], v1 offset:2560
    v_mfma_f32_16x16x32_bf16 v[152:155], a[4:7], a[188:191], v[152:155]
    ds_read_b64_tr_b16 a[44:45], v1 offset:3072
    v_mfma_f32_16x16x32_bf16 v[152:155], a[0:3], a[180:183], v[152:155]
    ds_read_b64_tr_b16 a[46:47], v1 offset:3584
    s_waitcnt lgkmcnt(8)
    v_mfma_f32_16x16x32_bf16 v[140:143], a[16:19], a[176:179], v[140:143]
    ds_read_b64_tr_b16 a[0:1], v2 offset:0
    buffer_load_dwordx4 v[216:219], v13, s[12:15], s41 offen offset:3072 sc1
    v_mfma_f32_16x16x32_bf16 v[140:143], a[20:23], a[184:187], v[140:143]
    ds_read_b64_tr_b16 a[2:3], v2 offset:512
    v_mfma_f32_16x16x32_bf16 v[140:143], a[24:27], a[192:195], v[140:143]
    ds_read_b64_tr_b16 a[4:5], v2 offset:1024
    v_mfma_f32_16x16x32_bf16 v[140:143], a[28:31], a[200:203], v[140:143]
    ds_read_b64_tr_b16 a[6:7], v2 offset:1536
    buffer_load_dwordx4 v[220:223], v0, s[12:15], s41 offen offset:3072 sc1
    v_mfma_f32_16x16x32_bf16 v[156:159], a[28:31], a[204:207], v[156:159]
    ds_read_b64_tr_b16 a[8:9], v2 offset:2048
    v_mfma_f32_16x16x32_bf16 v[156:159], a[24:27], a[196:199], v[156:159]
    ds_read_b64_tr_b16 a[10:11], v2 offset:2560
    v_mfma_f32_16x16x32_bf16 v[156:159], a[20:23], a[188:191], v[156:159]
    ds_read_b64_tr_b16 a[12:13], v2 offset:3072
    v_mfma_f32_16x16x32_bf16 v[156:159], a[16:19], a[180:183], v[156:159]
    ds_read_b64_tr_b16 a[14:15], v2 offset:3584
    s_waitcnt vmcnt(28) lgkmcnt(8)
    v_mfma_f32_16x16x32_bf16 v[96:99], a[32:35], a[208:211], v[96:99]
    ds_read_b64_tr_b16 a[16:17], v3 offset:0
    s_add_u32 m0, s21, 65536
    v_mfma_f32_16x16x32_bf16 v[96:99], a[36:39], a[216:219], v[96:99]
    ds_read_b64_tr_b16 a[18:19], v3 offset:512
    buffer_load_dwordx4 v17, s[96:99], s32 offen offset:0 lds
    v_mfma_f32_16x16x32_bf16 v[96:99], a[40:43], a[224:227], v[96:99]
    ds_read_b64_tr_b16 a[20:21], v3 offset:1024
    v_mfma_f32_16x16x32_bf16 v[96:99], a[44:47], a[232:235], v[96:99]
    ds_read_b64_tr_b16 a[22:23], v3 offset:1536
    v_mfma_f32_16x16x32_bf16 v[112:115], a[44:47], a[236:239], v[112:115]
    ds_read_b64_tr_b16 a[24:25], v3 offset:2048
    buffer_load_dwordx4 v17, s[96:99], s33 offen offset:1024 lds
    v_mfma_f32_16x16x32_bf16 v[112:115], a[40:43], a[228:231], v[112:115]
    ds_read_b64_tr_b16 a[26:27], v3 offset:2560
    v_mfma_f32_16x16x32_bf16 v[112:115], a[36:39], a[220:223], v[112:115]
    ds_read_b64_tr_b16 a[28:29], v3 offset:3072
    v_mfma_f32_16x16x32_bf16 v[112:115], a[32:35], a[212:215], v[112:115]
    ds_read_b64_tr_b16 a[30:31], v3 offset:3584
    s_waitcnt lgkmcnt(8)
    v_mfma_f32_16x16x32_bf16 v[100:103], a[0:3], a[208:211], v[100:103]
    ds_read_b64_tr_b16 a[32:33], v4 offset:0
    buffer_load_dwordx4 v17, s[96:99], s34 offen offset:2048 lds
    v_mfma_f32_16x16x32_bf16 v[100:103], a[4:7], a[216:219], v[100:103]
    ds_read_b64_tr_b16 a[34:35], v4 offset:512
    v_mfma_f32_16x16x32_bf16 v[100:103], a[8:11], a[224:227], v[100:103]
    ds_read_b64_tr_b16 a[36:37], v4 offset:1024
    v_mfma_f32_16x16x32_bf16 v[100:103], a[12:15], a[232:235], v[100:103]
    ds_read_b64_tr_b16 a[38:39], v4 offset:1536
    buffer_load_dwordx4 v17, s[96:99], s35 offen offset:3072 lds
    v_mfma_f32_16x16x32_bf16 v[116:119], a[12:15], a[236:239], v[116:119]
    ds_read_b64_tr_b16 a[40:41], v4 offset:2048
    v_mfma_f32_16x16x32_bf16 v[116:119], a[8:11], a[228:231], v[116:119]
    ds_read_b64_tr_b16 a[42:43], v4 offset:2560
    v_mfma_f32_16x16x32_bf16 v[116:119], a[4:7], a[220:223], v[116:119]
    ds_read_b64_tr_b16 a[44:45], v4 offset:3072
    ds_read_b64_tr_b16 a[46:47], v4 offset:3584
    v_mfma_f32_16x16x32_bf16 v[116:119], a[0:3], a[212:215], v[116:119]
    s_waitcnt vmcnt(28) lgkmcnt(8)
    s_barrier
    v_mfma_f32_16x16x32_bf16 v[104:107], a[16:19], a[208:211], v[104:107]
    ds_read_b64_tr_b16 a[0:1], v1 offset:16384
    s_mov_b32 s42, 40960
    v_mfma_f32_16x16x32_bf16 v[104:107], a[20:23], a[216:219], v[104:107]
    ds_read_b64_tr_b16 a[2:3], v1 offset:16896
    buffer_load_dwordx4 v[224:227], v13, s[12:15], s42 offen offset:0 sc1
    v_mfma_f32_16x16x32_bf16 v[104:107], a[24:27], a[224:227], v[104:107]
    ds_read_b64_tr_b16 a[4:5], v1 offset:17408
    v_mfma_f32_16x16x32_bf16 v[104:107], a[28:31], a[232:235], v[104:107]
    ds_read_b64_tr_b16 a[6:7], v1 offset:17920
    v_mfma_f32_16x16x32_bf16 v[120:123], a[28:31], a[236:239], v[120:123]
    ds_read_b64_tr_b16 a[8:9], v1 offset:18432
    buffer_load_dwordx4 v[228:231], v0, s[12:15], s42 offen offset:0 sc1
    v_mfma_f32_16x16x32_bf16 v[120:123], a[24:27], a[228:231], v[120:123]
    ds_read_b64_tr_b16 a[10:11], v1 offset:18944
    v_mfma_f32_16x16x32_bf16 v[120:123], a[20:23], a[220:223], v[120:123]
    ds_read_b64_tr_b16 a[12:13], v1 offset:19456
    v_mfma_f32_16x16x32_bf16 v[120:123], a[16:19], a[212:215], v[120:123]
    ds_read_b64_tr_b16 a[14:15], v1 offset:19968
    s_waitcnt lgkmcnt(8)
    v_mfma_f32_16x16x32_bf16 v[108:111], a[32:35], a[208:211], v[108:111]
    ds_read_b64_tr_b16 a[16:17], v2 offset:16384
    buffer_load_dwordx4 v[232:235], v13, s[12:15], s42 offen offset:1024 sc1
    v_mfma_f32_16x16x32_bf16 v[108:111], a[36:39], a[216:219], v[108:111]
    ds_read_b64_tr_b16 a[18:19], v2 offset:16896
    v_mfma_f32_16x16x32_bf16 v[108:111], a[40:43], a[224:227], v[108:111]
    ds_read_b64_tr_b16 a[20:21], v2 offset:17408
    v_mfma_f32_16x16x32_bf16 v[108:111], a[44:47], a[232:235], v[108:111]
    ds_read_b64_tr_b16 a[22:23], v2 offset:17920
    buffer_load_dwordx4 v[236:239], v0, s[12:15], s42 offen offset:1024 sc1
    v_mfma_f32_16x16x32_bf16 v[124:127], a[44:47], a[236:239], v[124:127]
    ds_read_b64_tr_b16 a[24:25], v2 offset:18432
    v_mfma_f32_16x16x32_bf16 v[124:127], a[40:43], a[228:231], v[124:127]
    ds_read_b64_tr_b16 a[26:27], v2 offset:18944
    v_mfma_f32_16x16x32_bf16 v[124:127], a[36:39], a[220:223], v[124:127]
    ds_read_b64_tr_b16 a[28:29], v2 offset:19456
    v_mfma_f32_16x16x32_bf16 v[124:127], a[32:35], a[212:215], v[124:127]
    ds_read_b64_tr_b16 a[30:31], v2 offset:19968
    s_waitcnt lgkmcnt(8)
    v_mfma_f32_16x16x32_bf16 v[128:131], a[0:3], a[208:211], v[128:131]
    ds_read_b64_tr_b16 a[32:33], v3 offset:16384
    buffer_load_dwordx4 v[240:243], v13, s[12:15], s42 offen offset:2048 sc1
    v_mfma_f32_16x16x32_bf16 v[128:131], a[4:7], a[216:219], v[128:131]
    ds_read_b64_tr_b16 a[34:35], v3 offset:16896
    v_mfma_f32_16x16x32_bf16 v[128:131], a[8:11], a[224:227], v[128:131]
    ds_read_b64_tr_b16 a[36:37], v3 offset:17408
    v_mfma_f32_16x16x32_bf16 v[128:131], a[12:15], a[232:235], v[128:131]
    ds_read_b64_tr_b16 a[38:39], v3 offset:17920
    v_mfma_f32_16x16x32_bf16 v[144:147], a[12:15], a[236:239], v[144:147]
    ds_read_b64_tr_b16 a[40:41], v3 offset:18432
    v_mfma_f32_16x16x32_bf16 v[144:147], a[8:11], a[228:231], v[144:147]
    ds_read_b64_tr_b16 a[42:43], v3 offset:18944
    v_mfma_f32_16x16x32_bf16 v[144:147], a[4:7], a[220:223], v[144:147]
    ds_read_b64_tr_b16 a[44:45], v3 offset:19456
    v_mfma_f32_16x16x32_bf16 v[144:147], a[0:3], a[212:215], v[144:147]
    ds_read_b64_tr_b16 a[46:47], v3 offset:19968
    s_waitcnt lgkmcnt(8)
    v_mfma_f32_16x16x32_bf16 v[132:135], a[16:19], a[208:211], v[132:135]
    ds_read_b64_tr_b16 a[0:1], v4 offset:16384
    buffer_load_dwordx4 v[244:247], v0, s[12:15], s42 offen offset:2048 sc1
    v_mfma_f32_16x16x32_bf16 v[132:135], a[20:23], a[216:219], v[132:135]
    ds_read_b64_tr_b16 a[2:3], v4 offset:16896
    v_mfma_f32_16x16x32_bf16 v[132:135], a[24:27], a[224:227], v[132:135]
    ds_read_b64_tr_b16 a[4:5], v4 offset:17408
    v_mfma_f32_16x16x32_bf16 v[132:135], a[28:31], a[232:235], v[132:135]
    ds_read_b64_tr_b16 a[6:7], v4 offset:17920
    buffer_load_dwordx4 v[248:251], v13, s[12:15], s42 offen offset:3072 sc1
    v_mfma_f32_16x16x32_bf16 v[148:151], a[28:31], a[236:239], v[148:151]
    ds_read_b64_tr_b16 a[8:9], v4 offset:18432
    v_mfma_f32_16x16x32_bf16 v[148:151], a[24:27], a[228:231], v[148:151]
    ds_read_b64_tr_b16 a[10:11], v4 offset:18944
    v_mfma_f32_16x16x32_bf16 v[148:151], a[20:23], a[220:223], v[148:151]
    ds_read_b64_tr_b16 a[12:13], v4 offset:19456
    ds_read_b64_tr_b16 a[14:15], v4 offset:19968
    v_mfma_f32_16x16x32_bf16 v[148:151], a[16:19], a[212:215], v[148:151]
    s_waitcnt vmcnt(31) lgkmcnt(8)
    s_barrier
    v_mfma_f32_16x16x32_bf16 v[136:139], a[32:35], a[208:211], v[136:139]
    ds_read_b64_tr_b16 a[16:17], v1 offset:32768
    buffer_load_dwordx4 v[252:255], v0, s[12:15], s42 offen offset:3072 sc1
    v_mfma_f32_16x16x32_bf16 v[136:139], a[36:39], a[216:219], v[136:139]
    ds_read_b64_tr_b16 a[18:19], v1 offset:33280
    v_mfma_f32_16x16x32_bf16 v[136:139], a[40:43], a[224:227], v[136:139]
    ds_read_b64_tr_b16 a[20:21], v1 offset:33792
    v_mfma_f32_16x16x32_bf16 v[136:139], a[44:47], a[232:235], v[136:139]
    ds_read_b64_tr_b16 a[22:23], v1 offset:34304
    s_add_u32 m0, s21, 81920
    v_mfma_f32_16x16x32_bf16 v[152:155], a[44:47], a[236:239], v[152:155]
    ds_read_b64_tr_b16 a[24:25], v1 offset:34816
    buffer_load_dwordx4 v17, s[96:99], s36 offen offset:0 lds
    v_mfma_f32_16x16x32_bf16 v[152:155], a[40:43], a[228:231], v[152:155]
    ds_read_b64_tr_b16 a[26:27], v1 offset:35328
    v_mfma_f32_16x16x32_bf16 v[152:155], a[36:39], a[220:223], v[152:155]
    ds_read_b64_tr_b16 a[28:29], v1 offset:35840
    v_mfma_f32_16x16x32_bf16 v[152:155], a[32:35], a[212:215], v[152:155]
    ds_read_b64_tr_b16 a[30:31], v1 offset:36352
    s_waitcnt lgkmcnt(8)
    v_mfma_f32_16x16x32_bf16 v[140:143], a[0:3], a[208:211], v[140:143]
    ds_read_b64_tr_b16 a[32:33], v2 offset:32768
    buffer_load_dwordx4 v17, s[96:99], s37 offen offset:1024 lds
    v_mfma_f32_16x16x32_bf16 v[140:143], a[4:7], a[216:219], v[140:143]
    ds_read_b64_tr_b16 a[34:35], v2 offset:33280
    v_mfma_f32_16x16x32_bf16 v[140:143], a[8:11], a[224:227], v[140:143]
    ds_read_b64_tr_b16 a[36:37], v2 offset:33792
    v_mfma_f32_16x16x32_bf16 v[140:143], a[12:15], a[232:235], v[140:143]
    ds_read_b64_tr_b16 a[38:39], v2 offset:34304
    buffer_load_dwordx4 v17, s[96:99], s38 offen offset:2048 lds
    v_mfma_f32_16x16x32_bf16 v[156:159], a[12:15], a[236:239], v[156:159]
    ds_read_b64_tr_b16 a[40:41], v2 offset:34816
    v_mfma_f32_16x16x32_bf16 v[156:159], a[8:11], a[228:231], v[156:159]
    ds_read_b64_tr_b16 a[42:43], v2 offset:35328
    v_mfma_f32_16x16x32_bf16 v[156:159], a[4:7], a[220:223], v[156:159]
    ds_read_b64_tr_b16 a[44:45], v2 offset:35840
    v_mfma_f32_16x16x32_bf16 v[156:159], a[0:3], a[212:215], v[156:159]
    ds_read_b64_tr_b16 a[46:47], v2 offset:36352
    s_waitcnt vmcnt(27) lgkmcnt(8)
    v_mfma_f32_16x16x32_bf16 v[96:99], a[16:19], v[160:163], v[96:99]
    ds_read_b64_tr_b16 a[0:1], v3 offset:32768
    buffer_load_dwordx4 v17, s[96:99], s39 offen offset:3072 lds
    v_mfma_f32_16x16x32_bf16 v[96:99], a[20:23], v[168:171], v[96:99]
    ds_read_b64_tr_b16 a[2:3], v3 offset:33280
    v_mfma_f32_16x16x32_bf16 v[96:99], a[24:27], v[176:179], v[96:99]
    ds_read_b64_tr_b16 a[4:5], v3 offset:33792
    v_mfma_f32_16x16x32_bf16 v[96:99], a[28:31], v[184:187], v[96:99]
    ds_read_b64_tr_b16 a[6:7], v3 offset:34304
    s_mov_b32 s43, 45056
    v_mfma_f32_16x16x32_bf16 v[112:115], a[28:31], v[188:191], v[112:115]
    ds_read_b64_tr_b16 a[8:9], v3 offset:34816
    buffer_load_dwordx4 v[32:35], v13, s[12:15], s43 offen offset:0 sc1
    v_mfma_f32_16x16x32_bf16 v[112:115], a[24:27], v[180:183], v[112:115]
    ds_read_b64_tr_b16 a[10:11], v3 offset:35328
    v_mfma_f32_16x16x32_bf16 v[112:115], a[20:23], v[172:175], v[112:115]
    ds_read_b64_tr_b16 a[12:13], v3 offset:35840
    v_mfma_f32_16x16x32_bf16 v[112:115], a[16:19], v[164:167], v[112:115]
    ds_read_b64_tr_b16 a[14:15], v3 offset:36352
    s_waitcnt lgkmcnt(8)
    v_mfma_f32_16x16x32_bf16 v[100:103], a[32:35], v[160:163], v[100:103]
    ds_read_b64_tr_b16 a[16:17], v4 offset:32768
    buffer_load_dwordx4 v[36:39], v0, s[12:15], s43 offen offset:0 sc1
    v_mfma_f32_16x16x32_bf16 v[100:103], a[36:39], v[168:171], v[100:103]
    ds_read_b64_tr_b16 a[18:19], v4 offset:33280
    v_mfma_f32_16x16x32_bf16 v[100:103], a[40:43], v[176:179], v[100:103]
    ds_read_b64_tr_b16 a[20:21], v4 offset:33792
    v_mfma_f32_16x16x32_bf16 v[100:103], a[44:47], v[184:187], v[100:103]
    ds_read_b64_tr_b16 a[22:23], v4 offset:34304
    buffer_load_dwordx4 v[40:43], v13, s[12:15], s43 offen offset:1024 sc1
    v_mfma_f32_16x16x32_bf16 v[116:119], a[44:47], v[188:191], v[116:119]
    ds_read_b64_tr_b16 a[24:25], v4 offset:34816
    v_mfma_f32_16x16x32_bf16 v[116:119], a[40:43], v[180:183], v[116:119]
    ds_read_b64_tr_b16 a[26:27], v4 offset:35328
    v_mfma_f32_16x16x32_bf16 v[116:119], a[36:39], v[172:175], v[116:119]
    ds_read_b64_tr_b16 a[28:29], v4 offset:35840
    ds_read_b64_tr_b16 a[30:31], v4 offset:36352
    v_mfma_f32_16x16x32_bf16 v[116:119], a[32:35], v[164:167], v[116:119]
    s_waitcnt vmcnt(27) lgkmcnt(8)
    s_barrier
    v_mfma_f32_16x16x32_bf16 v[104:107], a[0:3], v[160:163], v[104:107]
    ds_read_b64_tr_b16 a[32:33], v1 offset:49152
    buffer_load_dwordx4 v[44:47], v0, s[12:15], s43 offen offset:1024 sc1
    v_mfma_f32_16x16x32_bf16 v[104:107], a[4:7], v[168:171], v[104:107]
    ds_read_b64_tr_b16 a[34:35], v1 offset:49664
    v_mfma_f32_16x16x32_bf16 v[104:107], a[8:11], v[176:179], v[104:107]
    ds_read_b64_tr_b16 a[36:37], v1 offset:50176
    v_mfma_f32_16x16x32_bf16 v[104:107], a[12:15], v[184:187], v[104:107]
    ds_read_b64_tr_b16 a[38:39], v1 offset:50688
    v_mfma_f32_16x16x32_bf16 v[120:123], a[12:15], v[188:191], v[120:123]
    ds_read_b64_tr_b16 a[40:41], v1 offset:51200
    v_mfma_f32_16x16x32_bf16 v[120:123], a[8:11], v[180:183], v[120:123]
    ds_read_b64_tr_b16 a[42:43], v1 offset:51712
    v_mfma_f32_16x16x32_bf16 v[120:123], a[4:7], v[172:175], v[120:123]
    ds_read_b64_tr_b16 a[44:45], v1 offset:52224
    v_mfma_f32_16x16x32_bf16 v[120:123], a[0:3], v[164:167], v[120:123]
    ds_read_b64_tr_b16 a[46:47], v1 offset:52736
    s_waitcnt lgkmcnt(8)
    v_mfma_f32_16x16x32_bf16 v[108:111], a[16:19], v[160:163], v[108:111]
    ds_read_b64_tr_b16 a[0:1], v2 offset:49152
    buffer_load_dwordx4 v[48:51], v13, s[12:15], s43 offen offset:2048 sc1
    v_mfma_f32_16x16x32_bf16 v[108:111], a[20:23], v[168:171], v[108:111]
    ds_read_b64_tr_b16 a[2:3], v2 offset:49664
    v_mfma_f32_16x16x32_bf16 v[108:111], a[24:27], v[176:179], v[108:111]
    ds_read_b64_tr_b16 a[4:5], v2 offset:50176
    v_mfma_f32_16x16x32_bf16 v[108:111], a[28:31], v[184:187], v[108:111]
    ds_read_b64_tr_b16 a[6:7], v2 offset:50688
    buffer_load_dwordx4 v[52:55], v0, s[12:15], s43 offen offset:2048 sc1
    v_mfma_f32_16x16x32_bf16 v[124:127], a[28:31], v[188:191], v[124:127]
    ds_read_b64_tr_b16 a[8:9], v2 offset:51200
    v_mfma_f32_16x16x32_bf16 v[124:127], a[24:27], v[180:183], v[124:127]
    ds_read_b64_tr_b16 a[10:11], v2 offset:51712
    v_mfma_f32_16x16x32_bf16 v[124:127], a[20:23], v[172:175], v[124:127]
    ds_read_b64_tr_b16 a[12:13], v2 offset:52224
    v_mfma_f32_16x16x32_bf16 v[124:127], a[16:19], v[164:167], v[124:127]
    ds_read_b64_tr_b16 a[14:15], v2 offset:52736
    s_waitcnt vmcnt(22) lgkmcnt(8)
    v_mfma_f32_16x16x32_bf16 v[96:99], a[32:35], v[192:195], v[96:99]
    ds_read_b64_tr_b16 a[16:17], v3 offset:49152
    buffer_load_dwordx4 v[56:59], v13, s[12:15], s43 offen offset:3072 sc1
    v_mfma_f32_16x16x32_bf16 v[96:99], a[36:39], v[200:203], v[96:99]
    ds_read_b64_tr_b16 a[18:19], v3 offset:49664
    v_mfma_f32_16x16x32_bf16 v[96:99], a[40:43], v[208:211], v[96:99]
    ds_read_b64_tr_b16 a[20:21], v3 offset:50176
    v_mfma_f32_16x16x32_bf16 v[96:99], a[44:47], v[216:219], v[96:99]
    ds_read_b64_tr_b16 a[22:23], v3 offset:50688
    buffer_load_dwordx4 v[60:63], v0, s[12:15], s43 offen offset:3072 sc1
    v_mfma_f32_16x16x32_bf16 v[112:115], a[44:47], v[220:223], v[112:115]
    ds_read_b64_tr_b16 a[24:25], v3 offset:51200
    v_mfma_f32_16x16x32_bf16 v[112:115], a[40:43], v[212:215], v[112:115]
    ds_read_b64_tr_b16 a[26:27], v3 offset:51712
    v_mfma_f32_16x16x32_bf16 v[112:115], a[36:39], v[204:207], v[112:115]
    ds_read_b64_tr_b16 a[28:29], v3 offset:52224
    v_mfma_f32_16x16x32_bf16 v[112:115], a[32:35], v[196:199], v[112:115]
    ds_read_b64_tr_b16 a[30:31], v3 offset:52736
    s_waitcnt lgkmcnt(8)
    v_mfma_f32_16x16x32_bf16 v[100:103], a[0:3], v[192:195], v[100:103]
    ds_read_b64_tr_b16 a[32:33], v4 offset:49152
    v_add_u32 v17, 32768, v17
    v_mfma_f32_16x16x32_bf16 v[100:103], a[4:7], v[200:203], v[100:103]
    ds_read_b64_tr_b16 a[34:35], v4 offset:49664
    v_add_u32 v17, s23, v17
    v_mfma_f32_16x16x32_bf16 v[100:103], a[8:11], v[208:211], v[100:103]
    ds_read_b64_tr_b16 a[36:37], v4 offset:50176
    s_add_u32 m0, s21, 98304
    v_mfma_f32_16x16x32_bf16 v[100:103], a[12:15], v[216:219], v[100:103]
    ds_read_b64_tr_b16 a[38:39], v4 offset:50688
    buffer_load_dwordx4 v17, s[96:99], 0 offen offset:0 lds
    v_mfma_f32_16x16x32_bf16 v[116:119], a[12:15], v[220:223], v[116:119]
    ds_read_b64_tr_b16 a[40:41], v4 offset:51200
    v_mfma_f32_16x16x32_bf16 v[116:119], a[8:11], v[212:215], v[116:119]
    ds_read_b64_tr_b16 a[42:43], v4 offset:51712
    v_mfma_f32_16x16x32_bf16 v[116:119], a[4:7], v[204:207], v[116:119]
    ds_read_b64_tr_b16 a[44:45], v4 offset:52224
    ds_read_b64_tr_b16 a[46:47], v4 offset:52736
    s_mov_b32 s48, 457728
    buffer_load_dwordx4 v17, s[96:99], s48 offen offset:1024 lds
    v_mfma_f32_16x16x32_bf16 v[116:119], a[0:3], v[196:199], v[116:119]
    s_waitcnt vmcnt(22) lgkmcnt(8)
    s_barrier
    v_mfma_f32_16x16x32_bf16 v[104:107], a[16:19], v[192:195], v[104:107]
    ds_read_b64_tr_b16 a[0:1], v5 offset:0
    s_mov_b32 s49, 915456
    v_mfma_f32_16x16x32_bf16 v[104:107], a[20:23], v[200:203], v[104:107]
    ds_read_b64_tr_b16 a[2:3], v5 offset:512
    buffer_load_dwordx4 v17, s[96:99], s49 offen offset:2048 lds
    v_mfma_f32_16x16x32_bf16 v[104:107], a[24:27], v[208:211], v[104:107]
    ds_read_b64_tr_b16 a[4:5], v5 offset:1024
    v_mfma_f32_16x16x32_bf16 v[104:107], a[28:31], v[216:219], v[104:107]
    ds_read_b64_tr_b16 a[6:7], v5 offset:1536
    v_mfma_f32_16x16x32_bf16 v[120:123], a[28:31], v[220:223], v[120:123]
    ds_read_b64_tr_b16 a[8:9], v5 offset:2048
    s_mov_b32 s50, 1373184
    v_mfma_f32_16x16x32_bf16 v[120:123], a[24:27], v[212:215], v[120:123]
    ds_read_b64_tr_b16 a[10:11], v5 offset:2560
    buffer_load_dwordx4 v17, s[96:99], s50 offen offset:3072 lds
    v_mfma_f32_16x16x32_bf16 v[120:123], a[20:23], v[204:207], v[120:123]
    ds_read_b64_tr_b16 a[12:13], v5 offset:3072
    v_mfma_f32_16x16x32_bf16 v[120:123], a[16:19], v[196:199], v[120:123]
    ds_read_b64_tr_b16 a[14:15], v5 offset:3584
    s_waitcnt lgkmcnt(8)
    v_mfma_f32_16x16x32_bf16 v[108:111], a[32:35], v[192:195], v[108:111]
    ds_read_b64_tr_b16 a[16:17], v6 offset:0
    s_mov_b32 s40, 49152
    v_mfma_f32_16x16x32_bf16 v[108:111], a[36:39], v[200:203], v[108:111]
    ds_read_b64_tr_b16 a[18:19], v6 offset:512
    buffer_load_dwordx4 v[64:67], v13, s[12:15], s40 offen offset:0 sc1
    v_mfma_f32_16x16x32_bf16 v[108:111], a[40:43], v[208:211], v[108:111]
    ds_read_b64_tr_b16 a[20:21], v6 offset:1024
    v_mfma_f32_16x16x32_bf16 v[108:111], a[44:47], v[216:219], v[108:111]
    ds_read_b64_tr_b16 a[22:23], v6 offset:1536
    v_mfma_f32_16x16x32_bf16 v[124:127], a[44:47], v[220:223], v[124:127]
    ds_read_b64_tr_b16 a[24:25], v6 offset:2048
    buffer_load_dwordx4 v[68:71], v0, s[12:15], s40 offen offset:0 sc1
    v_mfma_f32_16x16x32_bf16 v[124:127], a[40:43], v[212:215], v[124:127]
    ds_read_b64_tr_b16 a[26:27], v6 offset:2560
    v_mfma_f32_16x16x32_bf16 v[124:127], a[36:39], v[204:207], v[124:127]
    ds_read_b64_tr_b16 a[28:29], v6 offset:3072
    v_mfma_f32_16x16x32_bf16 v[124:127], a[32:35], v[196:199], v[124:127]
    ds_read_b64_tr_b16 a[30:31], v6 offset:3584
    s_waitcnt vmcnt(18) lgkmcnt(8)
    v_mfma_f32_16x16x32_bf16 v[96:99], a[0:3], v[224:227], v[96:99]
    ds_read_b64_tr_b16 a[32:33], v7 offset:0
    buffer_load_dwordx4 v[72:75], v13, s[12:15], s40 offen offset:1024 sc1
    v_mfma_f32_16x16x32_bf16 v[96:99], a[4:7], v[232:235], v[96:99]
    ds_read_b64_tr_b16 a[34:35], v7 offset:512
    v_mfma_f32_16x16x32_bf16 v[96:99], a[8:11], v[240:243], v[96:99]
    ds_read_b64_tr_b16 a[36:37], v7 offset:1024
    v_mfma_f32_16x16x32_bf16 v[96:99], a[12:15], v[248:251], v[96:99]
    ds_read_b64_tr_b16 a[38:39], v7 offset:1536
    buffer_load_dwordx4 v[76:79], v0, s[12:15], s40 offen offset:1024 sc1
    v_mfma_f32_16x16x32_bf16 v[112:115], a[12:15], v[252:255], v[112:115]
    ds_read_b64_tr_b16 a[40:41], v7 offset:2048
    v_mfma_f32_16x16x32_bf16 v[112:115], a[8:11], v[244:247], v[112:115]
    ds_read_b64_tr_b16 a[42:43], v7 offset:2560
    v_mfma_f32_16x16x32_bf16 v[112:115], a[4:7], v[236:239], v[112:115]
    ds_read_b64_tr_b16 a[44:45], v7 offset:3072
    v_mfma_f32_16x16x32_bf16 v[112:115], a[0:3], v[228:231], v[112:115]
    ds_read_b64_tr_b16 a[46:47], v7 offset:3584
    s_waitcnt lgkmcnt(8)
    v_mfma_f32_16x16x32_bf16 v[100:103], a[16:19], v[224:227], v[100:103]
    ds_read_b64_tr_b16 a[0:1], v8 offset:0
    buffer_load_dwordx4 v[80:83], v13, s[12:15], s40 offen offset:2048 sc1
    v_mfma_f32_16x16x32_bf16 v[100:103], a[20:23], v[232:235], v[100:103]
    ds_read_b64_tr_b16 a[2:3], v8 offset:512
    v_mfma_f32_16x16x32_bf16 v[100:103], a[24:27], v[240:243], v[100:103]
    ds_read_b64_tr_b16 a[4:5], v8 offset:1024
    v_mfma_f32_16x16x32_bf16 v[100:103], a[28:31], v[248:251], v[100:103]
    ds_read_b64_tr_b16 a[6:7], v8 offset:1536
    v_mfma_f32_16x16x32_bf16 v[116:119], a[28:31], v[252:255], v[116:119]
    ds_read_b64_tr_b16 a[8:9], v8 offset:2048
    v_mfma_f32_16x16x32_bf16 v[116:119], a[24:27], v[244:247], v[116:119]
    ds_read_b64_tr_b16 a[10:11], v8 offset:2560
    v_mfma_f32_16x16x32_bf16 v[116:119], a[20:23], v[236:239], v[116:119]
    ds_read_b64_tr_b16 a[12:13], v8 offset:3072
    ds_read_b64_tr_b16 a[14:15], v8 offset:3584
    v_mfma_f32_16x16x32_bf16 v[116:119], a[16:19], v[228:231], v[116:119]
    s_waitcnt vmcnt(17) lgkmcnt(8)
    s_barrier
    v_mfma_f32_16x16x32_bf16 v[104:107], a[32:35], v[224:227], v[104:107]
    ds_read_b64_tr_b16 a[16:17], v5 offset:16384
    buffer_load_dwordx4 v[84:87], v0, s[12:15], s40 offen offset:2048 sc1
    v_mfma_f32_16x16x32_bf16 v[104:107], a[36:39], v[232:235], v[104:107]
    ds_read_b64_tr_b16 a[18:19], v5 offset:16896
    v_mfma_f32_16x16x32_bf16 v[104:107], a[40:43], v[240:243], v[104:107]
    ds_read_b64_tr_b16 a[20:21], v5 offset:17408
    v_mfma_f32_16x16x32_bf16 v[104:107], a[44:47], v[248:251], v[104:107]
    ds_read_b64_tr_b16 a[22:23], v5 offset:17920
    buffer_load_dwordx4 v[88:91], v13, s[12:15], s40 offen offset:3072 sc1
    v_mfma_f32_16x16x32_bf16 v[120:123], a[44:47], v[252:255], v[120:123]
    ds_read_b64_tr_b16 a[24:25], v5 offset:18432
    v_mfma_f32_16x16x32_bf16 v[120:123], a[40:43], v[244:247], v[120:123]
    ds_read_b64_tr_b16 a[26:27], v5 offset:18944
    v_mfma_f32_16x16x32_bf16 v[120:123], a[36:39], v[236:239], v[120:123]
    ds_read_b64_tr_b16 a[28:29], v5 offset:19456
    buffer_load_dwordx4 v[92:95], v0, s[12:15], s40 offen offset:3072 sc1
    v_mfma_f32_16x16x32_bf16 v[120:123], a[32:35], v[228:231], v[120:123]
    ds_read_b64_tr_b16 a[30:31], v5 offset:19968
    s_waitcnt lgkmcnt(8)
    v_mfma_f32_16x16x32_bf16 v[108:111], a[0:3], v[224:227], v[108:111]
    ds_read_b64_tr_b16 a[32:33], v6 offset:16384
    s_add_u32 m0, s21, 114688
    v_mfma_f32_16x16x32_bf16 v[108:111], a[4:7], v[232:235], v[108:111]
    ds_read_b64_tr_b16 a[34:35], v6 offset:16896
    s_mov_b32 s51, 1835008
    v_mfma_f32_16x16x32_bf16 v[108:111], a[8:11], v[240:243], v[108:111]
    ds_read_b64_tr_b16 a[36:37], v6 offset:17408
    buffer_load_dwordx4 v17, s[96:99], s51 offen offset:0 lds
    v_mfma_f32_16x16x32_bf16 v[108:111], a[12:15], v[248:251], v[108:111]
    ds_read_b64_tr_b16 a[38:39], v6 offset:17920
    v_mfma_f32_16x16x32_bf16 v[124:127], a[12:15], v[252:255], v[124:127]
    ds_read_b64_tr_b16 a[40:41], v6 offset:18432
    v_mfma_f32_16x16x32_bf16 v[124:127], a[8:11], v[244:247], v[124:127]
    ds_read_b64_tr_b16 a[42:43], v6 offset:18944
    s_mov_b32 s48, 2292736
    v_mfma_f32_16x16x32_bf16 v[124:127], a[4:7], v[236:239], v[124:127]
    ds_read_b64_tr_b16 a[44:45], v6 offset:19456
    buffer_load_dwordx4 v17, s[96:99], s48 offen offset:1024 lds
    v_mfma_f32_16x16x32_bf16 v[124:127], a[0:3], v[228:231], v[124:127]
    ds_read_b64_tr_b16 a[46:47], v6 offset:19968
    s_waitcnt vmcnt(14) lgkmcnt(8)
    v_mfma_f32_16x16x32_bf16 v[96:99], a[16:19], v[32:35], v[96:99]
    ds_read_b64_tr_b16 a[0:1], v7 offset:16384
    s_mov_b32 s49, 2750464
    v_mfma_f32_16x16x32_bf16 v[96:99], a[20:23], v[40:43], v[96:99]
    ds_read_b64_tr_b16 a[2:3], v7 offset:16896
    buffer_load_dwordx4 v17, s[96:99], s49 offen offset:2048 lds
    v_mfma_f32_16x16x32_bf16 v[96:99], a[24:27], v[48:51], v[96:99]
    ds_read_b64_tr_b16 a[4:5], v7 offset:17408
    v_mfma_f32_16x16x32_bf16 v[96:99], a[28:31], v[56:59], v[96:99]
    ds_read_b64_tr_b16 a[6:7], v7 offset:17920
    v_mfma_f32_16x16x32_bf16 v[112:115], a[28:31], v[60:63], v[112:115]
    ds_read_b64_tr_b16 a[8:9], v7 offset:18432
    s_mov_b32 s50, 3208192
    v_mfma_f32_16x16x32_bf16 v[112:115], a[24:27], v[52:55], v[112:115]
    ds_read_b64_tr_b16 a[10:11], v7 offset:18944
    buffer_load_dwordx4 v17, s[96:99], s50 offen offset:3072 lds
L_pad10:
    s_cbranch_execz L_pad_ret
    v_mfma_f32_16x16x32_bf16 v[112:115], a[20:23], v[44:47], v[112:115]
    ds_read_b64_tr_b16 a[12:13], v7 offset:19456
    v_mfma_f32_16x16x32_bf16 v[112:115], a[16:19], v[36:39], v[112:115]
    ds_read_b64_tr_b16 a[14:15], v7 offset:19968
    s_waitcnt lgkmcnt(8)
    v_mfma_f32_16x16x32_bf16 v[100:103], a[32:35], v[32:35], v[100:103]
    ds_read_b64_tr_b16 a[16:17], v8 offset:16384
    s_mov_b32 s41, 53248
    v_mfma_f32_16x16x32_bf16 v[100:103], a[36:39], v[40:43], v[100:103]
    ds_read_b64_tr_b16 a[18:19], v8 offset:16896
    buffer_load_dwordx4 a[48:51], v13, s[12:15], s41 offen offset:0 sc1
    v_mfma_f32_16x16x32_bf16 v[100:103], a[40:43], v[48:51], v[100:103]
    ds_read_b64_tr_b16 a[20:21], v8 offset:17408
    v_mfma_f32_16x16x32_bf16 v[100:103], a[44:47], v[56:59], v[100:103]
    ds_read_b64_tr_b16 a[22:23], v8 offset:17920
    v_mfma_f32_16x16x32_bf16 v[116:119], a[44:47], v[60:63], v[116:119]
    ds_read_b64_tr_b16 a[24:25], v8 offset:18432
    buffer_load_dwordx4 a[52:55], v0, s[12:15], s41 offen offset:0 sc1
    v_mfma_f32_16x16x32_bf16 v[116:119], a[40:43], v[52:55], v[116:119]
    ds_read_b64_tr_b16 a[26:27], v8 offset:18944
    v_mfma_f32_16x16x32_bf16 v[116:119], a[36:39], v[44:47], v[116:119]
    ds_read_b64_tr_b16 a[28:29], v8 offset:19456
    ds_read_b64_tr_b16 a[30:31], v8 offset:19968
    v_mfma_f32_16x16x32_bf16 v[116:119], a[32:35], v[36:39], v[116:119]
    s_waitcnt vmcnt(14) lgkmcnt(8)
    s_barrier
    v_mfma_f32_16x16x32_bf16 v[104:107], a[0:3], v[32:35], v[104:107]
    ds_read_b64_tr_b16 a[32:33], v5 offset:32768
    buffer_load_dwordx4 a[56:59], v13, s[12:15], s41 offen offset:1024 sc1
    v_mfma_f32_16x16x32_bf16 v[104:107], a[4:7], v[40:43], v[104:107]
    ds_read_b64_tr_b16 a[34:35], v5 offset:33280
    v_mfma_f32_16x16x32_bf16 v[104:107], a[8:11], v[48:51], v[104:107]
    ds_read_b64_tr_b16 a[36:37], v5 offset:33792
    v_mfma_f32_16x16x32_bf16 v[104:107], a[12:15], v[56:59], v[104:107]
    ds_read_b64_tr_b16 a[38:39], v5 offset:34304
    buffer_load_dwordx4 a[60:63], v0, s[12:15], s41 offen offset:1024 sc1
    v_mfma_f32_16x16x32_bf16 v[120:123], a[12:15], v[60:63], v[120:123]
    ds_read_b64_tr_b16 a[40:41], v5 offset:34816
    v_mfma_f32_16x16x32_bf16 v[120:123], a[8:11], v[52:55], v[120:123]
    ds_read_b64_tr_b16 a[42:43], v5 offset:35328
    v_mfma_f32_16x16x32_bf16 v[120:123], a[4:7], v[44:47], v[120:123]
    ds_read_b64_tr_b16 a[44:45], v5 offset:35840
    buffer_load_dwordx4 a[64:67], v13, s[12:15], s41 offen offset:2048 sc1
    v_mfma_f32_16x16x32_bf16 v[120:123], a[0:3], v[36:39], v[120:123]
    ds_read_b64_tr_b16 a[46:47], v5 offset:36352
    s_waitcnt lgkmcnt(8)
    v_mfma_f32_16x16x32_bf16 v[108:111], a[16:19], v[32:35], v[108:111]
    ds_read_b64_tr_b16 a[0:1], v6 offset:32768
    buffer_load_dwordx4 a[68:71], v0, s[12:15], s41 offen offset:2048 sc1
    v_mfma_f32_16x16x32_bf16 v[108:111], a[20:23], v[40:43], v[108:111]
    ds_read_b64_tr_b16 a[2:3], v6 offset:33280
    v_mfma_f32_16x16x32_bf16 v[108:111], a[24:27], v[48:51], v[108:111]
    ds_read_b64_tr_b16 a[4:5], v6 offset:33792
    v_mfma_f32_16x16x32_bf16 v[108:111], a[28:31], v[56:59], v[108:111]
    ds_read_b64_tr_b16 a[6:7], v6 offset:34304
    buffer_load_dwordx4 a[72:75], v13, s[12:15], s41 offen offset:3072 sc1
    v_mfma_f32_16x16x32_bf16 v[124:127], a[28:31], v[60:63], v[124:127]
    ds_read_b64_tr_b16 a[8:9], v6 offset:34816
    v_mfma_f32_16x16x32_bf16 v[124:127], a[24:27], v[52:55], v[124:127]
    ds_read_b64_tr_b16 a[10:11], v6 offset:35328
    v_mfma_f32_16x16x32_bf16 v[124:127], a[20:23], v[44:47], v[124:127]
    ds_read_b64_tr_b16 a[12:13], v6 offset:35840
    buffer_load_dwordx4 a[76:79], v0, s[12:15], s41 offen offset:3072 sc1
    v_mfma_f32_16x16x32_bf16 v[124:127], a[16:19], v[36:39], v[124:127]
    ds_read_b64_tr_b16 a[14:15], v6 offset:36352
    s_waitcnt vmcnt(12) lgkmcnt(8)
    v_mfma_f32_16x16x32_bf16 v[96:99], a[32:35], v[64:67], v[96:99]
    ds_read_b64_tr_b16 a[16:17], v7 offset:32768
    v_add_u32 v18, 32768, v18
    v_mfma_f32_16x16x32_bf16 v[96:99], a[36:39], v[72:75], v[96:99]
    ds_read_b64_tr_b16 a[18:19], v7 offset:33280
    s_add_u32 m0, s21, 131072
    v_mfma_f32_16x16x32_bf16 v[96:99], a[40:43], v[80:83], v[96:99]
    ds_read_b64_tr_b16 a[20:21], v7 offset:33792
    buffer_load_dwordx4 v18, s[96:99], s24 offen offset:0 lds
    v_mfma_f32_16x16x32_bf16 v[96:99], a[44:47], v[88:91], v[96:99]
    ds_read_b64_tr_b16 a[22:23], v7 offset:34304
    v_mfma_f32_16x16x32_bf16 v[112:115], a[44:47], v[92:95], v[112:115]
    ds_read_b64_tr_b16 a[24:25], v7 offset:34816
    v_mfma_f32_16x16x32_bf16 v[112:115], a[40:43], v[84:87], v[112:115]
    ds_read_b64_tr_b16 a[26:27], v7 offset:35328
    buffer_load_dwordx4 v18, s[96:99], s25 offen offset:1024 lds
    v_mfma_f32_16x16x32_bf16 v[112:115], a[36:39], v[76:79], v[112:115]
    ds_read_b64_tr_b16 a[28:29], v7 offset:35840
    buffer_load_dwordx4 v18, s[96:99], s26 offen offset:2048 lds
    v_mfma_f32_16x16x32_bf16 v[112:115], a[32:35], v[68:71], v[112:115]
    ds_read_b64_tr_b16 a[30:31], v7 offset:36352
    s_waitcnt lgkmcnt(8)
    v_mfma_f32_16x16x32_bf16 v[100:103], a[0:3], v[64:67], v[100:103]
    ds_read_b64_tr_b16 a[32:33], v8 offset:32768
    buffer_load_dwordx4 v18, s[96:99], s27 offen offset:3072 lds
    v_mfma_f32_16x16x32_bf16 v[100:103], a[4:7], v[72:75], v[100:103]
    ds_read_b64_tr_b16 a[34:35], v8 offset:33280
    v_mfma_f32_16x16x32_bf16 v[100:103], a[8:11], v[80:83], v[100:103]
    ds_read_b64_tr_b16 a[36:37], v8 offset:33792
    v_mfma_f32_16x16x32_bf16 v[100:103], a[12:15], v[88:91], v[100:103]
    ds_read_b64_tr_b16 a[38:39], v8 offset:34304
    s_add_u32 m0, s21, 147456
    v_mfma_f32_16x16x32_bf16 v[116:119], a[12:15], v[92:95], v[116:119]
    ds_read_b64_tr_b16 a[40:41], v8 offset:34816
    buffer_load_dwordx4 v18, s[96:99], s28 offen offset:0 lds
    v_mfma_f32_16x16x32_bf16 v[116:119], a[8:11], v[84:87], v[116:119]
    ds_read_b64_tr_b16 a[42:43], v8 offset:35328
    v_mfma_f32_16x16x32_bf16 v[116:119], a[4:7], v[76:79], v[116:119]
    ds_read_b64_tr_b16 a[44:45], v8 offset:35840
    ds_read_b64_tr_b16 a[46:47], v8 offset:36352
    v_mfma_f32_16x16x32_bf16 v[116:119], a[0:3], v[68:71], v[116:119]
    s_waitcnt vmcnt(13) lgkmcnt(8)
    s_barrier
    v_mfma_f32_16x16x32_bf16 v[104:107], a[16:19], v[64:67], v[104:107]
    ds_read_b64_tr_b16 a[0:1], v5 offset:49152
    buffer_load_dwordx4 v18, s[96:99], s29 offen offset:1024 lds
    v_mfma_f32_16x16x32_bf16 v[104:107], a[20:23], v[72:75], v[104:107]
    ds_read_b64_tr_b16 a[2:3], v5 offset:49664
    v_mfma_f32_16x16x32_bf16 v[104:107], a[24:27], v[80:83], v[104:107]
    ds_read_b64_tr_b16 a[4:5], v5 offset:50176
    v_mfma_f32_16x16x32_bf16 v[104:107], a[28:31], v[88:91], v[104:107]
    ds_read_b64_tr_b16 a[6:7], v5 offset:50688
    buffer_load_dwordx4 v18, s[96:99], s30 offen offset:2048 lds
    v_mfma_f32_16x16x32_bf16 v[120:123], a[28:31], v[92:95], v[120:123]
    ds_read_b64_tr_b16 a[8:9], v5 offset:51200
    v_mfma_f32_16x16x32_bf16 v[120:123], a[24:27], v[84:87], v[120:123]
    ds_read_b64_tr_b16 a[10:11], v5 offset:51712
    v_mfma_f32_16x16x32_bf16 v[120:123], a[20:23], v[76:79], v[120:123]
    ds_read_b64_tr_b16 a[12:13], v5 offset:52224
    v_mfma_f32_16x16x32_bf16 v[120:123], a[16:19], v[68:71], v[120:123]
    ds_read_b64_tr_b16 a[14:15], v5 offset:52736
    s_waitcnt lgkmcnt(8)
    v_mfma_f32_16x16x32_bf16 v[108:111], a[32:35], v[64:67], v[108:111]
    ds_read_b64_tr_b16 a[16:17], v6 offset:49152
    buffer_load_dwordx4 v18, s[96:99], s31 offen offset:3072 lds
    v_mfma_f32_16x16x32_bf16 v[108:111], a[36:39], v[72:75], v[108:111]
    ds_read_b64_tr_b16 a[18:19], v6 offset:49664
    v_mfma_f32_16x16x32_bf16 v[108:111], a[40:43], v[80:83], v[108:111]
    ds_read_b64_tr_b16 a[20:21], v6 offset:50176
    v_mfma_f32_16x16x32_bf16 v[108:111], a[44:47], v[88:91], v[108:111]
    ds_read_b64_tr_b16 a[22:23], v6 offset:50688
    s_add_u32 m0, s21, 0
    v_mfma_f32_16x16x32_bf16 v[124:127], a[44:47], v[92:95], v[124:127]
    ds_read_b64_tr_b16 a[24:25], v6 offset:51200
    buffer_load_dwordx4 v18, s[96:99], s32 offen offset:0 lds
    v_mfma_f32_16x16x32_bf16 v[124:127], a[40:43], v[84:87], v[124:127]
    ds_read_b64_tr_b16 a[26:27], v6 offset:51712
    v_mfma_f32_16x16x32_bf16 v[124:127], a[36:39], v[76:79], v[124:127]
    ds_read_b64_tr_b16 a[28:29], v6 offset:52224
    v_mfma_f32_16x16x32_bf16 v[124:127], a[32:35], v[68:71], v[124:127]
    ds_read_b64_tr_b16 a[30:31], v6 offset:52736
    s_waitcnt vmcnt(9) lgkmcnt(8)
    v_mfma_f32_16x16x32_bf16 v[96:99], a[0:3], a[48:51], v[96:99]
    ds_read_b64_tr_b16 a[32:33], v7 offset:49152
    buffer_load_dwordx4 v18, s[96:99], s33 offen offset:1024 lds
    v_mfma_f32_16x16x32_bf16 v[96:99], a[4:7], a[56:59], v[96:99]
    ds_read_b64_tr_b16 a[34:35], v7 offset:49664
    v_mfma_f32_16x16x32_bf16 v[96:99], a[8:11], a[64:67], v[96:99]
    ds_read_b64_tr_b16 a[36:37], v7 offset:50176
    v_mfma_f32_16x16x32_bf16 v[96:99], a[12:15], a[72:75], v[96:99]
    ds_read_b64_tr_b16 a[38:39], v7 offset:50688
    buffer_load_dwordx4 v18, s[96:99], s34 offen offset:2048 lds
    v_mfma_f32_16x16x32_bf16 v[112:115], a[12:15], a[76:79], v[112:115]
    ds_read_b64_tr_b16 a[40:41], v7 offset:51200
    v_mfma_f32_16x16x32_bf16 v[112:115], a[8:11], a[68:71], v[112:115]
    ds_read_b64_tr_b16 a[42:43], v7 offset:51712
    v_mfma_f32_16x16x32_bf16 v[112:115], a[4:7], a[60:63], v[112:115]
    ds_read_b64_tr_b16 a[44:45], v7 offset:52224
    v_mfma_f32_16x16x32_bf16 v[112:115], a[0:3], a[52:55], v[112:115]
    ds_read_b64_tr_b16 a[46:47], v7 offset:52736
    s_waitcnt lgkmcnt(8)
    v_mfma_f32_16x16x32_bf16 v[100:103], a[16:19], a[48:51], v[100:103]
    ds_read_b64_tr_b16 a[0:1], v8 offset:49152
    buffer_load_dwordx4 v18, s[96:99], s35 offen offset:3072 lds
    v_mfma_f32_16x16x32_bf16 v[100:103], a[20:23], a[56:59], v[100:103]
    ds_read_b64_tr_b16 a[2:3], v8 offset:49664
    v_mfma_f32_16x16x32_bf16 v[100:103], a[24:27], a[64:67], v[100:103]
    ds_read_b64_tr_b16 a[4:5], v8 offset:50176
    v_mfma_f32_16x16x32_bf16 v[100:103], a[28:31], a[72:75], v[100:103]
    ds_read_b64_tr_b16 a[6:7], v8 offset:50688
    s_add_u32 m0, s21, 16384
    v_mfma_f32_16x16x32_bf16 v[116:119], a[28:31], a[76:79], v[116:119]
    ds_read_b64_tr_b16 a[8:9], v8 offset:51200
    buffer_load_dwordx4 v18, s[96:99], s36 offen offset:0 lds
    v_mfma_f32_16x16x32_bf16 v[116:119], a[24:27], a[68:71], v[116:119]
    ds_read_b64_tr_b16 a[10:11], v8 offset:51712
    v_mfma_f32_16x16x32_bf16 v[116:119], a[20:23], a[60:63], v[116:119]
    ds_read_b64_tr_b16 a[12:13], v8 offset:52224
    ds_read_b64_tr_b16 a[14:15], v8 offset:52736
    v_mfma_f32_16x16x32_bf16 v[116:119], a[16:19], a[52:55], v[116:119]
    s_waitcnt vmcnt(9) lgkmcnt(8)
    s_barrier
    v_mfma_f32_16x16x32_bf16 v[104:107], a[32:35], a[48:51], v[104:107]
    ds_read_b64_tr_b16 a[16:17], v9 offset:0
    buffer_load_dwordx4 v18, s[96:99], s37 offen offset:1024 lds
    v_mfma_f32_16x16x32_bf16 v[104:107], a[36:39], a[56:59], v[104:107]
    ds_read_b64_tr_b16 a[18:19], v9 offset:512
    v_mfma_f32_16x16x32_bf16 v[104:107], a[40:43], a[64:67], v[104:107]
    ds_read_b64_tr_b16 a[20:21], v9 offset:1024
    v_mfma_f32_16x16x32_bf16 v[104:107], a[44:47], a[72:75], v[104:107]
    ds_read_b64_tr_b16 a[22:23], v9 offset:1536
    v_mfma_f32_16x16x32_bf16 v[120:123], a[44:47], a[76:79], v[120:123]
    ds_read_b64_tr_b16 a[24:25], v9 offset:2048
    v_mfma_f32_16x16x32_bf16 v[120:123], a[40:43], a[68:71], v[120:123]
    ds_read_b64_tr_b16 a[26:27], v9 offset:2560
    v_mfma_f32_16x16x32_bf16 v[120:123], a[36:39], a[60:63], v[120:123]
    ds_read_b64_tr_b16 a[28:29], v9 offset:3072
    v_mfma_f32_16x16x32_bf16 v[120:123], a[32:35], a[52:55], v[120:123]
    ds_read_b64_tr_b16 a[30:31], v9 offset:3584
    s_waitcnt lgkmcnt(8)
    v_mfma_f32_16x16x32_bf16 v[108:111], a[0:3], a[48:51], v[108:111]
    ds_read_b64_tr_b16 a[32:33], v10 offset:0
    buffer_load_dwordx4 v18, s[96:99], s38 offen offset:2048 lds
    v_mfma_f32_16x16x32_bf16 v[108:111], a[4:7], a[56:59], v[108:111]
    ds_read_b64_tr_b16 a[34:35], v10 offset:512
    v_mfma_f32_16x16x32_bf16 v[108:111], a[8:11], a[64:67], v[108:111]
    ds_read_b64_tr_b16 a[36:37], v10 offset:1024
    v_mfma_f32_16x16x32_bf16 v[108:111], a[12:15], a[72:75], v[108:111]
    ds_read_b64_tr_b16 a[38:39], v10 offset:1536
    buffer_load_dwordx4 v18, s[96:99], s39 offen offset:3072 lds
    v_mfma_f32_16x16x32_bf16 v[124:127], a[12:15], a[76:79], v[124:127]
    ds_read_b64_tr_b16 a[40:41], v10 offset:2048
    v_mfma_f32_16x16x32_bf16 v[124:127], a[8:11], a[68:71], v[124:127]
    ds_read_b64_tr_b16 a[42:43], v10 offset:2560
    v_mfma_f32_16x16x32_bf16 v[124:127], a[4:7], a[60:63], v[124:127]
    ds_read_b64_tr_b16 a[44:45], v10 offset:3072
    v_mfma_f32_16x16x32_bf16 v[124:127], a[0:3], a[52:55], v[124:127]
    ds_read_b64_tr_b16 a[46:47], v10 offset:3584
    s_waitcnt lgkmcnt(8)
    v_mfma_f32_16x16x32_bf16 v[128:131], a[16:19], v[160:163], v[128:131]
    ds_read_b64_tr_b16 a[0:1], v11 offset:0
    v_add_u32 v18, 32768, v18
    v_mfma_f32_16x16x32_bf16 v[128:131], a[20:23], v[168:171], v[128:131]
    ds_read_b64_tr_b16 a[2:3], v11 offset:512
    v_add_u32 v18, s23, v18
    v_mfma_f32_16x16x32_bf16 v[128:131], a[24:27], v[176:179], v[128:131]
    ds_read_b64_tr_b16 a[4:5], v11 offset:1024
    s_add_u32 m0, s21, 32768
    v_mfma_f32_16x16x32_bf16 v[128:131], a[28:31], v[184:187], v[128:131]
    ds_read_b64_tr_b16 a[6:7], v11 offset:1536
    buffer_load_dwordx4 v18, s[96:99], 0 offen offset:0 lds
    v_mfma_f32_16x16x32_bf16 v[144:147], a[28:31], v[188:191], v[144:147]
    ds_read_b64_tr_b16 a[8:9], v11 offset:2048
    v_mfma_f32_16x16x32_bf16 v[144:147], a[24:27], v[180:183], v[144:147]
    ds_read_b64_tr_b16 a[10:11], v11 offset:2560
    v_mfma_f32_16x16x32_bf16 v[144:147], a[20:23], v[172:175], v[144:147]
    ds_read_b64_tr_b16 a[12:13], v11 offset:3072
    s_mov_b32 s51, 457728
    buffer_load_dwordx4 v18, s[96:99], s51 offen offset:1024 lds
    v_mfma_f32_16x16x32_bf16 v[144:147], a[16:19], v[164:167], v[144:147]
    ds_read_b64_tr_b16 a[14:15], v11 offset:3584
    s_waitcnt lgkmcnt(8)
    v_mfma_f32_16x16x32_bf16 v[132:135], a[32:35], v[160:163], v[132:135]
    ds_read_b64_tr_b16 a[16:17], v12 offset:0
    v_cvt_pk_bf16_f32 v96, v96, v97
    v_mfma_f32_16x16x32_bf16 v[132:135], a[36:39], v[168:171], v[132:135]
    ds_read_b64_tr_b16 a[18:19], v12 offset:512
    v_cvt_pk_bf16_f32 v97, v98, v99
    v_mfma_f32_16x16x32_bf16 v[132:135], a[40:43], v[176:179], v[132:135]
    ds_read_b64_tr_b16 a[20:21], v12 offset:1024
    v_cvt_pk_bf16_f32 v98, v100, v101
    v_mfma_f32_16x16x32_bf16 v[132:135], a[44:47], v[184:187], v[132:135]
    ds_read_b64_tr_b16 a[22:23], v12 offset:1536
    v_cvt_pk_bf16_f32 v99, v102, v103
    v_mfma_f32_16x16x32_bf16 v[148:151], a[44:47], v[188:191], v[148:151]
    ds_read_b64_tr_b16 a[24:25], v12 offset:2048
    buffer_store_dwordx4 v[96:99], v20, s[12:15], 0 offen offset:0 sc1
    v_mfma_f32_16x16x32_bf16 v[148:151], a[40:43], v[180:183], v[148:151]
    ds_read_b64_tr_b16 a[26:27], v12 offset:2560
    v_mfma_f32_16x16x32_bf16 v[148:151], a[36:39], v[172:175], v[148:151]
    ds_read_b64_tr_b16 a[28:29], v12 offset:3072
    ds_read_b64_tr_b16 a[30:31], v12 offset:3584
    s_mov_b32 s48, 915456
    buffer_load_dwordx4 v18, s[96:99], s48 offen offset:2048 lds
    v_mfma_f32_16x16x32_bf16 v[148:151], a[32:35], v[164:167], v[148:151]
    s_waitcnt vmcnt(12) lgkmcnt(8)
    s_barrier
    v_mfma_f32_16x16x32_bf16 v[136:139], a[0:3], v[160:163], v[136:139]
    ds_read_b64_tr_b16 a[32:33], v9 offset:16384
    v_cvt_pk_bf16_f32 v104, v104, v105
    v_mfma_f32_16x16x32_bf16 v[136:139], a[4:7], v[168:171], v[136:139]
    ds_read_b64_tr_b16 a[34:35], v9 offset:16896
    v_cvt_pk_bf16_f32 v105, v106, v107
    v_mfma_f32_16x16x32_bf16 v[136:139], a[8:11], v[176:179], v[136:139]
    ds_read_b64_tr_b16 a[36:37], v9 offset:17408
    v_cvt_pk_bf16_f32 v106, v108, v109
    v_mfma_f32_16x16x32_bf16 v[136:139], a[12:15], v[184:187], v[136:139]
    ds_read_b64_tr_b16 a[38:39], v9 offset:17920
    v_cvt_pk_bf16_f32 v107, v110, v111
    v_mfma_f32_16x16x32_bf16 v[152:155], a[12:15], v[188:191], v[152:155]
    ds_read_b64_tr_b16 a[40:41], v9 offset:18432
    buffer_store_dwordx4 v[104:107], v20, s[12:15], 0 offen offset:1024 sc1
    v_mfma_f32_16x16x32_bf16 v[152:155], a[8:11], v[180:183], v[152:155]
    ds_read_b64_tr_b16 a[42:43], v9 offset:18944
    v_mfma_f32_16x16x32_bf16 v[152:155], a[4:7], v[172:175], v[152:155]
    ds_read_b64_tr_b16 a[44:45], v9 offset:19456
    s_mov_b32 s49, 1373184
    buffer_load_dwordx4 v18, s[96:99], s49 offen offset:3072 lds
    v_mfma_f32_16x16x32_bf16 v[152:155], a[0:3], v[164:167], v[152:155]
    ds_read_b64_tr_b16 a[46:47], v9 offset:19968
    s_waitcnt lgkmcnt(8)
    v_mfma_f32_16x16x32_bf16 v[140:143], a[16:19], v[160:163], v[140:143]
    ds_read_b64_tr_b16 a[0:1], v10 offset:16384
    v_cvt_pk_bf16_f32 v112, v112, v113
    v_mfma_f32_16x16x32_bf16 v[140:143], a[20:23], v[168:171], v[140:143]
    ds_read_b64_tr_b16 a[2:3], v10 offset:16896
    v_cvt_pk_bf16_f32 v113, v114, v115
    v_mfma_f32_16x16x32_bf16 v[140:143], a[24:27], v[176:179], v[140:143]
    ds_read_b64_tr_b16 a[4:5], v10 offset:17408
    v_cvt_pk_bf16_f32 v114, v116, v117
    v_mfma_f32_16x16x32_bf16 v[140:143], a[28:31], v[184:187], v[140:143]
    ds_read_b64_tr_b16 a[6:7], v10 offset:17920
    v_cvt_pk_bf16_f32 v115, v118, v119
    v_mfma_f32_16x16x32_bf16 v[156:159], a[28:31], v[188:191], v[156:159]
    ds_read_b64_tr_b16 a[8:9], v10 offset:18432
    buffer_store_dwordx4 v[112:115], v20, s[12:15], 0 offen offset:2048 sc1
    v_mfma_f32_16x16x32_bf16 v[156:159], a[24:27], v[180:183], v[156:159]
    ds_read_b64_tr_b16 a[10:11], v10 offset:18944
    v_mfma_f32_16x16x32_bf16 v[156:159], a[20:23], v[172:175], v[156:159]
    ds_read_b64_tr_b16 a[12:13], v10 offset:19456
    s_add_u32 m0, s21, 49152
    s_mov_b32 s50, 1835008
    buffer_load_dwordx4 v18, s[96:99], s50 offen offset:0 lds
    v_mfma_f32_16x16x32_bf16 v[156:159], a[16:19], v[164:167], v[156:159]
    ds_read_b64_tr_b16 a[14:15], v10 offset:19968
    s_waitcnt lgkmcnt(8)
    v_mfma_f32_16x16x32_bf16 v[128:131], a[32:35], v[192:195], v[128:131]
    ds_read_b64_tr_b16 a[16:17], v11 offset:16384
    v_cvt_pk_bf16_f32 v120, v120, v121
    v_mfma_f32_16x16x32_bf16 v[128:131], a[36:39], v[200:203], v[128:131]
    ds_read_b64_tr_b16 a[18:19], v11 offset:16896
    v_cvt_pk_bf16_f32 v121, v122, v123
    v_mfma_f32_16x16x32_bf16 v[128:131], a[40:43], v[208:211], v[128:131]
    ds_read_b64_tr_b16 a[20:21], v11 offset:17408
    v_cvt_pk_bf16_f32 v122, v124, v125
    v_mfma_f32_16x16x32_bf16 v[128:131], a[44:47], v[216:219], v[128:131]
    ds_read_b64_tr_b16 a[22:23], v11 offset:17920
    v_cvt_pk_bf16_f32 v123, v126, v127
    v_mfma_f32_16x16x32_bf16 v[144:147], a[44:47], v[220:223], v[144:147]
    ds_read_b64_tr_b16 a[24:25], v11 offset:18432
    buffer_store_dwordx4 v[120:123], v20, s[12:15], 0 offen offset:3072 sc1
    v_mfma_f32_16x16x32_bf16 v[144:147], a[40:43], v[212:215], v[144:147]
    ds_read_b64_tr_b16 a[26:27], v11 offset:18944
    v_mfma_f32_16x16x32_bf16 v[144:147], a[36:39], v[204:207], v[144:147]
    ds_read_b64_tr_b16 a[28:29], v11 offset:19456
    s_mov_b32 s51, 2292736
    buffer_load_dwordx4 v18, s[96:99], s51 offen offset:1024 lds
    v_mfma_f32_16x16x32_bf16 v[144:147], a[32:35], v[196:199], v[144:147]
    ds_read_b64_tr_b16 a[30:31], v11 offset:19968
    s_waitcnt lgkmcnt(8)
    v_mfma_f32_16x16x32_bf16 v[132:135], a[0:3], v[192:195], v[132:135]
    ds_read_b64_tr_b16 a[32:33], v12 offset:16384
    s_mov_b32 s48, 2750464
    v_mfma_f32_16x16x32_bf16 v[132:135], a[4:7], v[200:203], v[132:135]
    ds_read_b64_tr_b16 a[34:35], v12 offset:16896
    buffer_load_dwordx4 v18, s[96:99], s48 offen offset:2048 lds
    v_mfma_f32_16x16x32_bf16 v[132:135], a[8:11], v[208:211], v[132:135]
    ds_read_b64_tr_b16 a[36:37], v12 offset:17408
    v_mfma_f32_16x16x32_bf16 v[132:135], a[12:15], v[216:219], v[132:135]
    ds_read_b64_tr_b16 a[38:39], v12 offset:17920
    v_mfma_f32_16x16x32_bf16 v[148:151], a[12:15], v[220:223], v[148:151]
    ds_read_b64_tr_b16 a[40:41], v12 offset:18432
    v_mfma_f32_16x16x32_bf16 v[148:151], a[8:11], v[212:215], v[148:151]
    ds_read_b64_tr_b16 a[42:43], v12 offset:18944
    v_mfma_f32_16x16x32_bf16 v[148:151], a[4:7], v[204:207], v[148:151]
    ds_read_b64_tr_b16 a[44:45], v12 offset:19456
    ds_read_b64_tr_b16 a[46:47], v12 offset:19968
    v_mfma_f32_16x16x32_bf16 v[148:151], a[0:3], v[196:199], v[148:151]
    s_waitcnt vmcnt(15) lgkmcnt(8)
    s_barrier
    v_mfma_f32_16x16x32_bf16 v[136:139], a[16:19], v[192:195], v[136:139]
    ds_read_b64_tr_b16 a[0:1], v1 offset:0
    s_mov_b32 s49, 3208192
    v_mfma_f32_16x16x32_bf16 v[136:139], a[20:23], v[200:203], v[136:139]
    ds_read_b64_tr_b16 a[2:3], v1 offset:512
    buffer_load_dwordx4 v18, s[96:99], s49 offen offset:3072 lds
    v_mfma_f32_16x16x32_bf16 v[136:139], a[24:27], v[208:211], v[136:139]
    ds_read_b64_tr_b16 a[4:5], v1 offset:1024
    v_mfma_f32_16x16x32_bf16 v[136:139], a[28:31], v[216:219], v[136:139]
    ds_read_b64_tr_b16 a[6:7], v1 offset:1536
    v_mfma_f32_16x16x32_bf16 v[152:155], a[28:31], v[220:223], v[152:155]
    ds_read_b64_tr_b16 a[8:9], v1 offset:2048
    v_mfma_f32_16x16x32_bf16 v[152:155], a[24:27], v[212:215], v[152:155]
    ds_read_b64_tr_b16 a[10:11], v1 offset:2560
    v_mfma_f32_16x16x32_bf16 v[152:155], a[20:23], v[204:207], v[152:155]
    ds_read_b64_tr_b16 a[12:13], v1 offset:3072
    v_mfma_f32_16x16x32_bf16 v[152:155], a[16:19], v[196:199], v[152:155]
    ds_read_b64_tr_b16 a[14:15], v1 offset:3584
    s_waitcnt lgkmcnt(8)
    v_mfma_f32_16x16x32_bf16 v[140:143], a[32:35], v[192:195], v[140:143]
    ds_read_b64_tr_b16 a[16:17], v2 offset:0
    v_mfma_f32_16x16x32_bf16 v[140:143], a[36:39], v[200:203], v[140:143]
    ds_read_b64_tr_b16 a[18:19], v2 offset:512
    v_mfma_f32_16x16x32_bf16 v[140:143], a[40:43], v[208:211], v[140:143]
    ds_read_b64_tr_b16 a[20:21], v2 offset:1024
    v_mfma_f32_16x16x32_bf16 v[140:143], a[44:47], v[216:219], v[140:143]
    ds_read_b64_tr_b16 a[22:23], v2 offset:1536
    v_mfma_f32_16x16x32_bf16 v[156:159], a[44:47], v[220:223], v[156:159]
    ds_read_b64_tr_b16 a[24:25], v2 offset:2048
    v_mfma_f32_16x16x32_bf16 v[156:159], a[40:43], v[212:215], v[156:159]
    ds_read_b64_tr_b16 a[26:27], v2 offset:2560
    v_mfma_f32_16x16x32_bf16 v[156:159], a[36:39], v[204:207], v[156:159]
    ds_read_b64_tr_b16 a[28:29], v2 offset:3072
    v_mfma_f32_16x16x32_bf16 v[156:159], a[32:35], v[196:199], v[156:159]
    ds_read_b64_tr_b16 a[30:31], v2 offset:3584
    s_waitcnt lgkmcnt(8)
    v_mfma_f32_16x16x32_bf16 v[128:131], a[0:3], v[224:227], v[128:131]
    ds_read_b64_tr_b16 a[32:33], v3 offset:0
    v_mfma_f32_16x16x32_bf16 v[128:131], a[4:7], v[232:235], v[128:131]
    ds_read_b64_tr_b16 a[34:35], v3 offset:512
    v_mfma_f32_16x16x32_bf16 v[128:131], a[8:11], v[240:243], v[128:131]
    ds_read_b64_tr_b16 a[36:37], v3 offset:1024
    v_mfma_f32_16x16x32_bf16 v[128:131], a[12:15], v[248:251], v[128:131]
    ds_read_b64_tr_b16 a[38:39], v3 offset:1536
    v_mfma_f32_16x16x32_bf16 v[144:147], a[12:15], v[252:255], v[144:147]
    ds_read_b64_tr_b16 a[40:41], v3 offset:2048
    v_mfma_f32_16x16x32_bf16 v[144:147], a[8:11], v[244:247], v[144:147]
    ds_read_b64_tr_b16 a[42:43], v3 offset:2560
    v_mfma_f32_16x16x32_bf16 v[144:147], a[4:7], v[236:239], v[144:147]
    ds_read_b64_tr_b16 a[44:45], v3 offset:3072
    v_mfma_f32_16x16x32_bf16 v[144:147], a[0:3], v[228:231], v[144:147]
    ds_read_b64_tr_b16 a[46:47], v3 offset:3584
    s_waitcnt lgkmcnt(8)
    v_mfma_f32_16x16x32_bf16 v[132:135], a[16:19], v[224:227], v[132:135]
    ds_read_b64_tr_b16 a[0:1], v4 offset:0
    v_mfma_f32_16x16x32_bf16 v[132:135], a[20:23], v[232:235], v[132:135]
    ds_read_b64_tr_b16 a[2:3], v4 offset:512
    v_mfma_f32_16x16x32_bf16 v[132:135], a[24:27], v[240:243], v[132:135]
    ds_read_b64_tr_b16 a[4:5], v4 offset:1024
    v_mfma_f32_16x16x32_bf16 v[132:135], a[28:31], v[248:251], v[132:135]
    ds_read_b64_tr_b16 a[6:7], v4 offset:1536
    v_mfma_f32_16x16x32_bf16 v[148:151], a[28:31], v[252:255], v[148:151]
    ds_read_b64_tr_b16 a[8:9], v4 offset:2048
    v_mfma_f32_16x16x32_bf16 v[148:151], a[24:27], v[244:247], v[148:151]
    ds_read_b64_tr_b16 a[10:11], v4 offset:2560
    v_mfma_f32_16x16x32_bf16 v[148:151], a[20:23], v[236:239], v[148:151]
    ds_read_b64_tr_b16 a[12:13], v4 offset:3072
    ds_read_b64_tr_b16 a[14:15], v4 offset:3584
    v_mfma_f32_16x16x32_bf16 v[148:151], a[16:19], v[228:231], v[148:151]
    s_waitcnt vmcnt(3)
    buffer_store_dword v26, v22, s[12:15], 0 offen sc1
    s_waitcnt lgkmcnt(8)
    s_barrier
    v_mfma_f32_16x16x32_bf16 v[136:139], a[32:35], v[224:227], v[136:139]
    ds_read_b64_tr_b16 a[16:17], v1 offset:16384
    v_mfma_f32_16x16x32_bf16 v[136:139], a[36:39], v[232:235], v[136:139]
    ds_read_b64_tr_b16 a[18:19], v1 offset:16896
    v_mfma_f32_16x16x32_bf16 v[136:139], a[40:43], v[240:243], v[136:139]
    ds_read_b64_tr_b16 a[20:21], v1 offset:17408
    v_mfma_f32_16x16x32_bf16 v[136:139], a[44:47], v[248:251], v[136:139]
    ds_read_b64_tr_b16 a[22:23], v1 offset:17920
    v_mfma_f32_16x16x32_bf16 v[152:155], a[44:47], v[252:255], v[152:155]
    ds_read_b64_tr_b16 a[24:25], v1 offset:18432
    v_mfma_f32_16x16x32_bf16 v[152:155], a[40:43], v[244:247], v[152:155]
    ds_read_b64_tr_b16 a[26:27], v1 offset:18944
    v_mfma_f32_16x16x32_bf16 v[152:155], a[36:39], v[236:239], v[152:155]
    ds_read_b64_tr_b16 a[28:29], v1 offset:19456
    v_mfma_f32_16x16x32_bf16 v[152:155], a[32:35], v[228:231], v[152:155]
    ds_read_b64_tr_b16 a[30:31], v1 offset:19968
    s_waitcnt lgkmcnt(8)
    v_mfma_f32_16x16x32_bf16 v[140:143], a[0:3], v[224:227], v[140:143]
    ds_read_b64_tr_b16 a[32:33], v2 offset:16384
    v_mfma_f32_16x16x32_bf16 v[140:143], a[4:7], v[232:235], v[140:143]
    ds_read_b64_tr_b16 a[34:35], v2 offset:16896
    v_mfma_f32_16x16x32_bf16 v[140:143], a[8:11], v[240:243], v[140:143]
    ds_read_b64_tr_b16 a[36:37], v2 offset:17408
    v_mfma_f32_16x16x32_bf16 v[140:143], a[12:15], v[248:251], v[140:143]
    ds_read_b64_tr_b16 a[38:39], v2 offset:17920
    v_mfma_f32_16x16x32_bf16 v[156:159], a[12:15], v[252:255], v[156:159]
    ds_read_b64_tr_b16 a[40:41], v2 offset:18432
    v_mfma_f32_16x16x32_bf16 v[156:159], a[8:11], v[244:247], v[156:159]
    ds_read_b64_tr_b16 a[42:43], v2 offset:18944
    v_mfma_f32_16x16x32_bf16 v[156:159], a[4:7], v[236:239], v[156:159]
    ds_read_b64_tr_b16 a[44:45], v2 offset:19456
    v_mfma_f32_16x16x32_bf16 v[156:159], a[0:3], v[228:231], v[156:159]
    ds_read_b64_tr_b16 a[46:47], v2 offset:19968
    s_waitcnt lgkmcnt(8)
    v_mfma_f32_16x16x32_bf16 v[128:131], a[16:19], v[32:35], v[128:131]
    ds_read_b64_tr_b16 a[0:1], v3 offset:16384
    v_mfma_f32_16x16x32_bf16 v[128:131], a[20:23], v[40:43], v[128:131]
    ds_read_b64_tr_b16 a[2:3], v3 offset:16896
    v_mfma_f32_16x16x32_bf16 v[128:131], a[24:27], v[48:51], v[128:131]
    ds_read_b64_tr_b16 a[4:5], v3 offset:17408
    v_mfma_f32_16x16x32_bf16 v[128:131], a[28:31], v[56:59], v[128:131]
    ds_read_b64_tr_b16 a[6:7], v3 offset:17920
    v_mfma_f32_16x16x32_bf16 v[144:147], a[28:31], v[60:63], v[144:147]
    ds_read_b64_tr_b16 a[8:9], v3 offset:18432
    v_mfma_f32_16x16x32_bf16 v[144:147], a[24:27], v[52:55], v[144:147]
    ds_read_b64_tr_b16 a[10:11], v3 offset:18944
    v_mfma_f32_16x16x32_bf16 v[144:147], a[20:23], v[44:47], v[144:147]
    ds_read_b64_tr_b16 a[12:13], v3 offset:19456
    v_mfma_f32_16x16x32_bf16 v[144:147], a[16:19], v[36:39], v[144:147]
    ds_read_b64_tr_b16 a[14:15], v3 offset:19968
    s_waitcnt lgkmcnt(8)
    v_mfma_f32_16x16x32_bf16 v[132:135], a[32:35], v[32:35], v[132:135]
    ds_read_b64_tr_b16 a[16:17], v4 offset:16384
    v_mfma_f32_16x16x32_bf16 v[132:135], a[36:39], v[40:43], v[132:135]
    ds_read_b64_tr_b16 a[18:19], v4 offset:16896
    v_mfma_f32_16x16x32_bf16 v[132:135], a[40:43], v[48:51], v[132:135]
    ds_read_b64_tr_b16 a[20:21], v4 offset:17408
    v_mfma_f32_16x16x32_bf16 v[132:135], a[44:47], v[56:59], v[132:135]
    ds_read_b64_tr_b16 a[22:23], v4 offset:17920
    v_mfma_f32_16x16x32_bf16 v[148:151], a[44:47], v[60:63], v[148:151]
    ds_read_b64_tr_b16 a[24:25], v4 offset:18432
    v_mfma_f32_16x16x32_bf16 v[148:151], a[40:43], v[52:55], v[148:151]
    ds_read_b64_tr_b16 a[26:27], v4 offset:18944
    v_mfma_f32_16x16x32_bf16 v[148:151], a[36:39], v[44:47], v[148:151]
    ds_read_b64_tr_b16 a[28:29], v4 offset:19456
    ds_read_b64_tr_b16 a[30:31], v4 offset:19968
    v_mfma_f32_16x16x32_bf16 v[148:151], a[32:35], v[36:39], v[148:151]
    s_waitcnt lgkmcnt(8)
    s_barrier
    v_mfma_f32_16x16x32_bf16 v[136:139], a[0:3], v[32:35], v[136:139]
    ds_read_b64_tr_b16 a[32:33], v1 offset:32768
    v_mfma_f32_16x16x32_bf16 v[136:139], a[4:7], v[40:43], v[136:139]
    ds_read_b64_tr_b16 a[34:35], v1 offset:33280
    v_mfma_f32_16x16x32_bf16 v[136:139], a[8:11], v[48:51], v[136:139]
    ds_read_b64_tr_b16 a[36:37], v1 offset:33792
    v_mfma_f32_16x16x32_bf16 v[136:139], a[12:15], v[56:59], v[136:139]
    ds_read_b64_tr_b16 a[38:39], v1 offset:34304
    v_mfma_f32_16x16x32_bf16 v[152:155], a[12:15], v[60:63], v[152:155]
    ds_read_b64_tr_b16 a[40:41], v1 offset:34816
    v_mfma_f32_16x16x32_bf16 v[152:155], a[8:11], v[52:55], v[152:155]
    ds_read_b64_tr_b16 a[42:43], v1 offset:35328
    v_mfma_f32_16x16x32_bf16 v[152:155], a[4:7], v[44:47], v[152:155]
    ds_read_b64_tr_b16 a[44:45], v1 offset:35840
    v_mfma_f32_16x16x32_bf16 v[152:155], a[0:3], v[36:39], v[152:155]
    ds_read_b64_tr_b16 a[46:47], v1 offset:36352
    s_waitcnt lgkmcnt(8)
    v_mfma_f32_16x16x32_bf16 v[140:143], a[16:19], v[32:35], v[140:143]
    ds_read_b64_tr_b16 a[0:1], v2 offset:32768
    v_mfma_f32_16x16x32_bf16 v[140:143], a[20:23], v[40:43], v[140:143]
    ds_read_b64_tr_b16 a[2:3], v2 offset:33280
    v_mfma_f32_16x16x32_bf16 v[140:143], a[24:27], v[48:51], v[140:143]
L_pad11:
    s_cbranch_execz L_pad_ret
    ds_read_b64_tr_b16 a[4:5], v2 offset:33792
    v_mfma_f32_16x16x32_bf16 v[140:143], a[28:31], v[56:59], v[140:143]
    ds_read_b64_tr_b16 a[6:7], v2 offset:34304
    v_mfma_f32_16x16x32_bf16 v[156:159], a[28:31], v[60:63], v[156:159]
    ds_read_b64_tr_b16 a[8:9], v2 offset:34816
    v_mfma_f32_16x16x32_bf16 v[156:159], a[24:27], v[52:55], v[156:159]
    ds_read_b64_tr_b16 a[10:11], v2 offset:35328
    v_mfma_f32_16x16x32_bf16 v[156:159], a[20:23], v[44:47], v[156:159]
    ds_read_b64_tr_b16 a[12:13], v2 offset:35840
    v_mfma_f32_16x16x32_bf16 v[156:159], a[16:19], v[36:39], v[156:159]
    ds_read_b64_tr_b16 a[14:15], v2 offset:36352
    buffer_load_dword v29, v23, s[12:15], 0 offen sc1
    s_waitcnt lgkmcnt(8)
    v_mfma_f32_16x16x32_bf16 v[128:131], a[32:35], v[64:67], v[128:131]
    ds_read_b64_tr_b16 a[16:17], v3 offset:32768
    v_mfma_f32_16x16x32_bf16 v[128:131], a[36:39], v[72:75], v[128:131]
    ds_read_b64_tr_b16 a[18:19], v3 offset:33280
    v_mfma_f32_16x16x32_bf16 v[128:131], a[40:43], v[80:83], v[128:131]
    ds_read_b64_tr_b16 a[20:21], v3 offset:33792
    v_mfma_f32_16x16x32_bf16 v[128:131], a[44:47], v[88:91], v[128:131]
    ds_read_b64_tr_b16 a[22:23], v3 offset:34304
    v_mfma_f32_16x16x32_bf16 v[144:147], a[44:47], v[92:95], v[144:147]
    ds_read_b64_tr_b16 a[24:25], v3 offset:34816
    v_mfma_f32_16x16x32_bf16 v[144:147], a[40:43], v[84:87], v[144:147]
    ds_read_b64_tr_b16 a[26:27], v3 offset:35328
    v_mfma_f32_16x16x32_bf16 v[144:147], a[36:39], v[76:79], v[144:147]
    ds_read_b64_tr_b16 a[28:29], v3 offset:35840
    v_mfma_f32_16x16x32_bf16 v[144:147], a[32:35], v[68:71], v[144:147]
    ds_read_b64_tr_b16 a[30:31], v3 offset:36352
    s_waitcnt lgkmcnt(8)
    v_mfma_f32_16x16x32_bf16 v[132:135], a[0:3], v[64:67], v[132:135]
    ds_read_b64_tr_b16 a[32:33], v4 offset:32768
    v_mfma_f32_16x16x32_bf16 v[132:135], a[4:7], v[72:75], v[132:135]
    ds_read_b64_tr_b16 a[34:35], v4 offset:33280
    v_mfma_f32_16x16x32_bf16 v[132:135], a[8:11], v[80:83], v[132:135]
    ds_read_b64_tr_b16 a[36:37], v4 offset:33792
    v_mfma_f32_16x16x32_bf16 v[132:135], a[12:15], v[88:91], v[132:135]
    ds_read_b64_tr_b16 a[38:39], v4 offset:34304
    v_mfma_f32_16x16x32_bf16 v[148:151], a[12:15], v[92:95], v[148:151]
    ds_read_b64_tr_b16 a[40:41], v4 offset:34816
    v_mfma_f32_16x16x32_bf16 v[148:151], a[8:11], v[84:87], v[148:151]
    ds_read_b64_tr_b16 a[42:43], v4 offset:35328
    v_mfma_f32_16x16x32_bf16 v[148:151], a[4:7], v[76:79], v[148:151]
    ds_read_b64_tr_b16 a[44:45], v4 offset:35840
    ds_read_b64_tr_b16 a[46:47], v4 offset:36352
    v_mfma_f32_16x16x32_bf16 v[148:151], a[0:3], v[68:71], v[148:151]
    s_waitcnt vmcnt(2) lgkmcnt(8)
    s_barrier
    v_mfma_f32_16x16x32_bf16 v[136:139], a[16:19], v[64:67], v[136:139]
    ds_read_b64_tr_b16 a[0:1], v1 offset:49152
    v_mfma_f32_16x16x32_bf16 v[136:139], a[20:23], v[72:75], v[136:139]
    ds_read_b64_tr_b16 a[2:3], v1 offset:49664
    v_mfma_f32_16x16x32_bf16 v[136:139], a[24:27], v[80:83], v[136:139]
    ds_read_b64_tr_b16 a[4:5], v1 offset:50176
    v_mfma_f32_16x16x32_bf16 v[136:139], a[28:31], v[88:91], v[136:139]
    ds_read_b64_tr_b16 a[6:7], v1 offset:50688
    v_mfma_f32_16x16x32_bf16 v[152:155], a[28:31], v[92:95], v[152:155]
    ds_read_b64_tr_b16 a[8:9], v1 offset:51200
    v_mfma_f32_16x16x32_bf16 v[152:155], a[24:27], v[84:87], v[152:155]
    ds_read_b64_tr_b16 a[10:11], v1 offset:51712
    v_mfma_f32_16x16x32_bf16 v[152:155], a[20:23], v[76:79], v[152:155]
    ds_read_b64_tr_b16 a[12:13], v1 offset:52224
    v_mfma_f32_16x16x32_bf16 v[152:155], a[16:19], v[68:71], v[152:155]
    ds_read_b64_tr_b16 a[14:15], v1 offset:52736
    s_waitcnt lgkmcnt(8)
    v_mfma_f32_16x16x32_bf16 v[140:143], a[32:35], v[64:67], v[140:143]
    ds_read_b64_tr_b16 a[16:17], v2 offset:49152
    v_mfma_f32_16x16x32_bf16 v[140:143], a[36:39], v[72:75], v[140:143]
    ds_read_b64_tr_b16 a[18:19], v2 offset:49664
    v_mfma_f32_16x16x32_bf16 v[140:143], a[40:43], v[80:83], v[140:143]
    ds_read_b64_tr_b16 a[20:21], v2 offset:50176
    v_mfma_f32_16x16x32_bf16 v[140:143], a[44:47], v[88:91], v[140:143]
    ds_read_b64_tr_b16 a[22:23], v2 offset:50688
    v_mfma_f32_16x16x32_bf16 v[156:159], a[44:47], v[92:95], v[156:159]
    ds_read_b64_tr_b16 a[24:25], v2 offset:51200
    v_mfma_f32_16x16x32_bf16 v[156:159], a[40:43], v[84:87], v[156:159]
    ds_read_b64_tr_b16 a[26:27], v2 offset:51712
    v_mfma_f32_16x16x32_bf16 v[156:159], a[36:39], v[76:79], v[156:159]
    ds_read_b64_tr_b16 a[28:29], v2 offset:52224
    v_mfma_f32_16x16x32_bf16 v[156:159], a[32:35], v[68:71], v[156:159]
    ds_read_b64_tr_b16 a[30:31], v2 offset:52736
    s_waitcnt vmcnt(0)
    v_cmp_gt_u32 vcc, v27, v29
    s_cbranch_vccz L_spin3_ret
    s_mov_b32 s3, 0x40000
L_spin3_loop:
    buffer_load_dword v29, v23, s[12:15], 0 offen sc1
    s_sub_u32 s3, s3, 1
    s_cmp_eq_u32 s3, 0
    s_waitcnt vmcnt(0)
    s_cbranch_scc1 L_spin3_ret
    v_cmp_gt_u32 vcc, v27, v29
    s_cbranch_vccnz L_spin3_loop
L_spin3_ret:
    s_waitcnt lgkmcnt(8)
    v_mfma_f32_16x16x32_bf16 v[128:131], a[0:3], a[48:51], v[128:131]
    ds_read_b64_tr_b16 a[32:33], v3 offset:49152
    buffer_load_dwordx4 v[96:99], v21, s[12:15], 0 offen offset:0 sc1
    v_mfma_f32_16x16x32_bf16 v[128:131], a[4:7], a[56:59], v[128:131]
    ds_read_b64_tr_b16 a[34:35], v3 offset:49664
    v_mfma_f32_16x16x32_bf16 v[128:131], a[8:11], a[64:67], v[128:131]
    ds_read_b64_tr_b16 a[36:37], v3 offset:50176
    v_mfma_f32_16x16x32_bf16 v[128:131], a[12:15], a[72:75], v[128:131]
    ds_read_b64_tr_b16 a[38:39], v3 offset:50688
    buffer_load_dwordx4 v[104:107], v21, s[12:15], 0 offen offset:1024 sc1
    v_mfma_f32_16x16x32_bf16 v[144:147], a[12:15], a[76:79], v[144:147]
    ds_read_b64_tr_b16 a[40:41], v3 offset:51200
    v_mfma_f32_16x16x32_bf16 v[144:147], a[8:11], a[68:71], v[144:147]
    ds_read_b64_tr_b16 a[42:43], v3 offset:51712
    v_mfma_f32_16x16x32_bf16 v[144:147], a[4:7], a[60:63], v[144:147]
    ds_read_b64_tr_b16 a[44:45], v3 offset:52224
    v_mfma_f32_16x16x32_bf16 v[144:147], a[0:3], a[52:55], v[144:147]
    ds_read_b64_tr_b16 a[46:47], v3 offset:52736
    s_waitcnt lgkmcnt(8)
    v_mfma_f32_16x16x32_bf16 v[132:135], a[16:19], a[48:51], v[132:135]
    ds_read_b64_tr_b16 a[0:1], v4 offset:49152
    buffer_load_dwordx4 v[112:115], v21, s[12:15], 0 offen offset:2048 sc1
    v_mfma_f32_16x16x32_bf16 v[132:135], a[20:23], a[56:59], v[132:135]
    ds_read_b64_tr_b16 a[2:3], v4 offset:49664
    v_mfma_f32_16x16x32_bf16 v[132:135], a[24:27], a[64:67], v[132:135]
    ds_read_b64_tr_b16 a[4:5], v4 offset:50176
    v_mfma_f32_16x16x32_bf16 v[132:135], a[28:31], a[72:75], v[132:135]
    ds_read_b64_tr_b16 a[6:7], v4 offset:50688
    buffer_load_dwordx4 v[120:123], v21, s[12:15], 0 offen offset:3072 sc1
    v_mfma_f32_16x16x32_bf16 v[148:151], a[28:31], a[76:79], v[148:151]
    ds_read_b64_tr_b16 a[8:9], v4 offset:51200
    v_mfma_f32_16x16x32_bf16 v[148:151], a[24:27], a[68:71], v[148:151]
    ds_read_b64_tr_b16 a[10:11], v4 offset:51712
    v_mfma_f32_16x16x32_bf16 v[148:151], a[20:23], a[60:63], v[148:151]
    ds_read_b64_tr_b16 a[12:13], v4 offset:52224
    v_mfma_f32_16x16x32_bf16 v[148:151], a[16:19], a[52:55], v[148:151]
    ds_read_b64_tr_b16 a[14:15], v4 offset:52736
    s_waitcnt lgkmcnt(8)
    v_mfma_f32_16x16x32_bf16 v[136:139], a[32:35], a[48:51], v[136:139]
    v_mfma_f32_16x16x32_bf16 v[136:139], a[36:39], a[56:59], v[136:139]
    v_mfma_f32_16x16x32_bf16 v[136:139], a[40:43], a[64:67], v[136:139]
    v_mfma_f32_16x16x32_bf16 v[136:139], a[44:47], a[72:75], v[136:139]
    v_mfma_f32_16x16x32_bf16 v[152:155], a[44:47], a[76:79], v[152:155]
    v_mfma_f32_16x16x32_bf16 v[152:155], a[40:43], a[68:71], v[152:155]
    v_mfma_f32_16x16x32_bf16 v[152:155], a[36:39], a[60:63], v[152:155]
    v_mfma_f32_16x16x32_bf16 v[152:155], a[32:35], a[52:55], v[152:155]
    s_waitcnt lgkmcnt(0)
    v_mfma_f32_16x16x32_bf16 v[140:143], a[0:3], a[48:51], v[140:143]
    v_mfma_f32_16x16x32_bf16 v[140:143], a[4:7], a[56:59], v[140:143]
    v_mfma_f32_16x16x32_bf16 v[140:143], a[8:11], a[64:67], v[140:143]
    v_mfma_f32_16x16x32_bf16 v[140:143], a[12:15], a[72:75], v[140:143]
    v_mfma_f32_16x16x32_bf16 v[156:159], a[12:15], a[76:79], v[156:159]
    v_mfma_f32_16x16x32_bf16 v[156:159], a[8:11], a[68:71], v[156:159]
    v_mfma_f32_16x16x32_bf16 v[156:159], a[4:7], a[60:63], v[156:159]
    v_mfma_f32_16x16x32_bf16 v[156:159], a[0:3], a[52:55], v[156:159]
    s_nop 7
    s_waitcnt vmcnt(3)
    v_and_b32 v103, 0xffff0000, v99
    v_lshlrev_b32 v102, 16, v99
    v_and_b32 v101, 0xffff0000, v98
    v_lshlrev_b32 v100, 16, v98
    v_and_b32 v99, 0xffff0000, v97
    v_lshlrev_b32 v98, 16, v97
    v_and_b32 v97, 0xffff0000, v96
    v_lshlrev_b32 v96, 16, v96
    v_pk_add_f32 v[128:129], v[128:129], v[96:97]
    v_pk_add_f32 v[130:131], v[130:131], v[98:99]
    v_pk_add_f32 v[132:133], v[132:133], v[100:101]
    v_pk_add_f32 v[134:135], v[134:135], v[102:103]
    v_cvt_pk_bf16_f32 v96, v128, v129
    v_cvt_pk_bf16_f32 v97, v130, v131
    v_cvt_pk_bf16_f32 v98, v132, v133
    v_cvt_pk_bf16_f32 v99, v134, v135
    s_mov_b32 s56, 0
    s_nop 0
    v_permlane16_swap_b32 v96, v98
    v_permlane16_swap_b32 v97, v99
    buffer_store_dwordx4 v[96:99], v25, s[4:7], s56 offen offset:0 nt
    s_waitcnt vmcnt(3)
    v_and_b32 v111, 0xffff0000, v107
    v_lshlrev_b32 v110, 16, v107
    v_and_b32 v109, 0xffff0000, v106
    v_lshlrev_b32 v108, 16, v106
    v_and_b32 v107, 0xffff0000, v105
    v_lshlrev_b32 v106, 16, v105
    v_and_b32 v105, 0xffff0000, v104
    v_lshlrev_b32 v104, 16, v104
    v_pk_add_f32 v[136:137], v[136:137], v[104:105]
    v_pk_add_f32 v[138:139], v[138:139], v[106:107]
    v_pk_add_f32 v[140:141], v[140:141], v[108:109]
    v_pk_add_f32 v[142:143], v[142:143], v[110:111]
    v_cvt_pk_bf16_f32 v104, v136, v137
    v_cvt_pk_bf16_f32 v105, v138, v139
    v_cvt_pk_bf16_f32 v106, v140, v141
    v_cvt_pk_bf16_f32 v107, v142, v143
    s_mov_b32 s56, 0
    s_nop 0
    v_permlane16_swap_b32 v104, v106
    v_permlane16_swap_b32 v105, v107
    buffer_store_dwordx4 v[104:107], v25, s[4:7], s56 offen offset:64 nt
    s_waitcnt vmcnt(3)
    v_and_b32 v119, 0xffff0000, v115
    v_lshlrev_b32 v118, 16, v115
    v_and_b32 v117, 0xffff0000, v114
    v_lshlrev_b32 v116, 16, v114
    v_and_b32 v115, 0xffff0000, v113
    v_lshlrev_b32 v114, 16, v113
    v_and_b32 v113, 0xffff0000, v112
    v_lshlrev_b32 v112, 16, v112
    v_pk_add_f32 v[144:145], v[144:145], v[112:113]
    v_pk_add_f32 v[146:147], v[146:147], v[114:115]
    v_pk_add_f32 v[148:149], v[148:149], v[116:117]
    v_pk_add_f32 v[150:151], v[150:151], v[118:119]
    v_cvt_pk_bf16_f32 v112, v144, v145
    v_cvt_pk_bf16_f32 v113, v146, v147
    v_cvt_pk_bf16_f32 v114, v148, v149
    v_cvt_pk_bf16_f32 v115, v150, v151
    s_mov_b32 s56, 32768
    s_nop 0
    v_permlane16_swap_b32 v112, v114
    v_permlane16_swap_b32 v113, v115
    buffer_store_dwordx4 v[112:115], v25, s[4:7], s56 offen offset:0 nt
    s_waitcnt vmcnt(3)
    v_and_b32 v127, 0xffff0000, v123
    v_lshlrev_b32 v126, 16, v123
    v_and_b32 v125, 0xffff0000, v122
    v_lshlrev_b32 v124, 16, v122
    v_and_b32 v123, 0xffff0000, v121
    v_lshlrev_b32 v122, 16, v121
    v_and_b32 v121, 0xffff0000, v120
    v_lshlrev_b32 v120, 16, v120
    v_pk_add_f32 v[152:153], v[152:153], v[120:121]
    v_pk_add_f32 v[154:155], v[154:155], v[122:123]
    v_pk_add_f32 v[156:157], v[156:157], v[124:125]
    v_pk_add_f32 v[158:159], v[158:159], v[126:127]
    v_cvt_pk_bf16_f32 v120, v152, v153
    v_cvt_pk_bf16_f32 v121, v154, v155
    v_cvt_pk_bf16_f32 v122, v156, v157
    v_cvt_pk_bf16_f32 v123, v158, v159
    s_mov_b32 s56, 32768
    s_nop 0
    v_permlane16_swap_b32 v120, v122
    v_permlane16_swap_b32 v121, v123
    buffer_store_dwordx4 v[120:123], v25, s[4:7], s56 offen offset:64 nt
L_end:
    s_endpgm
L_hs_add:
    s_mov_b32 s56, 1
    s_atomic_add s56, s[60:61], 0
    s_branch L_hs_ret
L_spin0:
    s_mov_b32 s3, 0x40000
L_spin0_loop:
    buffer_load_dword v26, v29, s[60:63], 0 offen sc1
    s_sub_u32 s3, s3, 1
    s_cmp_eq_u32 s3, 0
    s_waitcnt vmcnt(0)
    s_cbranch_scc1 L_spin0_ret
    v_cmp_gt_u32 vcc, 32, v26
    s_cbranch_vccnz L_spin0_loop
    s_branch L_spin0_ret
.fill 8192, 4, 0xbf800000
.section .rodata,"a"
.p2align 6
.amdhsa_kernel standalone__swiglu_ffn__prompt_kernel
  .amdhsa_next_free_vgpr 512
  .amdhsa_next_free_sgpr 102
  .amdhsa_accum_offset 256
  .amdhsa_group_segment_fixed_size 0
  .amdhsa_kernarg_size 56
  .amdhsa_user_sgpr_count 2
  .amdhsa_user_sgpr_kernarg_segment_ptr 1
  .amdhsa_system_sgpr_workgroup_id_x 1
  .amdhsa_float_denorm_mode_32 3
.end_amdhsa_kernel
```
